```python
import torch

def _softmax(x, axis=-1):
    return torch.softmax(x, dim=axis)

def _gelu(x):
    return torch.nn.functional.gelu(x, approximate='tanh')

def _silu(x):
    return torch.nn.functional.silu(x)

def _sigmoid(x):
    return torch.sigmoid(x)

def _layernorm(x, axis=-1, eps=1e-05):
    m = x.mean(dim=axis, keepdim=True)
    v = x.var(dim=axis, keepdim=True, unbiased=False)
    return (x - m) / torch.sqrt(v + eps)

def _scatter_add(tgt, idx, src, axis=0):
    return tgt.clone().index_add_(axis, idx, src)

def _segment_sum(src, seg, n):
    out = torch.zeros((n,) + src.shape[1:], dtype=src.dtype)
    return out.index_add_(0, seg, src)

def _pad(x, pw):
    flat = tuple((v for pair in reversed(pw) for v in pair))
    return torch.nn.functional.pad(x, flat)
kernel_name = 'interleave_layers__memory_aug_recurrent_mem_tr__glu_gated_glu__prompt'

def setup_inputs():

    _w = lambda a: (lambda t: t.to(torch.bfloat16) if t.is_floating_point() else t)(torch.as_tensor(a))

    def _A_setup():
        B, S, Dm = (1, 2048, 448)
        H, Dh = (16, 256)
        M, seg = (8, 32)
        seg = min(seg, S)
        S = S // seg * seg
        return {'x': _w((lambda *s: torch.randn(*s, dtype=torch.bfloat16) * 0.05)(B, S, Dm)), 'mem0': _w((lambda *s: torch.randn(*s, dtype=torch.bfloat16) * 0.8)(B, M, Dm)), 'Wq': _w((lambda *s: torch.randn(*s, dtype=torch.bfloat16) * 0.8)(Dm, H, Dh) * Dm ** (-0.5)), 'Wk': _w((lambda *s: torch.randn(*s, dtype=torch.bfloat16) * 0.8)(Dm, H, Dh) * Dm ** (-0.5)), 'Wv': _w((lambda *s: torch.randn(*s, dtype=torch.bfloat16) * 0.8)(Dm, H, Dh) * Dm ** (-0.5)), 'Wo': _w((lambda *s: torch.randn(*s, dtype=torch.bfloat16) * 0.8)(H, Dh, Dm) * (H * Dh) ** (-0.5)), 'seg_len': seg}
    _A_in = _A_setup()

    def _B_setup():
        B, S, D, F = (1, 2048, 448, 1792)
        return {'x': _w((lambda *s: torch.randn(*s, dtype=torch.bfloat16) * 0.05)(B, S, D)), 'w_gate': _w((lambda *s: torch.randn(*s, dtype=torch.bfloat16) * 0.05)(D, F)), 'w_up': _w((lambda *s: torch.randn(*s, dtype=torch.bfloat16) * 0.05)(D, F)), 'w_down': _w((lambda *s: torch.randn(*s, dtype=torch.bfloat16) * 0.05)(F, D))}
    _B_in = _B_setup()
    return {'A_x': _A_in['x'], 'A_mem0': _A_in['mem0'], 'A_Wq': _A_in['Wq'], 'A_Wk': _A_in['Wk'], 'A_Wv': _A_in['Wv'], 'A_Wo': _A_in['Wo'], 'A_seg_len': _A_in['seg_len'], 'B_x': _B_in['x'], 'B_w_gate': _B_in['w_gate'], 'B_w_up': _B_in['w_up'], 'B_w_down': _B_in['w_down']}

def reference(A_x, A_mem0, A_Wq, A_Wk, A_Wv, A_Wo, A_seg_len, B_x, B_w_gate, B_w_up, B_w_down):

    def _A_ref(x, mem0, Wq, Wk, Wv, Wo, seg_len):
        B, S, Dm = x.shape
        H, Dh = (Wq.shape[1], Wq.shape[2])
        M = mem0.shape[1]
        scale = Dh ** (-0.5)
        n_seg = S // seg_len
        L = M + seg_len
        idx = torch.arange(L)
        mask = (idx[:, None] < M) | (idx[:, None] >= idx[None, :])
        mem = mem0
        outs = []
        for s in range(n_seg):
            xs = x[:, s * seg_len:(s + 1) * seg_len, :].clone()
            h = torch.concatenate([mem, xs], axis=1)
            q = torch.einsum('btd,dhe->bhte', h, Wq)
            k = torch.einsum('btd,dhe->bhte', h, Wk)
            v = torch.einsum('btd,dhe->bhte', h, Wv)
            scores = torch.einsum('bhqe,bhke->bhqk', q, k) * scale
            scores = torch.where(mask[None, None], scores, -1000000000.0)
            p = _softmax(scores, axis=-1)
            o = torch.einsum('bhqk,bhke->bhqe', p, v)
            o = torch.einsum('bhte,hed->btd', o, Wo)
            mem = o[:, :M, :].clone()
            outs.append(o[:, M:, :])
        return torch.concatenate(outs, axis=1)

    def _B_ref(x, w_gate, w_up, w_down):
        g = torch.einsum('bsd,df->bsf', x, w_gate)
        u = torch.einsum('bsd,df->bsf', x, w_up)
        h = _sigmoid(g) * u
        return torch.einsum('bsf,fd->bsd', h, w_down)
    x = A_x
    x = x + _A_ref(_layernorm(x, axis=-1), A_mem0, A_Wq, A_Wk, A_Wv, A_Wo, A_seg_len)
    x = x + _B_ref(_layernorm(x, axis=-1), B_w_gate, B_w_up, B_w_down)
    x = x + _A_ref(_layernorm(x, axis=-1), A_mem0, A_Wq, A_Wk, A_Wv, A_Wo, A_seg_len)
    x = x + _B_ref(_layernorm(x, axis=-1), B_w_gate, B_w_up, B_w_down)
    return x
```

```asm
; @launch kernel=prep_kernel grid=(256,1,1) block=(256,1,1) lds=163840
; @launch kernel=interleave_layers__memory_aug_recurrent_mem_tr__glu_gated_glu__prompt_kernel grid=(256,1,1) block=(256,1,1) lds=163328
.amdgcn_target "amdgcn-amd-amdhsa--gfx950"
.text
.globl prep_kernel
.p2align 8
.type prep_kernel,@function
prep_kernel:
  s_cmp_ge_u32 s2, 256
  s_cbranch_scc1 k0_exit
  s_load_dwordx16 s[4:19], s[0:1], 0
  s_load_dwordx8 s[20:27], s[0:1], 64
  s_load_dwordx4 s[28:31], s[0:1], 96
  s_waitcnt lgkmcnt(0)
  s_mov_b32 s32, s30
  s_and_b32 s33, s31, 0xffff
  s_mov_b32 s34, 268435456
  s_mov_b32 s35, 0x20000
  v_lshrrev_b32 v1, 6, v0
  s_nop 0
  v_readfirstlane_b32 s73, v1
  v_and_b32 v1, 63, v0
  s_and_b32 s70, s2, 7
  s_lshl_b32 s70, s70, 1
  s_bfe_u32 s71, s2, 0x10006
  s_add_u32 s70, s70, s71
  s_bfe_u32 s71, s2, 0x20004
  s_bfe_u32 s72, s2, 0x10003
  v_mov_b32 v199, 0
  s_mov_b32 s56, 268435456
  s_mov_b32 s48, s2
  s_lshl_b32 s49, s48, 12
  v_lshl_add_u32 v2, v0, 4, s49
  v_mov_b32 v4, -1
  v_mov_b32 v5, -1
  v_mov_b32 v6, -1
  v_mov_b32 v7, -1
  v_mov_b32 v8, 0
  v_mov_b32 v9, 0
  v_mov_b32 v10, 0
  v_mov_b32 v11, 0
  s_mov_b32 s34, 121405440
  s_mov_b32 s50, 120953856
fill_1:
  buffer_store_dwordx4 v[4:7], v2, s[32:35], s50 offen
  s_add_u32 s50, s50, 1048576
  s_cmp_lt_u32 s50, 121405440
  s_cbranch_scc1 fill_1
  s_mov_b32 s34, 121864192
  s_mov_b32 s50, 121412608
fill_2:
  buffer_store_dwordx4 v[4:7], v2, s[32:35], s50 offen
  s_add_u32 s50, s50, 1048576
  s_cmp_lt_u32 s50, 121864192
  s_cbranch_scc1 fill_2
  s_mov_b32 s34, 122322944
  s_mov_b32 s50, 121871360
fill_3:
  buffer_store_dwordx4 v[4:7], v2, s[32:35], s50 offen
  s_add_u32 s50, s50, 1048576
  s_cmp_lt_u32 s50, 122322944
  s_cbranch_scc1 fill_3
  s_mov_b32 s34, 122781696
  s_mov_b32 s50, 122330112
fill_4:
  buffer_store_dwordx4 v[4:7], v2, s[32:35], s50 offen
  s_add_u32 s50, s50, 1048576
  s_cmp_lt_u32 s50, 122781696
  s_cbranch_scc1 fill_4
  s_mov_b32 s34, 124092416
  s_mov_b32 s50, 122781696
fill_5:
  buffer_store_dwordx4 v[4:7], v2, s[32:35], s50 offen
  s_add_u32 s50, s50, 1048576
  s_cmp_lt_u32 s50, 124092416
  s_cbranch_scc1 fill_5
  s_mov_b32 s34, 124788736
  s_mov_b32 s50, 124092416
fill_6:
  buffer_store_dwordx4 v[8:11], v2, s[32:35], s50 offen
  s_add_u32 s50, s50, 1048576
  s_cmp_lt_u32 s50, 124788736
  s_cbranch_scc1 fill_6
  s_mov_b32 s34, 268435456
  s_cmp_ge_u32 s48, 7
  s_cbranch_scc1 done_7
  s_mov_b32 s36, s6
  s_and_b32 s37, s7, 0xffff
  s_mov_b32 s38, 7168
  s_mov_b32 s39, 0x20000
  v_lshrrev_b32 v12, 5, v0
  v_and_b32 v13, 31, v0
  v_mul_u32_u24 v3, 896, v12
  v_lshl_add_u32 v3, v13, 2, v3
  s_lshl_b32 s50, s48, 7
  buffer_load_dword v14, v3, s[36:39], s50 offen
  v_lshrrev_b32 v15, 4, v13
  v_lshlrev_b32 v15, 9, v15
  v_bfe_u32 v16, v13, 2, 2
  v_lshl_add_u32 v16, v16, 3, v12
  v_lshl_add_u32 v15, v16, 4, v15
  v_and_b32 v16, 3, v13
  v_lshl_add_u32 v15, v16, 2, v15
  v_lshrrev_b32 v17, 3, v13
  v_lshlrev_b32 v17, 4, v17
  v_lshl_add_u32 v17, v12, 1, v17
  v_and_b32 v16, 1, v13
  v_add_u32 v17, v17, v16
  v_lshlrev_b32 v17, 4, v17
  v_bfe_u32 v16, v13, 1, 2
  v_lshl_add_u32 v17, v16, 2, v17
  s_lshl_b32 s50, s48, 10
  s_waitcnt vmcnt(0)
  v_min_u32 v14, -2, v14
  s_add_u32 s51, s50, 120946688
  buffer_store_dword v14, v17, s[32:35], s51 offen
  s_add_u32 s51, s50, 121864192
  buffer_store_dword v14, v15, s[32:35], s51 offen
  s_add_u32 s51, s50, 121405440
  buffer_store_dword v14, v17, s[32:35], s51 offen
  s_add_u32 s51, s50, 122322944
  buffer_store_dword v14, v15, s[32:35], s51 offen
done_7:
  s_cmp_lg_u32 s73, 3
  s_cbranch_scc1 k0_noln
  s_mov_b32 s36, s4
  s_and_b32 s37, s5, 0xffff
  s_mov_b32 s38, 1835008
  s_mov_b32 s39, 0x20000
  s_lshr_b32 s48, s2, 2
  s_and_b32 s49, s2, 3
  s_lshl_b32 s49, s49, 3
  v_lshrrev_b32 v2, 3, v1
  v_add_u32 v2, s49, v2
  v_and_b32 v3, 7, v1
  v_mul_u32_u24 v4, 896, v2
  v_lshl_add_u32 v4, v3, 4, v4
  s_mul_i32 s56, s48, 28672
  buffer_load_dwordx4 v[8:11], v4, s[36:39], s56 offen offset:0
  buffer_load_dwordx4 v[12:15], v4, s[36:39], s56 offen offset:128
  buffer_load_dwordx4 v[16:19], v4, s[36:39], s56 offen offset:256
  buffer_load_dwordx4 v[20:23], v4, s[36:39], s56 offen offset:384
  buffer_load_dwordx4 v[24:27], v4, s[36:39], s56 offen offset:512
  buffer_load_dwordx4 v[28:31], v4, s[36:39], s56 offen offset:640
  buffer_load_dwordx4 v[32:35], v4, s[36:39], s56 offen offset:768
  v_lshrrev_b32 v5, 4, v2
  v_mul_u32_u24 v5, 14, v5
  v_lshrrev_b32 v6, 2, v3
  v_add_u32 v5, v5, v6
  v_lshlrev_b32 v5, 10, v5
  v_and_b32 v6, 3, v3
  v_lshlrev_b32 v6, 4, v6
  v_and_b32 v7, 15, v2
  v_add_u32 v6, v6, v7
  v_lshl_add_u32 v199, v6, 4, v5
k0_noln:
  s_cmp_ge_u32 s2, 128
  s_cbranch_scc1 k0_ib
  s_mov_b32 s76, s8
  s_and_b32 s77, s9, 0xffff
  s_mov_b32 s78, 3670016
  s_mov_b32 s79, 0x20000
  s_mov_b32 s80, s10
  s_and_b32 s81, s11, 0xffff
  s_mov_b32 s82, 3670016
  s_mov_b32 s83, 0x20000
  v_bfe_u32 v3, v1, 2, 2
  v_lshlrev_b32 v3, 3, v3
  v_and_b32 v2, 3, v1
  v_add_u32 v2, v2, v3
  v_mul_u32_u24 v2, 8192, v2
  v_lshrrev_b32 v3, 4, v1
  v_lshlrev_b32 v3, 4, v3
  v_add_u32 v2, v2, v3
  v_lshrrev_b32 v3, 4, v1
  v_add_u32 v3, 0, v3
  v_and_b32 v4, 15, v1
  v_xor_b32 v4, v4, v3
  v_lshrrev_b32 v5, 4, v1
  v_add_u32 v3, 0, v5
  v_lshlrev_b32 v3, 13, v3
  v_lshl_add_u32 v200, v4, 4, v3
  v_lshrrev_b32 v3, 4, v1
  v_add_u32 v3, 4, v3
  v_and_b32 v4, 15, v1
  v_xor_b32 v4, v4, v3
  v_lshrrev_b32 v5, 4, v1
  v_add_u32 v3, 8, v5
  v_lshlrev_b32 v3, 13, v3
  v_lshl_add_u32 v201, v4, 4, v3
  v_lshrrev_b32 v3, 4, v1
  v_add_u32 v3, 8, v3
  v_and_b32 v4, 15, v1
  v_xor_b32 v4, v4, v3
  v_lshrrev_b32 v5, 4, v1
  v_add_u32 v3, 16, v5
  v_lshlrev_b32 v3, 13, v3
  v_lshl_add_u32 v202, v4, 4, v3
  v_lshrrev_b32 v3, 4, v1
  v_add_u32 v3, 12, v3
  v_and_b32 v4, 15, v1
  v_xor_b32 v4, v4, v3
  v_lshrrev_b32 v5, 4, v1
  v_add_u32 v3, 24, v5
  v_lshlrev_b32 v3, 13, v3
  v_lshl_add_u32 v203, v4, 4, v3
  s_lshl_b32 s52, s70, 9
  s_mul_i32 s74, s72, 7
  s_lshl_b32 s53, s73, 1
  s_add_u32 s74, s74, s53
  s_cmp_lt_u32 s73, 3
  s_cselect_b32 s75, 1, 0
  s_add_u32 s75, s75, s74
  s_lshl_b32 s53, s74, 5
  s_add_u32 s53, s53, 0
  s_lshl_b32 s53, s53, 13
  s_add_u32 s84, s53, s52
  s_lshl_b32 s53, s74, 5
  s_add_u32 s53, s53, 4
  s_lshl_b32 s53, s53, 13
  s_add_u32 s85, s53, s52
  s_lshl_b32 s53, s75, 5
  s_add_u32 s53, s53, 0
  s_lshl_b32 s53, s53, 13
  s_add_u32 s86, s53, s52
  s_lshl_b32 s53, s75, 5
  s_add_u32 s53, s53, 4
  s_lshl_b32 s53, s53, 13
  s_add_u32 s87, s53, s52
  s_mul_i32 s53, s71, 7
  s_add_u32 s53, s53, s73
  s_add_u32 s53, s53, 0
  s_and_b32 s54, s53, 1
  s_lshl_b32 s54, s54, 2
  s_lshr_b32 s53, s53, 1
  s_lshl_b32 s53, s53, 5
  s_add_u32 s53, s53, s54
  s_lshl_b32 s53, s53, 13
  s_add_u32 s58, s53, s52
  s_mul_i32 s53, s71, 7
  s_add_u32 s53, s53, s73
  s_add_u32 s53, s53, 4
  s_and_b32 s54, s53, 1
  s_lshl_b32 s54, s54, 2
  s_lshr_b32 s53, s53, 1
  s_lshl_b32 s53, s53, 5
  s_add_u32 s53, s53, s54
  s_lshl_b32 s53, s53, 13
  s_add_u32 s59, s53, s52
  s_lshl_b32 s60, s73, 13
  s_lshl_b32 s61, s73, 15
  s_add_u32 m0, s60, 0
  s_nop 0
  buffer_load_dwordx4 v200, s[80:83], s58 offen lds
  s_add_u32 m0, s60, 1024
  s_nop 0
  buffer_load_dwordx4 v201, s[80:83], s58 offen lds
  s_add_u32 m0, s60, 2048
  s_nop 0
  buffer_load_dwordx4 v202, s[80:83], s58 offen lds
  s_add_u32 m0, s60, 3072
  s_nop 0
  buffer_load_dwordx4 v203, s[80:83], s58 offen lds
  s_cmp_eq_u32 s73, 3
  s_cbranch_scc1 w3_8
  s_add_u32 m0, s60, 32768
  s_nop 0
  buffer_load_dwordx4 v200, s[80:83], s59 offen lds
  s_add_u32 m0, s60, 33792
  s_nop 0
  buffer_load_dwordx4 v201, s[80:83], s59 offen lds
  s_add_u32 m0, s60, 34816
  s_nop 0
  buffer_load_dwordx4 v202, s[80:83], s59 offen lds
  s_add_u32 m0, s60, 35840
  s_nop 0
  buffer_load_dwordx4 v203, s[80:83], s59 offen lds
  s_add_u32 m0, s61, 65536
  s_nop 0
  buffer_load_dwordx4 v200, s[76:79], s84 offen lds
  s_add_u32 m0, s61, 66560
  s_nop 0
  buffer_load_dwordx4 v201, s[76:79], s84 offen lds
  s_add_u32 m0, s61, 67584
  s_nop 0
  buffer_load_dwordx4 v202, s[76:79], s84 offen lds
  s_add_u32 m0, s61, 68608
  s_nop 0
  buffer_load_dwordx4 v203, s[76:79], s84 offen lds
  s_add_u32 m0, s61, 73728
  s_nop 0
  buffer_load_dwordx4 v200, s[76:79], s85 offen lds
  s_add_u32 m0, s61, 74752
  s_nop 0
  buffer_load_dwordx4 v201, s[76:79], s85 offen lds
  s_add_u32 m0, s61, 75776
  s_nop 0
  buffer_load_dwordx4 v202, s[76:79], s85 offen lds
  s_add_u32 m0, s61, 76800
  s_nop 0
  buffer_load_dwordx4 v203, s[76:79], s85 offen lds
  s_add_u32 m0, s61, 81920
  s_nop 0
  buffer_load_dwordx4 v200, s[76:79], s86 offen lds
  s_add_u32 m0, s61, 82944
  s_nop 0
  buffer_load_dwordx4 v201, s[76:79], s86 offen lds
  s_add_u32 m0, s61, 83968
  s_nop 0
  buffer_load_dwordx4 v202, s[76:79], s86 offen lds
  s_add_u32 m0, s61, 84992
  s_nop 0
  buffer_load_dwordx4 v203, s[76:79], s86 offen lds
  s_add_u32 m0, s61, 90112
  s_nop 0
  buffer_load_dwordx4 v200, s[76:79], s87 offen lds
  s_add_u32 m0, s61, 91136
  s_nop 0
  buffer_load_dwordx4 v201, s[76:79], s87 offen lds
  s_add_u32 m0, s61, 92160
  s_nop 0
  buffer_load_dwordx4 v202, s[76:79], s87 offen lds
  s_add_u32 m0, s61, 93184
  s_nop 0
  buffer_load_dwordx4 v203, s[76:79], s87 offen lds
  s_branch dn_9
w3_8:
  buffer_load_dwordx4 a[0:3], v2, s[76:79], s84 offen offset:0
  buffer_load_dwordx4 a[4:7], v2, s[76:79], s85 offen offset:0
  buffer_load_dwordx4 a[16:19], v2, s[76:79], s84 offen offset:64
  buffer_load_dwordx4 a[20:23], v2, s[76:79], s85 offen offset:64
  buffer_load_dwordx4 a[32:35], v2, s[76:79], s84 offen offset:128
  buffer_load_dwordx4 a[36:39], v2, s[76:79], s85 offen offset:128
  buffer_load_dwordx4 a[48:51], v2, s[76:79], s84 offen offset:192
  buffer_load_dwordx4 a[52:55], v2, s[76:79], s85 offen offset:192
dn_9:
  s_add_u32 s57, s58, 256
  s_add_u32 m0, s60, 4096
  s_nop 0
  buffer_load_dwordx4 v200, s[80:83], s57 offen lds
  s_add_u32 m0, s60, 5120
  s_nop 0
  buffer_load_dwordx4 v201, s[80:83], s57 offen lds
  s_add_u32 m0, s60, 6144
  s_nop 0
  buffer_load_dwordx4 v202, s[80:83], s57 offen lds
  s_add_u32 m0, s60, 7168
  s_nop 0
  buffer_load_dwordx4 v203, s[80:83], s57 offen lds
  s_cmp_eq_u32 s73, 3
  s_cbranch_scc1 w3_10
  s_add_u32 s57, s59, 256
  s_add_u32 m0, s60, 36864
  s_nop 0
  buffer_load_dwordx4 v200, s[80:83], s57 offen lds
  s_add_u32 m0, s60, 37888
  s_nop 0
  buffer_load_dwordx4 v201, s[80:83], s57 offen lds
  s_add_u32 m0, s60, 38912
  s_nop 0
  buffer_load_dwordx4 v202, s[80:83], s57 offen lds
  s_add_u32 m0, s60, 39936
  s_nop 0
  buffer_load_dwordx4 v203, s[80:83], s57 offen lds
  s_add_u32 s57, s84, 256
  s_add_u32 m0, s61, 69632
  s_nop 0
  buffer_load_dwordx4 v200, s[76:79], s57 offen lds
  s_add_u32 m0, s61, 70656
  s_nop 0
  buffer_load_dwordx4 v201, s[76:79], s57 offen lds
  s_add_u32 m0, s61, 71680
  s_nop 0
  buffer_load_dwordx4 v202, s[76:79], s57 offen lds
  s_add_u32 m0, s61, 72704
  s_nop 0
  buffer_load_dwordx4 v203, s[76:79], s57 offen lds
  s_add_u32 s57, s85, 256
  s_add_u32 m0, s61, 77824
  s_nop 0
  buffer_load_dwordx4 v200, s[76:79], s57 offen lds
  s_add_u32 m0, s61, 78848
  s_nop 0
  buffer_load_dwordx4 v201, s[76:79], s57 offen lds
  s_add_u32 m0, s61, 79872
  s_nop 0
  buffer_load_dwordx4 v202, s[76:79], s57 offen lds
  s_add_u32 m0, s61, 80896
  s_nop 0
  buffer_load_dwordx4 v203, s[76:79], s57 offen lds
  s_add_u32 s57, s86, 256
  s_add_u32 m0, s61, 86016
  s_nop 0
  buffer_load_dwordx4 v200, s[76:79], s57 offen lds
  s_add_u32 m0, s61, 87040
  s_nop 0
  buffer_load_dwordx4 v201, s[76:79], s57 offen lds
  s_add_u32 m0, s61, 88064
  s_nop 0
  buffer_load_dwordx4 v202, s[76:79], s57 offen lds
  s_add_u32 m0, s61, 89088
  s_nop 0
  buffer_load_dwordx4 v203, s[76:79], s57 offen lds
  s_add_u32 s57, s87, 256
  s_add_u32 m0, s61, 94208
  s_nop 0
  buffer_load_dwordx4 v200, s[76:79], s57 offen lds
  s_add_u32 m0, s61, 95232
  s_nop 0
  buffer_load_dwordx4 v201, s[76:79], s57 offen lds
  s_add_u32 m0, s61, 96256
  s_nop 0
  buffer_load_dwordx4 v202, s[76:79], s57 offen lds
  s_add_u32 m0, s61, 97280
  s_nop 0
  buffer_load_dwordx4 v203, s[76:79], s57 offen lds
  s_branch dn_11
w3_10:
  buffer_load_dwordx4 a[64:67], v2, s[76:79], s84 offen offset:256
  buffer_load_dwordx4 a[68:71], v2, s[76:79], s85 offen offset:256
  buffer_load_dwordx4 a[80:83], v2, s[76:79], s84 offen offset:320
  buffer_load_dwordx4 a[84:87], v2, s[76:79], s85 offen offset:320
  buffer_load_dwordx4 a[96:99], v2, s[76:79], s84 offen offset:384
  buffer_load_dwordx4 a[100:103], v2, s[76:79], s85 offen offset:384
  buffer_load_dwordx4 a[112:115], v2, s[76:79], s84 offen offset:448
  buffer_load_dwordx4 a[116:119], v2, s[76:79], s85 offen offset:448
dn_11:
  s_branch k0_small
k0_ib:
  s_mov_b32 s76, s12
  s_and_b32 s77, s13, 0xffff
  s_mov_b32 s78, 3670016
  s_mov_b32 s79, 0x20000
  s_mov_b32 s80, s14
  s_and_b32 s81, s15, 0xffff
  s_mov_b32 s82, 3670016
  s_mov_b32 s83, 0x20000
  v_bfe_u32 v3, v1, 2, 2
  v_lshlrev_b32 v3, 3, v3
  v_and_b32 v2, 3, v1
  v_add_u32 v2, v2, v3
  v_mul_u32_u24 v2, 8192, v2
  v_lshrrev_b32 v3, 4, v1
  v_lshlrev_b32 v3, 4, v3
  v_add_u32 v2, v2, v3
  v_lshrrev_b32 v3, 4, v1
  v_add_u32 v3, 0, v3
  v_and_b32 v4, 15, v1
  v_xor_b32 v4, v4, v3
  v_lshrrev_b32 v5, 4, v1
  v_add_u32 v3, 0, v5
  v_lshlrev_b32 v3, 13, v3
  v_lshl_add_u32 v200, v4, 4, v3
  v_lshrrev_b32 v3, 4, v1
  v_add_u32 v3, 4, v3
  v_and_b32 v4, 15, v1
  v_xor_b32 v4, v4, v3
  v_lshrrev_b32 v5, 4, v1
  v_add_u32 v3, 8, v5
  v_lshlrev_b32 v3, 13, v3
  v_lshl_add_u32 v201, v4, 4, v3
  v_lshrrev_b32 v3, 4, v1
  v_add_u32 v3, 8, v3
  v_and_b32 v4, 15, v1
  v_xor_b32 v4, v4, v3
  v_lshrrev_b32 v5, 4, v1
  v_add_u32 v3, 16, v5
  v_lshlrev_b32 v3, 13, v3
  v_lshl_add_u32 v202, v4, 4, v3
  v_lshrrev_b32 v3, 4, v1
  v_add_u32 v3, 12, v3
  v_and_b32 v4, 15, v1
  v_xor_b32 v4, v4, v3
  v_lshrrev_b32 v5, 4, v1
  v_add_u32 v3, 24, v5
  v_lshlrev_b32 v3, 13, v3
  v_lshl_add_u32 v203, v4, 4, v3
  s_lshl_b32 s52, s70, 9
  s_mul_i32 s74, s72, 7
  s_lshl_b32 s53, s73, 1
  s_add_u32 s74, s74, s53
  s_cmp_lt_u32 s73, 3
  s_cselect_b32 s75, 1, 0
  s_add_u32 s75, s75, s74
  s_lshl_b32 s53, s74, 5
  s_add_u32 s53, s53, 0
  s_lshl_b32 s53, s53, 13
  s_add_u32 s84, s53, s52
  s_lshl_b32 s53, s74, 5
  s_add_u32 s53, s53, 4
  s_lshl_b32 s53, s53, 13
  s_add_u32 s85, s53, s52
  s_lshl_b32 s53, s75, 5
  s_add_u32 s53, s53, 0
  s_lshl_b32 s53, s53, 13
  s_add_u32 s86, s53, s52
  s_lshl_b32 s53, s75, 5
  s_add_u32 s53, s53, 4
  s_lshl_b32 s53, s53, 13
  s_add_u32 s87, s53, s52
  v_lshrrev_b32 v3, 4, v1
  v_lshlrev_b32 v4, 2, v3
  v_sub_u32 v4, v1, v4
  v_and_b32 v4, 15, v4
  v_mul_u32_u24 v3, 896, v3
  v_lshl_add_u32 v3, v4, 4, v3
  s_mul_i32 s53, s71, 7
  s_lshr_b32 s53, s53, 1
  s_lshl_b32 s53, s53, 6
  s_mul_i32 s54, s70, 229376
  s_add_u32 s53, s53, s54
  s_mul_i32 s54, s73, 28672
  s_add_u32 s58, s53, s54
  s_lshl_b32 s60, s73, 13
  s_lshl_b32 s61, s73, 15
  s_add_u32 m0, s60, 0
  s_add_u32 s53, s58, 0
  buffer_load_dwordx4 v3, s[80:83], s53 offen lds
  s_add_u32 m0, s60, 1024
  s_add_u32 s53, s58, 3584
  buffer_load_dwordx4 v3, s[80:83], s53 offen lds
  s_add_u32 m0, s60, 2048
  s_add_u32 s53, s58, 7168
  buffer_load_dwordx4 v3, s[80:83], s53 offen lds
  s_add_u32 m0, s60, 3072
  s_add_u32 s53, s58, 10752
  buffer_load_dwordx4 v3, s[80:83], s53 offen lds
  s_add_u32 m0, s60, 4096
  s_add_u32 s53, s58, 14336
  buffer_load_dwordx4 v3, s[80:83], s53 offen lds
  s_add_u32 m0, s60, 5120
  s_add_u32 s53, s58, 17920
  buffer_load_dwordx4 v3, s[80:83], s53 offen lds
  s_add_u32 m0, s60, 6144
  s_add_u32 s53, s58, 21504
  buffer_load_dwordx4 v3, s[80:83], s53 offen lds
  s_add_u32 m0, s60, 7168
  s_add_u32 s53, s58, 25088
  buffer_load_dwordx4 v3, s[80:83], s53 offen lds
  s_cmp_eq_u32 s73, 3
  s_cbranch_scc1 w3_12
  s_add_u32 m0, s61, 65536
  s_nop 0
  buffer_load_dwordx4 v200, s[76:79], s84 offen lds
  s_add_u32 m0, s61, 66560
  s_nop 0
  buffer_load_dwordx4 v201, s[76:79], s84 offen lds
  s_add_u32 m0, s61, 67584
  s_nop 0
  buffer_load_dwordx4 v202, s[76:79], s84 offen lds
  s_add_u32 m0, s61, 68608
  s_nop 0
  buffer_load_dwordx4 v203, s[76:79], s84 offen lds
  s_add_u32 m0, s61, 73728
  s_nop 0
  buffer_load_dwordx4 v200, s[76:79], s85 offen lds
  s_add_u32 m0, s61, 74752
  s_nop 0
  buffer_load_dwordx4 v201, s[76:79], s85 offen lds
  s_add_u32 m0, s61, 75776
  s_nop 0
  buffer_load_dwordx4 v202, s[76:79], s85 offen lds
  s_add_u32 m0, s61, 76800
  s_nop 0
  buffer_load_dwordx4 v203, s[76:79], s85 offen lds
  s_add_u32 m0, s61, 81920
  s_nop 0
  buffer_load_dwordx4 v200, s[76:79], s86 offen lds
  s_add_u32 m0, s61, 82944
  s_nop 0
  buffer_load_dwordx4 v201, s[76:79], s86 offen lds
  s_add_u32 m0, s61, 83968
  s_nop 0
  buffer_load_dwordx4 v202, s[76:79], s86 offen lds
  s_add_u32 m0, s61, 84992
  s_nop 0
  buffer_load_dwordx4 v203, s[76:79], s86 offen lds
  s_add_u32 m0, s61, 90112
  s_nop 0
  buffer_load_dwordx4 v200, s[76:79], s87 offen lds
  s_add_u32 m0, s61, 91136
  s_nop 0
  buffer_load_dwordx4 v201, s[76:79], s87 offen lds
  s_add_u32 m0, s61, 92160
  s_nop 0
  buffer_load_dwordx4 v202, s[76:79], s87 offen lds
  s_add_u32 m0, s61, 93184
  s_nop 0
  buffer_load_dwordx4 v203, s[76:79], s87 offen lds
  s_branch dn_13
w3_12:
  buffer_load_dwordx4 a[0:3], v2, s[76:79], s84 offen offset:0
  buffer_load_dwordx4 a[4:7], v2, s[76:79], s85 offen offset:0
  buffer_load_dwordx4 a[16:19], v2, s[76:79], s84 offen offset:64
  buffer_load_dwordx4 a[20:23], v2, s[76:79], s85 offen offset:64
  buffer_load_dwordx4 a[32:35], v2, s[76:79], s84 offen offset:128
  buffer_load_dwordx4 a[36:39], v2, s[76:79], s85 offen offset:128
  buffer_load_dwordx4 a[48:51], v2, s[76:79], s84 offen offset:192
  buffer_load_dwordx4 a[52:55], v2, s[76:79], s85 offen offset:192
dn_13:
  s_add_u32 m0, s60, 32768
  s_add_u32 s53, s58, 114688
  buffer_load_dwordx4 v3, s[80:83], s53 offen lds
  s_add_u32 m0, s60, 33792
  s_add_u32 s53, s58, 118272
  buffer_load_dwordx4 v3, s[80:83], s53 offen lds
  s_add_u32 m0, s60, 34816
  s_add_u32 s53, s58, 121856
  buffer_load_dwordx4 v3, s[80:83], s53 offen lds
  s_add_u32 m0, s60, 35840
  s_add_u32 s53, s58, 125440
  buffer_load_dwordx4 v3, s[80:83], s53 offen lds
  s_add_u32 m0, s60, 36864
  s_add_u32 s53, s58, 129024
  buffer_load_dwordx4 v3, s[80:83], s53 offen lds
  s_add_u32 m0, s60, 37888
  s_add_u32 s53, s58, 132608
  buffer_load_dwordx4 v3, s[80:83], s53 offen lds
  s_add_u32 m0, s60, 38912
  s_add_u32 s53, s58, 136192
  buffer_load_dwordx4 v3, s[80:83], s53 offen lds
  s_add_u32 m0, s60, 39936
  s_add_u32 s53, s58, 139776
  buffer_load_dwordx4 v3, s[80:83], s53 offen lds
  s_cmp_eq_u32 s73, 3
  s_cbranch_scc1 w3_14
  s_add_u32 s57, s84, 256
  s_add_u32 m0, s61, 69632
  s_nop 0
  buffer_load_dwordx4 v200, s[76:79], s57 offen lds
  s_add_u32 m0, s61, 70656
  s_nop 0
  buffer_load_dwordx4 v201, s[76:79], s57 offen lds
  s_add_u32 m0, s61, 71680
  s_nop 0
  buffer_load_dwordx4 v202, s[76:79], s57 offen lds
  s_add_u32 m0, s61, 72704
  s_nop 0
  buffer_load_dwordx4 v203, s[76:79], s57 offen lds
  s_add_u32 s57, s85, 256
  s_add_u32 m0, s61, 77824
  s_nop 0
  buffer_load_dwordx4 v200, s[76:79], s57 offen lds
  s_add_u32 m0, s61, 78848
  s_nop 0
  buffer_load_dwordx4 v201, s[76:79], s57 offen lds
  s_add_u32 m0, s61, 79872
  s_nop 0
  buffer_load_dwordx4 v202, s[76:79], s57 offen lds
  s_add_u32 m0, s61, 80896
  s_nop 0
  buffer_load_dwordx4 v203, s[76:79], s57 offen lds
  s_add_u32 s57, s86, 256
  s_add_u32 m0, s61, 86016
  s_nop 0
  buffer_load_dwordx4 v200, s[76:79], s57 offen lds
  s_add_u32 m0, s61, 87040
  s_nop 0
  buffer_load_dwordx4 v201, s[76:79], s57 offen lds
  s_add_u32 m0, s61, 88064
  s_nop 0
  buffer_load_dwordx4 v202, s[76:79], s57 offen lds
  s_add_u32 m0, s61, 89088
  s_nop 0
  buffer_load_dwordx4 v203, s[76:79], s57 offen lds
  s_add_u32 s57, s87, 256
  s_add_u32 m0, s61, 94208
  s_nop 0
  buffer_load_dwordx4 v200, s[76:79], s57 offen lds
  s_add_u32 m0, s61, 95232
  s_nop 0
  buffer_load_dwordx4 v201, s[76:79], s57 offen lds
  s_add_u32 m0, s61, 96256
  s_nop 0
  buffer_load_dwordx4 v202, s[76:79], s57 offen lds
  s_add_u32 m0, s61, 97280
  s_nop 0
  buffer_load_dwordx4 v203, s[76:79], s57 offen lds
  s_branch dn_15
w3_14:
  buffer_load_dwordx4 a[64:67], v2, s[76:79], s84 offen offset:256
  buffer_load_dwordx4 a[68:71], v2, s[76:79], s85 offen offset:256
  buffer_load_dwordx4 a[80:83], v2, s[76:79], s84 offen offset:320
  buffer_load_dwordx4 a[84:87], v2, s[76:79], s85 offen offset:320
  buffer_load_dwordx4 a[96:99], v2, s[76:79], s84 offen offset:384
  buffer_load_dwordx4 a[100:103], v2, s[76:79], s85 offen offset:384
  buffer_load_dwordx4 a[112:115], v2, s[76:79], s84 offen offset:448
  buffer_load_dwordx4 a[116:119], v2, s[76:79], s85 offen offset:448
dn_15:
k0_small:
  s_cmp_lg_u32 s73, 3
  s_cbranch_scc1 k0_run
  s_waitcnt vmcnt(24)
  v_lshlrev_b32 v40, 16, v8
  v_and_b32 v41, 0xffff0000, v8
  v_lshlrev_b32 v42, 16, v9
  v_and_b32 v43, 0xffff0000, v9
  v_lshlrev_b32 v44, 16, v10
  v_and_b32 v45, 0xffff0000, v10
  v_lshlrev_b32 v46, 16, v11
  v_and_b32 v47, 0xffff0000, v11
  v_lshlrev_b32 v48, 16, v12
  v_and_b32 v49, 0xffff0000, v12
  v_lshlrev_b32 v50, 16, v13
  v_and_b32 v51, 0xffff0000, v13
  v_lshlrev_b32 v52, 16, v14
  v_and_b32 v53, 0xffff0000, v14
  v_lshlrev_b32 v54, 16, v15
  v_and_b32 v55, 0xffff0000, v15
  v_lshlrev_b32 v56, 16, v16
  v_and_b32 v57, 0xffff0000, v16
  v_lshlrev_b32 v58, 16, v17
  v_and_b32 v59, 0xffff0000, v17
  v_lshlrev_b32 v60, 16, v18
  v_and_b32 v61, 0xffff0000, v18
  v_lshlrev_b32 v62, 16, v19
  v_and_b32 v63, 0xffff0000, v19
  v_lshlrev_b32 v64, 16, v20
  v_and_b32 v65, 0xffff0000, v20
  v_lshlrev_b32 v66, 16, v21
  v_and_b32 v67, 0xffff0000, v21
  v_lshlrev_b32 v68, 16, v22
  v_and_b32 v69, 0xffff0000, v22
  v_lshlrev_b32 v70, 16, v23
  v_and_b32 v71, 0xffff0000, v23
  v_lshlrev_b32 v72, 16, v24
  v_and_b32 v73, 0xffff0000, v24
  v_lshlrev_b32 v74, 16, v25
  v_and_b32 v75, 0xffff0000, v25
  v_lshlrev_b32 v76, 16, v26
  v_and_b32 v77, 0xffff0000, v26
  v_lshlrev_b32 v78, 16, v27
  v_and_b32 v79, 0xffff0000, v27
  v_lshlrev_b32 v80, 16, v28
  v_and_b32 v81, 0xffff0000, v28
  v_lshlrev_b32 v82, 16, v29
  v_and_b32 v83, 0xffff0000, v29
  v_lshlrev_b32 v84, 16, v30
  v_and_b32 v85, 0xffff0000, v30
  v_lshlrev_b32 v86, 16, v31
  v_and_b32 v87, 0xffff0000, v31
  v_lshlrev_b32 v88, 16, v32
  v_and_b32 v89, 0xffff0000, v32
  v_lshlrev_b32 v90, 16, v33
  v_and_b32 v91, 0xffff0000, v33
  v_lshlrev_b32 v92, 16, v34
  v_and_b32 v93, 0xffff0000, v34
  v_lshlrev_b32 v94, 16, v35
  v_and_b32 v95, 0xffff0000, v35
  v_add_f32 v6, v40, v41
  v_add_f32 v7, v42, v43
  v_add_f32 v6, v6, v44
  v_add_f32 v7, v7, v45
  v_add_f32 v6, v6, v46
  v_add_f32 v7, v7, v47
  v_add_f32 v6, v6, v48
  v_add_f32 v7, v7, v49
  v_add_f32 v6, v6, v50
  v_add_f32 v7, v7, v51
  v_add_f32 v6, v6, v52
  v_add_f32 v7, v7, v53
  v_add_f32 v6, v6, v54
  v_add_f32 v7, v7, v55
  v_add_f32 v6, v6, v56
  v_add_f32 v7, v7, v57
  v_add_f32 v6, v6, v58
  v_add_f32 v7, v7, v59
  v_add_f32 v6, v6, v60
  v_add_f32 v7, v7, v61
  v_add_f32 v6, v6, v62
  v_add_f32 v7, v7, v63
  v_add_f32 v6, v6, v64
  v_add_f32 v7, v7, v65
  v_add_f32 v6, v6, v66
  v_add_f32 v7, v7, v67
  v_add_f32 v6, v6, v68
  v_add_f32 v7, v7, v69
  v_add_f32 v6, v6, v70
  v_add_f32 v7, v7, v71
  v_add_f32 v6, v6, v72
  v_add_f32 v7, v7, v73
  v_add_f32 v6, v6, v74
  v_add_f32 v7, v7, v75
  v_add_f32 v6, v6, v76
  v_add_f32 v7, v7, v77
  v_add_f32 v6, v6, v78
  v_add_f32 v7, v7, v79
  v_add_f32 v6, v6, v80
  v_add_f32 v7, v7, v81
  v_add_f32 v6, v6, v82
  v_add_f32 v7, v7, v83
  v_add_f32 v6, v6, v84
  v_add_f32 v7, v7, v85
  v_add_f32 v6, v6, v86
  v_add_f32 v7, v7, v87
  v_add_f32 v6, v6, v88
  v_add_f32 v7, v7, v89
  v_add_f32 v6, v6, v90
  v_add_f32 v7, v7, v91
  v_add_f32 v6, v6, v92
  v_add_f32 v7, v7, v93
  v_add_f32 v6, v6, v94
  v_add_f32 v7, v7, v95
  v_add_f32 v6, v6, v7
  s_nop 1
  v_add_f32_dpp v6, v6, v6 quad_perm:[1,0,3,2] row_mask:0xf bank_mask:0xf
  s_nop 1
  v_add_f32_dpp v6, v6, v6 quad_perm:[2,3,0,1] row_mask:0xf bank_mask:0xf
  s_nop 1
  v_add_f32_dpp v6, v6, v6 row_half_mirror row_mask:0xf bank_mask:0xf
  v_mul_f32 v6, 0x3b124925, v6
  v_sub_f32 v40, v40, v6
  v_sub_f32 v41, v41, v6
  v_sub_f32 v42, v42, v6
  v_sub_f32 v43, v43, v6
  v_sub_f32 v44, v44, v6
  v_sub_f32 v45, v45, v6
  v_sub_f32 v46, v46, v6
  v_sub_f32 v47, v47, v6
  v_sub_f32 v48, v48, v6
  v_sub_f32 v49, v49, v6
  v_sub_f32 v50, v50, v6
  v_sub_f32 v51, v51, v6
  v_sub_f32 v52, v52, v6
  v_sub_f32 v53, v53, v6
  v_sub_f32 v54, v54, v6
  v_sub_f32 v55, v55, v6
  v_sub_f32 v56, v56, v6
  v_sub_f32 v57, v57, v6
  v_sub_f32 v58, v58, v6
  v_sub_f32 v59, v59, v6
  v_sub_f32 v60, v60, v6
  v_sub_f32 v61, v61, v6
  v_sub_f32 v62, v62, v6
  v_sub_f32 v63, v63, v6
  v_sub_f32 v64, v64, v6
  v_sub_f32 v65, v65, v6
  v_sub_f32 v66, v66, v6
  v_sub_f32 v67, v67, v6
  v_sub_f32 v68, v68, v6
  v_sub_f32 v69, v69, v6
  v_sub_f32 v70, v70, v6
  v_sub_f32 v71, v71, v6
  v_sub_f32 v72, v72, v6
  v_sub_f32 v73, v73, v6
  v_sub_f32 v74, v74, v6
  v_sub_f32 v75, v75, v6
  v_sub_f32 v76, v76, v6
  v_sub_f32 v77, v77, v6
  v_sub_f32 v78, v78, v6
  v_sub_f32 v79, v79, v6
  v_sub_f32 v80, v80, v6
  v_sub_f32 v81, v81, v6
  v_sub_f32 v82, v82, v6
  v_sub_f32 v83, v83, v6
  v_sub_f32 v84, v84, v6
  v_sub_f32 v85, v85, v6
  v_sub_f32 v86, v86, v6
  v_sub_f32 v87, v87, v6
  v_sub_f32 v88, v88, v6
  v_sub_f32 v89, v89, v6
  v_sub_f32 v90, v90, v6
  v_sub_f32 v91, v91, v6
  v_sub_f32 v92, v92, v6
  v_sub_f32 v93, v93, v6
  v_sub_f32 v94, v94, v6
  v_sub_f32 v95, v95, v6
  v_mul_f32 v6, v40, v40
  v_mul_f32 v7, v41, v41
  v_fmac_f32 v6, v42, v42
  v_fmac_f32 v7, v43, v43
  v_fmac_f32 v6, v44, v44
  v_fmac_f32 v7, v45, v45
  v_fmac_f32 v6, v46, v46
  v_fmac_f32 v7, v47, v47
  v_fmac_f32 v6, v48, v48
  v_fmac_f32 v7, v49, v49
  v_fmac_f32 v6, v50, v50
  v_fmac_f32 v7, v51, v51
  v_fmac_f32 v6, v52, v52
  v_fmac_f32 v7, v53, v53
  v_fmac_f32 v6, v54, v54
  v_fmac_f32 v7, v55, v55
  v_fmac_f32 v6, v56, v56
  v_fmac_f32 v7, v57, v57
  v_fmac_f32 v6, v58, v58
  v_fmac_f32 v7, v59, v59
  v_fmac_f32 v6, v60, v60
  v_fmac_f32 v7, v61, v61
  v_fmac_f32 v6, v62, v62
  v_fmac_f32 v7, v63, v63
  v_fmac_f32 v6, v64, v64
  v_fmac_f32 v7, v65, v65
  v_fmac_f32 v6, v66, v66
  v_fmac_f32 v7, v67, v67
  v_fmac_f32 v6, v68, v68
  v_fmac_f32 v7, v69, v69
  v_fmac_f32 v6, v70, v70
  v_fmac_f32 v7, v71, v71
  v_fmac_f32 v6, v72, v72
  v_fmac_f32 v7, v73, v73
  v_fmac_f32 v6, v74, v74
  v_fmac_f32 v7, v75, v75
  v_fmac_f32 v6, v76, v76
  v_fmac_f32 v7, v77, v77
  v_fmac_f32 v6, v78, v78
  v_fmac_f32 v7, v79, v79
  v_fmac_f32 v6, v80, v80
  v_fmac_f32 v7, v81, v81
  v_fmac_f32 v6, v82, v82
  v_fmac_f32 v7, v83, v83
  v_fmac_f32 v6, v84, v84
  v_fmac_f32 v7, v85, v85
  v_fmac_f32 v6, v86, v86
  v_fmac_f32 v7, v87, v87
  v_fmac_f32 v6, v88, v88
  v_fmac_f32 v7, v89, v89
  v_fmac_f32 v6, v90, v90
  v_fmac_f32 v7, v91, v91
  v_fmac_f32 v6, v92, v92
  v_fmac_f32 v7, v93, v93
  v_fmac_f32 v6, v94, v94
  v_fmac_f32 v7, v95, v95
  v_add_f32 v6, v6, v7
  s_nop 1
  v_add_f32_dpp v6, v6, v6 quad_perm:[1,0,3,2] row_mask:0xf bank_mask:0xf
  s_nop 1
  v_add_f32_dpp v6, v6, v6 quad_perm:[2,3,0,1] row_mask:0xf bank_mask:0xf
  s_nop 1
  v_add_f32_dpp v6, v6, v6 row_half_mirror row_mask:0xf bank_mask:0xf
  v_mov_b32 v7, 0x3727c5ac
  v_fmac_f32 v7, 0x3b124925, v6
  v_rsq_f32 v7, v7
  s_nop 0
  v_mul_f32 v40, v40, v7
  v_mul_f32 v41, v41, v7
  v_mul_f32 v42, v42, v7
  v_mul_f32 v43, v43, v7
  v_mul_f32 v44, v44, v7
  v_mul_f32 v45, v45, v7
  v_mul_f32 v46, v46, v7
  v_mul_f32 v47, v47, v7
  v_mul_f32 v48, v48, v7
  v_mul_f32 v49, v49, v7
  v_mul_f32 v50, v50, v7
  v_mul_f32 v51, v51, v7
  v_mul_f32 v52, v52, v7
  v_mul_f32 v53, v53, v7
  v_mul_f32 v54, v54, v7
  v_mul_f32 v55, v55, v7
  v_mul_f32 v56, v56, v7
  v_mul_f32 v57, v57, v7
  v_mul_f32 v58, v58, v7
  v_mul_f32 v59, v59, v7
  v_mul_f32 v60, v60, v7
  v_mul_f32 v61, v61, v7
  v_mul_f32 v62, v62, v7
  v_mul_f32 v63, v63, v7
  v_mul_f32 v64, v64, v7
  v_mul_f32 v65, v65, v7
  v_mul_f32 v66, v66, v7
  v_mul_f32 v67, v67, v7
  v_mul_f32 v68, v68, v7
  v_mul_f32 v69, v69, v7
  v_mul_f32 v70, v70, v7
  v_mul_f32 v71, v71, v7
  v_mul_f32 v72, v72, v7
  v_mul_f32 v73, v73, v7
  v_mul_f32 v74, v74, v7
  v_mul_f32 v75, v75, v7
  v_mul_f32 v76, v76, v7
  v_mul_f32 v77, v77, v7
  v_mul_f32 v78, v78, v7
  v_mul_f32 v79, v79, v7
  v_mul_f32 v80, v80, v7
  v_mul_f32 v81, v81, v7
  v_mul_f32 v82, v82, v7
  v_mul_f32 v83, v83, v7
  v_mul_f32 v84, v84, v7
  v_mul_f32 v85, v85, v7
  v_mul_f32 v86, v86, v7
  v_mul_f32 v87, v87, v7
  v_mul_f32 v88, v88, v7
  v_mul_f32 v89, v89, v7
  v_mul_f32 v90, v90, v7
  v_mul_f32 v91, v91, v7
  v_mul_f32 v92, v92, v7
  v_mul_f32 v93, v93, v7
  v_mul_f32 v94, v94, v7
  v_mul_f32 v95, v95, v7
  v_cvt_pk_bf16_f32 v8, v40, v41
  v_cvt_pk_bf16_f32 v9, v42, v43
  v_cvt_pk_bf16_f32 v10, v44, v45
  v_cvt_pk_bf16_f32 v11, v46, v47
  v_cvt_pk_bf16_f32 v12, v48, v49
  v_cvt_pk_bf16_f32 v13, v50, v51
  v_cvt_pk_bf16_f32 v14, v52, v53
  v_cvt_pk_bf16_f32 v15, v54, v55
  v_cvt_pk_bf16_f32 v16, v56, v57
  v_cvt_pk_bf16_f32 v17, v58, v59
  v_cvt_pk_bf16_f32 v18, v60, v61
  v_cvt_pk_bf16_f32 v19, v62, v63
  v_cvt_pk_bf16_f32 v20, v64, v65
  v_cvt_pk_bf16_f32 v21, v66, v67
  v_cvt_pk_bf16_f32 v22, v68, v69
  v_cvt_pk_bf16_f32 v23, v70, v71
  v_cvt_pk_bf16_f32 v24, v72, v73
  v_cvt_pk_bf16_f32 v25, v74, v75
  v_cvt_pk_bf16_f32 v26, v76, v77
  v_cvt_pk_bf16_f32 v27, v78, v79
  v_cvt_pk_bf16_f32 v28, v80, v81
  v_cvt_pk_bf16_f32 v29, v82, v83
  v_cvt_pk_bf16_f32 v30, v84, v85
  v_cvt_pk_bf16_f32 v31, v86, v87
  v_cvt_pk_bf16_f32 v32, v88, v89
  v_cvt_pk_bf16_f32 v33, v90, v91
  v_cvt_pk_bf16_f32 v34, v92, v93
  v_cvt_pk_bf16_f32 v35, v94, v95
  s_add_u32 s56, s56, 17661952
  buffer_store_dwordx4 v[8:11], v199, s[32:35], s56 offen
  s_add_u32 s56, s56, 2048
  buffer_store_dwordx4 v[12:15], v199, s[32:35], s56 offen
  s_add_u32 s56, s56, 2048
  buffer_store_dwordx4 v[16:19], v199, s[32:35], s56 offen
  s_add_u32 s56, s56, 2048
  buffer_store_dwordx4 v[20:23], v199, s[32:35], s56 offen
  s_add_u32 s56, s56, 2048
  buffer_store_dwordx4 v[24:27], v199, s[32:35], s56 offen
  s_add_u32 s56, s56, 2048
  buffer_store_dwordx4 v[28:31], v199, s[32:35], s56 offen
  s_add_u32 s56, s56, 2048
  buffer_store_dwordx4 v[32:35], v199, s[32:35], s56 offen
  s_add_u32 s56, s56, 2048
k0_run:
  s_cmp_ge_u32 s2, 128
  s_cbranch_scc1 k0_rb
  v_and_b32 v1, 63, v0
  v_lshlrev_b32 v3, 4, v1
  v_and_b32 v4, 15, v1
  v_lshrrev_b32 v5, 4, v1
  v_add_u32 v6, 0, v5
  v_xor_b32 v6, v6, v4
  v_lshlrev_b32 v6, 4, v6
  v_lshl_add_u32 v184, v4, 8, v6
  s_lshl_b32 s53, s73, 15
  s_add_u32 s53, s53, 65536
  v_add_u32 v188, s53, v184
  v_add_u32 v6, 4, v5
  v_xor_b32 v6, v6, v4
  v_lshlrev_b32 v6, 4, v6
  v_lshl_add_u32 v185, v4, 8, v6
  s_lshl_b32 s53, s73, 15
  s_add_u32 s53, s53, 65536
  v_add_u32 v189, s53, v185
  v_add_u32 v6, 8, v5
  v_xor_b32 v6, v6, v4
  v_lshlrev_b32 v6, 4, v6
  v_lshl_add_u32 v186, v4, 8, v6
  s_lshl_b32 s53, s73, 15
  s_add_u32 s53, s53, 65536
  v_add_u32 v190, s53, v186
  v_add_u32 v6, 12, v5
  v_xor_b32 v6, v6, v4
  v_lshlrev_b32 v6, 4, v6
  v_lshl_add_u32 v187, v4, 8, v6
  s_lshl_b32 s53, s73, 15
  s_add_u32 s53, s53, 65536
  v_add_u32 v191, s53, v187
  s_cmp_eq_u32 s73, 3
  s_cbranch_scc1 w3_17
  s_waitcnt vmcnt(24)
  s_branch w3_17_j
w3_17:
  s_waitcnt vmcnt(12)
w3_17_j:
  s_barrier
  s_cmp_eq_u32 s73, 3
  s_cbranch_scc1 nr_16
  ds_read_b128 a[0:3], v188 offset:0
  ds_read_b128 a[4:7], v188 offset:8192
  ds_read_b128 a[8:11], v188 offset:16384
  ds_read_b128 a[12:15], v188 offset:24576
  ds_read_b128 a[16:19], v189 offset:0
  ds_read_b128 a[20:23], v189 offset:8192
  ds_read_b128 a[24:27], v189 offset:16384
  ds_read_b128 a[28:31], v189 offset:24576
  s_waitcnt lgkmcnt(4)
  ds_read_b128 a[32:35], v190 offset:0
  ds_read_b128 a[36:39], v190 offset:8192
  ds_read_b128 a[40:43], v190 offset:16384
  ds_read_b128 a[44:47], v190 offset:24576
  ds_read_b128 a[48:51], v191 offset:0
  ds_read_b128 a[52:55], v191 offset:8192
  ds_read_b128 a[56:59], v191 offset:16384
  ds_read_b128 a[60:63], v191 offset:24576
  s_waitcnt lgkmcnt(4)
nr_16:
  ds_read_b128 v[120:123], v184 offset:0
  ds_read_b128 v[124:127], v184 offset:8192
  ds_read_b128 v[128:131], v184 offset:16384
  ds_read_b128 v[132:135], v184 offset:24576
  ds_read_b128 v[136:139], v184 offset:32768
  ds_read_b128 v[140:143], v184 offset:40960
  ds_read_b128 v[144:147], v184 offset:49152
  s_waitcnt lgkmcnt(0)
  ds_read_b128 v[148:151], v185 offset:0
  ds_read_b128 v[152:155], v185 offset:8192
  ds_read_b128 v[156:159], v185 offset:16384
  ds_read_b128 v[160:163], v185 offset:24576
  ds_read_b128 v[164:167], v185 offset:32768
  ds_read_b128 v[168:171], v185 offset:40960
  ds_read_b128 v[172:175], v185 offset:49152
  v_mfma_f32_16x16x32_bf16 v[8:11], a[0:3], v[120:123], 0
  v_mfma_f32_16x16x32_bf16 v[12:15], a[0:3], v[124:127], 0
  v_mfma_f32_16x16x32_bf16 v[16:19], a[0:3], v[128:131], 0
  v_mfma_f32_16x16x32_bf16 v[20:23], a[0:3], v[132:135], 0
  v_mfma_f32_16x16x32_bf16 v[24:27], a[0:3], v[136:139], 0
  v_mfma_f32_16x16x32_bf16 v[28:31], a[0:3], v[140:143], 0
  v_mfma_f32_16x16x32_bf16 v[32:35], a[0:3], v[144:147], 0
  v_mfma_f32_16x16x32_bf16 v[36:39], a[4:7], v[120:123], 0
  v_mfma_f32_16x16x32_bf16 v[40:43], a[4:7], v[124:127], 0
  v_mfma_f32_16x16x32_bf16 v[44:47], a[4:7], v[128:131], 0
  v_mfma_f32_16x16x32_bf16 v[48:51], a[4:7], v[132:135], 0
  v_mfma_f32_16x16x32_bf16 v[52:55], a[4:7], v[136:139], 0
  v_mfma_f32_16x16x32_bf16 v[56:59], a[4:7], v[140:143], 0
  v_mfma_f32_16x16x32_bf16 v[60:63], a[4:7], v[144:147], 0
  v_mfma_f32_16x16x32_bf16 v[64:67], a[8:11], v[120:123], 0
  v_mfma_f32_16x16x32_bf16 v[68:71], a[8:11], v[124:127], 0
  v_mfma_f32_16x16x32_bf16 v[72:75], a[8:11], v[128:131], 0
  v_mfma_f32_16x16x32_bf16 v[76:79], a[8:11], v[132:135], 0
  v_mfma_f32_16x16x32_bf16 v[80:83], a[8:11], v[136:139], 0
  v_mfma_f32_16x16x32_bf16 v[84:87], a[8:11], v[140:143], 0
  v_mfma_f32_16x16x32_bf16 v[88:91], a[8:11], v[144:147], 0
  v_mfma_f32_16x16x32_bf16 v[92:95], a[12:15], v[120:123], 0
  v_mfma_f32_16x16x32_bf16 v[96:99], a[12:15], v[124:127], 0
  v_mfma_f32_16x16x32_bf16 v[100:103], a[12:15], v[128:131], 0
  v_mfma_f32_16x16x32_bf16 v[104:107], a[12:15], v[132:135], 0
  v_mfma_f32_16x16x32_bf16 v[108:111], a[12:15], v[136:139], 0
  v_mfma_f32_16x16x32_bf16 v[112:115], a[12:15], v[140:143], 0
  v_mfma_f32_16x16x32_bf16 v[116:119], a[12:15], v[144:147], 0
  s_waitcnt lgkmcnt(0)
  ds_read_b128 v[120:123], v186 offset:0
  ds_read_b128 v[124:127], v186 offset:8192
  ds_read_b128 v[128:131], v186 offset:16384
  ds_read_b128 v[132:135], v186 offset:24576
  ds_read_b128 v[136:139], v186 offset:32768
  ds_read_b128 v[140:143], v186 offset:40960
  ds_read_b128 v[144:147], v186 offset:49152
  v_mfma_f32_16x16x32_bf16 v[8:11], a[16:19], v[148:151], v[8:11]
  v_mfma_f32_16x16x32_bf16 v[12:15], a[16:19], v[152:155], v[12:15]
  v_mfma_f32_16x16x32_bf16 v[16:19], a[16:19], v[156:159], v[16:19]
  v_mfma_f32_16x16x32_bf16 v[20:23], a[16:19], v[160:163], v[20:23]
  v_mfma_f32_16x16x32_bf16 v[24:27], a[16:19], v[164:167], v[24:27]
  v_mfma_f32_16x16x32_bf16 v[28:31], a[16:19], v[168:171], v[28:31]
  v_mfma_f32_16x16x32_bf16 v[32:35], a[16:19], v[172:175], v[32:35]
  v_mfma_f32_16x16x32_bf16 v[36:39], a[20:23], v[148:151], v[36:39]
  v_mfma_f32_16x16x32_bf16 v[40:43], a[20:23], v[152:155], v[40:43]
  v_mfma_f32_16x16x32_bf16 v[44:47], a[20:23], v[156:159], v[44:47]
  v_mfma_f32_16x16x32_bf16 v[48:51], a[20:23], v[160:163], v[48:51]
  v_mfma_f32_16x16x32_bf16 v[52:55], a[20:23], v[164:167], v[52:55]
  v_mfma_f32_16x16x32_bf16 v[56:59], a[20:23], v[168:171], v[56:59]
  v_mfma_f32_16x16x32_bf16 v[60:63], a[20:23], v[172:175], v[60:63]
  v_mfma_f32_16x16x32_bf16 v[64:67], a[24:27], v[148:151], v[64:67]
  v_mfma_f32_16x16x32_bf16 v[68:71], a[24:27], v[152:155], v[68:71]
  v_mfma_f32_16x16x32_bf16 v[72:75], a[24:27], v[156:159], v[72:75]
  v_mfma_f32_16x16x32_bf16 v[76:79], a[24:27], v[160:163], v[76:79]
  v_mfma_f32_16x16x32_bf16 v[80:83], a[24:27], v[164:167], v[80:83]
  v_mfma_f32_16x16x32_bf16 v[84:87], a[24:27], v[168:171], v[84:87]
  v_mfma_f32_16x16x32_bf16 v[88:91], a[24:27], v[172:175], v[88:91]
  v_mfma_f32_16x16x32_bf16 v[92:95], a[28:31], v[148:151], v[92:95]
  v_mfma_f32_16x16x32_bf16 v[96:99], a[28:31], v[152:155], v[96:99]
  v_mfma_f32_16x16x32_bf16 v[100:103], a[28:31], v[156:159], v[100:103]
  v_mfma_f32_16x16x32_bf16 v[104:107], a[28:31], v[160:163], v[104:107]
  v_mfma_f32_16x16x32_bf16 v[108:111], a[28:31], v[164:167], v[108:111]
  v_mfma_f32_16x16x32_bf16 v[112:115], a[28:31], v[168:171], v[112:115]
  v_mfma_f32_16x16x32_bf16 v[116:119], a[28:31], v[172:175], v[116:119]
  s_waitcnt lgkmcnt(0)
  ds_read_b128 v[148:151], v187 offset:0
  ds_read_b128 v[152:155], v187 offset:8192
  ds_read_b128 v[156:159], v187 offset:16384
  ds_read_b128 v[160:163], v187 offset:24576
  ds_read_b128 v[164:167], v187 offset:32768
  ds_read_b128 v[168:171], v187 offset:40960
  ds_read_b128 v[172:175], v187 offset:49152
  v_mfma_f32_16x16x32_bf16 v[8:11], a[32:35], v[120:123], v[8:11]
  v_mfma_f32_16x16x32_bf16 v[12:15], a[32:35], v[124:127], v[12:15]
  v_mfma_f32_16x16x32_bf16 v[16:19], a[32:35], v[128:131], v[16:19]
  v_mfma_f32_16x16x32_bf16 v[20:23], a[32:35], v[132:135], v[20:23]
  v_mfma_f32_16x16x32_bf16 v[24:27], a[32:35], v[136:139], v[24:27]
  v_mfma_f32_16x16x32_bf16 v[28:31], a[32:35], v[140:143], v[28:31]
  v_mfma_f32_16x16x32_bf16 v[32:35], a[32:35], v[144:147], v[32:35]
  v_mfma_f32_16x16x32_bf16 v[36:39], a[36:39], v[120:123], v[36:39]
  v_mfma_f32_16x16x32_bf16 v[40:43], a[36:39], v[124:127], v[40:43]
  v_mfma_f32_16x16x32_bf16 v[44:47], a[36:39], v[128:131], v[44:47]
  v_mfma_f32_16x16x32_bf16 v[48:51], a[36:39], v[132:135], v[48:51]
  v_mfma_f32_16x16x32_bf16 v[52:55], a[36:39], v[136:139], v[52:55]
  v_mfma_f32_16x16x32_bf16 v[56:59], a[36:39], v[140:143], v[56:59]
  v_mfma_f32_16x16x32_bf16 v[60:63], a[36:39], v[144:147], v[60:63]
  v_mfma_f32_16x16x32_bf16 v[64:67], a[40:43], v[120:123], v[64:67]
  v_mfma_f32_16x16x32_bf16 v[68:71], a[40:43], v[124:127], v[68:71]
  v_mfma_f32_16x16x32_bf16 v[72:75], a[40:43], v[128:131], v[72:75]
  v_mfma_f32_16x16x32_bf16 v[76:79], a[40:43], v[132:135], v[76:79]
  v_mfma_f32_16x16x32_bf16 v[80:83], a[40:43], v[136:139], v[80:83]
  v_mfma_f32_16x16x32_bf16 v[84:87], a[40:43], v[140:143], v[84:87]
  v_mfma_f32_16x16x32_bf16 v[88:91], a[40:43], v[144:147], v[88:91]
  v_mfma_f32_16x16x32_bf16 v[92:95], a[44:47], v[120:123], v[92:95]
  v_mfma_f32_16x16x32_bf16 v[96:99], a[44:47], v[124:127], v[96:99]
  v_mfma_f32_16x16x32_bf16 v[100:103], a[44:47], v[128:131], v[100:103]
  v_mfma_f32_16x16x32_bf16 v[104:107], a[44:47], v[132:135], v[104:107]
  v_mfma_f32_16x16x32_bf16 v[108:111], a[44:47], v[136:139], v[108:111]
  v_mfma_f32_16x16x32_bf16 v[112:115], a[44:47], v[140:143], v[112:115]
  v_mfma_f32_16x16x32_bf16 v[116:119], a[44:47], v[144:147], v[116:119]
  s_waitcnt lgkmcnt(0)
  v_mfma_f32_16x16x32_bf16 v[8:11], a[48:51], v[148:151], v[8:11]
  v_mfma_f32_16x16x32_bf16 v[12:15], a[48:51], v[152:155], v[12:15]
  v_mfma_f32_16x16x32_bf16 v[16:19], a[48:51], v[156:159], v[16:19]
  v_mfma_f32_16x16x32_bf16 v[20:23], a[48:51], v[160:163], v[20:23]
  v_mfma_f32_16x16x32_bf16 v[24:27], a[48:51], v[164:167], v[24:27]
  v_mfma_f32_16x16x32_bf16 v[28:31], a[48:51], v[168:171], v[28:31]
  v_mfma_f32_16x16x32_bf16 v[32:35], a[48:51], v[172:175], v[32:35]
  v_mfma_f32_16x16x32_bf16 v[36:39], a[52:55], v[148:151], v[36:39]
  v_mfma_f32_16x16x32_bf16 v[40:43], a[52:55], v[152:155], v[40:43]
  v_mfma_f32_16x16x32_bf16 v[44:47], a[52:55], v[156:159], v[44:47]
  v_mfma_f32_16x16x32_bf16 v[48:51], a[52:55], v[160:163], v[48:51]
  v_mfma_f32_16x16x32_bf16 v[52:55], a[52:55], v[164:167], v[52:55]
  v_mfma_f32_16x16x32_bf16 v[56:59], a[52:55], v[168:171], v[56:59]
  v_mfma_f32_16x16x32_bf16 v[60:63], a[52:55], v[172:175], v[60:63]
  v_mfma_f32_16x16x32_bf16 v[64:67], a[56:59], v[148:151], v[64:67]
  v_mfma_f32_16x16x32_bf16 v[68:71], a[56:59], v[152:155], v[68:71]
  v_mfma_f32_16x16x32_bf16 v[72:75], a[56:59], v[156:159], v[72:75]
  v_mfma_f32_16x16x32_bf16 v[76:79], a[56:59], v[160:163], v[76:79]
  v_mfma_f32_16x16x32_bf16 v[80:83], a[56:59], v[164:167], v[80:83]
  v_mfma_f32_16x16x32_bf16 v[84:87], a[56:59], v[168:171], v[84:87]
  v_mfma_f32_16x16x32_bf16 v[88:91], a[56:59], v[172:175], v[88:91]
  v_mfma_f32_16x16x32_bf16 v[92:95], a[60:63], v[148:151], v[92:95]
  v_mfma_f32_16x16x32_bf16 v[96:99], a[60:63], v[152:155], v[96:99]
  v_mfma_f32_16x16x32_bf16 v[100:103], a[60:63], v[156:159], v[100:103]
  v_mfma_f32_16x16x32_bf16 v[104:107], a[60:63], v[160:163], v[104:107]
  v_mfma_f32_16x16x32_bf16 v[108:111], a[60:63], v[164:167], v[108:111]
  v_mfma_f32_16x16x32_bf16 v[112:115], a[60:63], v[168:171], v[112:115]
  v_mfma_f32_16x16x32_bf16 v[116:119], a[60:63], v[172:175], v[116:119]
  s_waitcnt vmcnt(0)
  s_barrier
  s_cmp_eq_u32 s73, 3
  s_cbranch_scc1 nr_18
  ds_read_b128 a[64:67], v188 offset:4096
  ds_read_b128 a[68:71], v188 offset:12288
  ds_read_b128 a[72:75], v188 offset:20480
  ds_read_b128 a[76:79], v188 offset:28672
  ds_read_b128 a[80:83], v189 offset:4096
  ds_read_b128 a[84:87], v189 offset:12288
  ds_read_b128 a[88:91], v189 offset:20480
  ds_read_b128 a[92:95], v189 offset:28672
  s_waitcnt lgkmcnt(4)
  ds_read_b128 a[96:99], v190 offset:4096
  ds_read_b128 a[100:103], v190 offset:12288
  ds_read_b128 a[104:107], v190 offset:20480
  ds_read_b128 a[108:111], v190 offset:28672
  ds_read_b128 a[112:115], v191 offset:4096
  ds_read_b128 a[116:119], v191 offset:12288
  ds_read_b128 a[120:123], v191 offset:20480
  ds_read_b128 a[124:127], v191 offset:28672
  s_waitcnt lgkmcnt(4)
nr_18:
  ds_read_b128 v[120:123], v184 offset:4096
  ds_read_b128 v[124:127], v184 offset:12288
  ds_read_b128 v[128:131], v184 offset:20480
  ds_read_b128 v[132:135], v184 offset:28672
  ds_read_b128 v[136:139], v184 offset:36864
  ds_read_b128 v[140:143], v184 offset:45056
  ds_read_b128 v[144:147], v184 offset:53248
  s_waitcnt lgkmcnt(0)
  ds_read_b128 v[148:151], v185 offset:4096
  ds_read_b128 v[152:155], v185 offset:12288
  ds_read_b128 v[156:159], v185 offset:20480
  ds_read_b128 v[160:163], v185 offset:28672
  ds_read_b128 v[164:167], v185 offset:36864
  ds_read_b128 v[168:171], v185 offset:45056
  ds_read_b128 v[172:175], v185 offset:53248
  v_mfma_f32_16x16x32_bf16 v[8:11], a[64:67], v[120:123], v[8:11]
  v_mfma_f32_16x16x32_bf16 v[12:15], a[64:67], v[124:127], v[12:15]
  v_mfma_f32_16x16x32_bf16 v[16:19], a[64:67], v[128:131], v[16:19]
  v_mfma_f32_16x16x32_bf16 v[20:23], a[64:67], v[132:135], v[20:23]
  v_mfma_f32_16x16x32_bf16 v[24:27], a[64:67], v[136:139], v[24:27]
  v_mfma_f32_16x16x32_bf16 v[28:31], a[64:67], v[140:143], v[28:31]
  v_mfma_f32_16x16x32_bf16 v[32:35], a[64:67], v[144:147], v[32:35]
  v_mfma_f32_16x16x32_bf16 v[36:39], a[68:71], v[120:123], v[36:39]
  v_mfma_f32_16x16x32_bf16 v[40:43], a[68:71], v[124:127], v[40:43]
  v_mfma_f32_16x16x32_bf16 v[44:47], a[68:71], v[128:131], v[44:47]
  v_mfma_f32_16x16x32_bf16 v[48:51], a[68:71], v[132:135], v[48:51]
  v_mfma_f32_16x16x32_bf16 v[52:55], a[68:71], v[136:139], v[52:55]
  v_mfma_f32_16x16x32_bf16 v[56:59], a[68:71], v[140:143], v[56:59]
  v_mfma_f32_16x16x32_bf16 v[60:63], a[68:71], v[144:147], v[60:63]
  v_mfma_f32_16x16x32_bf16 v[64:67], a[72:75], v[120:123], v[64:67]
  v_mfma_f32_16x16x32_bf16 v[68:71], a[72:75], v[124:127], v[68:71]
  v_mfma_f32_16x16x32_bf16 v[72:75], a[72:75], v[128:131], v[72:75]
  v_mfma_f32_16x16x32_bf16 v[76:79], a[72:75], v[132:135], v[76:79]
  v_mfma_f32_16x16x32_bf16 v[80:83], a[72:75], v[136:139], v[80:83]
  v_mfma_f32_16x16x32_bf16 v[84:87], a[72:75], v[140:143], v[84:87]
  v_mfma_f32_16x16x32_bf16 v[88:91], a[72:75], v[144:147], v[88:91]
  v_mfma_f32_16x16x32_bf16 v[92:95], a[76:79], v[120:123], v[92:95]
  v_mfma_f32_16x16x32_bf16 v[96:99], a[76:79], v[124:127], v[96:99]
  v_mfma_f32_16x16x32_bf16 v[100:103], a[76:79], v[128:131], v[100:103]
  v_mfma_f32_16x16x32_bf16 v[104:107], a[76:79], v[132:135], v[104:107]
  v_mfma_f32_16x16x32_bf16 v[108:111], a[76:79], v[136:139], v[108:111]
  v_mfma_f32_16x16x32_bf16 v[112:115], a[76:79], v[140:143], v[112:115]
  v_mfma_f32_16x16x32_bf16 v[116:119], a[76:79], v[144:147], v[116:119]
  s_waitcnt lgkmcnt(0)
  ds_read_b128 v[120:123], v186 offset:4096
  ds_read_b128 v[124:127], v186 offset:12288
  ds_read_b128 v[128:131], v186 offset:20480
  ds_read_b128 v[132:135], v186 offset:28672
  ds_read_b128 v[136:139], v186 offset:36864
  ds_read_b128 v[140:143], v186 offset:45056
  ds_read_b128 v[144:147], v186 offset:53248
  v_mfma_f32_16x16x32_bf16 v[8:11], a[80:83], v[148:151], v[8:11]
  v_mfma_f32_16x16x32_bf16 v[12:15], a[80:83], v[152:155], v[12:15]
  v_mfma_f32_16x16x32_bf16 v[16:19], a[80:83], v[156:159], v[16:19]
  v_mfma_f32_16x16x32_bf16 v[20:23], a[80:83], v[160:163], v[20:23]
  v_mfma_f32_16x16x32_bf16 v[24:27], a[80:83], v[164:167], v[24:27]
  v_mfma_f32_16x16x32_bf16 v[28:31], a[80:83], v[168:171], v[28:31]
  v_mfma_f32_16x16x32_bf16 v[32:35], a[80:83], v[172:175], v[32:35]
  v_mfma_f32_16x16x32_bf16 v[36:39], a[84:87], v[148:151], v[36:39]
  v_mfma_f32_16x16x32_bf16 v[40:43], a[84:87], v[152:155], v[40:43]
  v_mfma_f32_16x16x32_bf16 v[44:47], a[84:87], v[156:159], v[44:47]
  v_mfma_f32_16x16x32_bf16 v[48:51], a[84:87], v[160:163], v[48:51]
  v_mfma_f32_16x16x32_bf16 v[52:55], a[84:87], v[164:167], v[52:55]
  v_mfma_f32_16x16x32_bf16 v[56:59], a[84:87], v[168:171], v[56:59]
  v_mfma_f32_16x16x32_bf16 v[60:63], a[84:87], v[172:175], v[60:63]
  v_mfma_f32_16x16x32_bf16 v[64:67], a[88:91], v[148:151], v[64:67]
  v_mfma_f32_16x16x32_bf16 v[68:71], a[88:91], v[152:155], v[68:71]
  v_mfma_f32_16x16x32_bf16 v[72:75], a[88:91], v[156:159], v[72:75]
  v_mfma_f32_16x16x32_bf16 v[76:79], a[88:91], v[160:163], v[76:79]
  v_mfma_f32_16x16x32_bf16 v[80:83], a[88:91], v[164:167], v[80:83]
  v_mfma_f32_16x16x32_bf16 v[84:87], a[88:91], v[168:171], v[84:87]
  v_mfma_f32_16x16x32_bf16 v[88:91], a[88:91], v[172:175], v[88:91]
  v_mfma_f32_16x16x32_bf16 v[92:95], a[92:95], v[148:151], v[92:95]
  v_mfma_f32_16x16x32_bf16 v[96:99], a[92:95], v[152:155], v[96:99]
  v_mfma_f32_16x16x32_bf16 v[100:103], a[92:95], v[156:159], v[100:103]
  v_mfma_f32_16x16x32_bf16 v[104:107], a[92:95], v[160:163], v[104:107]
  v_mfma_f32_16x16x32_bf16 v[108:111], a[92:95], v[164:167], v[108:111]
  v_mfma_f32_16x16x32_bf16 v[112:115], a[92:95], v[168:171], v[112:115]
  v_mfma_f32_16x16x32_bf16 v[116:119], a[92:95], v[172:175], v[116:119]
  s_waitcnt lgkmcnt(0)
  ds_read_b128 v[148:151], v187 offset:4096
  ds_read_b128 v[152:155], v187 offset:12288
  ds_read_b128 v[156:159], v187 offset:20480
  ds_read_b128 v[160:163], v187 offset:28672
  ds_read_b128 v[164:167], v187 offset:36864
  ds_read_b128 v[168:171], v187 offset:45056
  ds_read_b128 v[172:175], v187 offset:53248
  v_mfma_f32_16x16x32_bf16 v[8:11], a[96:99], v[120:123], v[8:11]
  v_mfma_f32_16x16x32_bf16 v[12:15], a[96:99], v[124:127], v[12:15]
  v_mfma_f32_16x16x32_bf16 v[16:19], a[96:99], v[128:131], v[16:19]
  v_mfma_f32_16x16x32_bf16 v[20:23], a[96:99], v[132:135], v[20:23]
  v_mfma_f32_16x16x32_bf16 v[24:27], a[96:99], v[136:139], v[24:27]
  v_mfma_f32_16x16x32_bf16 v[28:31], a[96:99], v[140:143], v[28:31]
  v_mfma_f32_16x16x32_bf16 v[32:35], a[96:99], v[144:147], v[32:35]
  v_mfma_f32_16x16x32_bf16 v[36:39], a[100:103], v[120:123], v[36:39]
  v_mfma_f32_16x16x32_bf16 v[40:43], a[100:103], v[124:127], v[40:43]
  v_mfma_f32_16x16x32_bf16 v[44:47], a[100:103], v[128:131], v[44:47]
  v_mfma_f32_16x16x32_bf16 v[48:51], a[100:103], v[132:135], v[48:51]
  v_mfma_f32_16x16x32_bf16 v[52:55], a[100:103], v[136:139], v[52:55]
  v_mfma_f32_16x16x32_bf16 v[56:59], a[100:103], v[140:143], v[56:59]
  v_mfma_f32_16x16x32_bf16 v[60:63], a[100:103], v[144:147], v[60:63]
  v_mfma_f32_16x16x32_bf16 v[64:67], a[104:107], v[120:123], v[64:67]
  v_mfma_f32_16x16x32_bf16 v[68:71], a[104:107], v[124:127], v[68:71]
  v_mfma_f32_16x16x32_bf16 v[72:75], a[104:107], v[128:131], v[72:75]
  v_mfma_f32_16x16x32_bf16 v[76:79], a[104:107], v[132:135], v[76:79]
  v_mfma_f32_16x16x32_bf16 v[80:83], a[104:107], v[136:139], v[80:83]
  v_mfma_f32_16x16x32_bf16 v[84:87], a[104:107], v[140:143], v[84:87]
  v_mfma_f32_16x16x32_bf16 v[88:91], a[104:107], v[144:147], v[88:91]
  v_mfma_f32_16x16x32_bf16 v[92:95], a[108:111], v[120:123], v[92:95]
  v_mfma_f32_16x16x32_bf16 v[96:99], a[108:111], v[124:127], v[96:99]
  v_mfma_f32_16x16x32_bf16 v[100:103], a[108:111], v[128:131], v[100:103]
  v_mfma_f32_16x16x32_bf16 v[104:107], a[108:111], v[132:135], v[104:107]
  v_mfma_f32_16x16x32_bf16 v[108:111], a[108:111], v[136:139], v[108:111]
  v_mfma_f32_16x16x32_bf16 v[112:115], a[108:111], v[140:143], v[112:115]
  v_mfma_f32_16x16x32_bf16 v[116:119], a[108:111], v[144:147], v[116:119]
  s_waitcnt lgkmcnt(0)
  v_mfma_f32_16x16x32_bf16 v[8:11], a[112:115], v[148:151], v[8:11]
  v_mfma_f32_16x16x32_bf16 v[12:15], a[112:115], v[152:155], v[12:15]
  v_mfma_f32_16x16x32_bf16 v[16:19], a[112:115], v[156:159], v[16:19]
  v_mfma_f32_16x16x32_bf16 v[20:23], a[112:115], v[160:163], v[20:23]
  v_mfma_f32_16x16x32_bf16 v[24:27], a[112:115], v[164:167], v[24:27]
  v_mfma_f32_16x16x32_bf16 v[28:31], a[112:115], v[168:171], v[28:31]
  v_mfma_f32_16x16x32_bf16 v[32:35], a[112:115], v[172:175], v[32:35]
  v_mfma_f32_16x16x32_bf16 v[36:39], a[116:119], v[148:151], v[36:39]
  v_mfma_f32_16x16x32_bf16 v[40:43], a[116:119], v[152:155], v[40:43]
  v_mfma_f32_16x16x32_bf16 v[44:47], a[116:119], v[156:159], v[44:47]
  v_mfma_f32_16x16x32_bf16 v[48:51], a[116:119], v[160:163], v[48:51]
  v_mfma_f32_16x16x32_bf16 v[52:55], a[116:119], v[164:167], v[52:55]
  v_mfma_f32_16x16x32_bf16 v[56:59], a[116:119], v[168:171], v[56:59]
  v_mfma_f32_16x16x32_bf16 v[60:63], a[116:119], v[172:175], v[60:63]
  v_mfma_f32_16x16x32_bf16 v[64:67], a[120:123], v[148:151], v[64:67]
  v_mfma_f32_16x16x32_bf16 v[68:71], a[120:123], v[152:155], v[68:71]
  v_mfma_f32_16x16x32_bf16 v[72:75], a[120:123], v[156:159], v[72:75]
  v_mfma_f32_16x16x32_bf16 v[76:79], a[120:123], v[160:163], v[76:79]
  v_mfma_f32_16x16x32_bf16 v[80:83], a[120:123], v[164:167], v[80:83]
  v_mfma_f32_16x16x32_bf16 v[84:87], a[120:123], v[168:171], v[84:87]
  v_mfma_f32_16x16x32_bf16 v[88:91], a[120:123], v[172:175], v[88:91]
  v_mfma_f32_16x16x32_bf16 v[92:95], a[124:127], v[148:151], v[92:95]
  v_mfma_f32_16x16x32_bf16 v[96:99], a[124:127], v[152:155], v[96:99]
  v_mfma_f32_16x16x32_bf16 v[100:103], a[124:127], v[156:159], v[100:103]
  v_mfma_f32_16x16x32_bf16 v[104:107], a[124:127], v[160:163], v[104:107]
  v_mfma_f32_16x16x32_bf16 v[108:111], a[124:127], v[164:167], v[108:111]
  v_mfma_f32_16x16x32_bf16 v[112:115], a[124:127], v[168:171], v[112:115]
  v_mfma_f32_16x16x32_bf16 v[116:119], a[124:127], v[172:175], v[116:119]
  s_mov_b32 s55, 0x3db8aa3b
  v_mul_f32 v8, s55, v8
  v_mul_f32 v36, s55, v36
  v_mul_f32 v9, s55, v9
  v_mul_f32 v37, s55, v37
  v_mul_f32 v10, s55, v10
  v_mul_f32 v38, s55, v38
  v_mul_f32 v11, s55, v11
  v_mul_f32 v39, s55, v39
  v_cvt_pk_bf16_f32 v8, v8, v9
  v_cvt_pk_bf16_f32 v9, v10, v11
  v_cvt_pk_bf16_f32 v10, v36, v37
  v_cvt_pk_bf16_f32 v11, v38, v39
  s_mul_i32 s53, s71, 7
  s_add_u32 s53, s53, 0
  s_mul_i32 s54, s70, 28
  s_add_u32 s53, s53, s54
  s_mul_i32 s53, s53, 14
  s_add_u32 s53, s53, s74
  s_add_u32 s53, s53, 0
  s_lshl_b32 s53, s53, 10
  buffer_store_dwordx4 v[8:11], v3, s[32:35], s53 offen
  v_mul_f32 v12, s55, v12
  v_mul_f32 v40, s55, v40
  v_mul_f32 v13, s55, v13
  v_mul_f32 v41, s55, v41
  v_mul_f32 v14, s55, v14
  v_mul_f32 v42, s55, v42
  v_mul_f32 v15, s55, v15
  v_mul_f32 v43, s55, v43
  v_cvt_pk_bf16_f32 v12, v12, v13
  v_cvt_pk_bf16_f32 v13, v14, v15
  v_cvt_pk_bf16_f32 v14, v40, v41
  v_cvt_pk_bf16_f32 v15, v42, v43
  s_mul_i32 s53, s71, 7
  s_add_u32 s53, s53, 1
  s_mul_i32 s54, s70, 28
  s_add_u32 s53, s53, s54
  s_mul_i32 s53, s53, 14
  s_add_u32 s53, s53, s74
  s_add_u32 s53, s53, 0
  s_lshl_b32 s53, s53, 10
  buffer_store_dwordx4 v[12:15], v3, s[32:35], s53 offen
  v_mul_f32 v16, s55, v16
  v_mul_f32 v44, s55, v44
  v_mul_f32 v17, s55, v17
  v_mul_f32 v45, s55, v45
  v_mul_f32 v18, s55, v18
  v_mul_f32 v46, s55, v46
  v_mul_f32 v19, s55, v19
  v_mul_f32 v47, s55, v47
  v_cvt_pk_bf16_f32 v16, v16, v17
  v_cvt_pk_bf16_f32 v17, v18, v19
  v_cvt_pk_bf16_f32 v18, v44, v45
  v_cvt_pk_bf16_f32 v19, v46, v47
  s_mul_i32 s53, s71, 7
  s_add_u32 s53, s53, 2
  s_mul_i32 s54, s70, 28
  s_add_u32 s53, s53, s54
  s_mul_i32 s53, s53, 14
  s_add_u32 s53, s53, s74
  s_add_u32 s53, s53, 0
  s_lshl_b32 s53, s53, 10
  buffer_store_dwordx4 v[16:19], v3, s[32:35], s53 offen
  v_mul_f32 v20, s55, v20
  v_mul_f32 v48, s55, v48
  v_mul_f32 v21, s55, v21
  v_mul_f32 v49, s55, v49
  v_mul_f32 v22, s55, v22
  v_mul_f32 v50, s55, v50
  v_mul_f32 v23, s55, v23
  v_mul_f32 v51, s55, v51
  v_cvt_pk_bf16_f32 v20, v20, v21
  v_cvt_pk_bf16_f32 v21, v22, v23
  v_cvt_pk_bf16_f32 v22, v48, v49
  v_cvt_pk_bf16_f32 v23, v50, v51
  s_mul_i32 s53, s71, 7
  s_add_u32 s53, s53, 3
  s_mul_i32 s54, s70, 28
  s_add_u32 s53, s53, s54
  s_mul_i32 s53, s53, 14
  s_add_u32 s53, s53, s74
  s_add_u32 s53, s53, 0
  s_lshl_b32 s53, s53, 10
  buffer_store_dwordx4 v[20:23], v3, s[32:35], s53 offen
  v_mul_f32 v24, s55, v24
  v_mul_f32 v52, s55, v52
  v_mul_f32 v25, s55, v25
  v_mul_f32 v53, s55, v53
  v_mul_f32 v26, s55, v26
  v_mul_f32 v54, s55, v54
  v_mul_f32 v27, s55, v27
  v_mul_f32 v55, s55, v55
  v_cvt_pk_bf16_f32 v24, v24, v25
  v_cvt_pk_bf16_f32 v25, v26, v27
  v_cvt_pk_bf16_f32 v26, v52, v53
  v_cvt_pk_bf16_f32 v27, v54, v55
  s_mul_i32 s53, s71, 7
  s_add_u32 s53, s53, 4
  s_mul_i32 s54, s70, 28
  s_add_u32 s53, s53, s54
  s_mul_i32 s53, s53, 14
  s_add_u32 s53, s53, s74
  s_add_u32 s53, s53, 0
  s_lshl_b32 s53, s53, 10
  buffer_store_dwordx4 v[24:27], v3, s[32:35], s53 offen
  v_mul_f32 v28, s55, v28
  v_mul_f32 v56, s55, v56
  v_mul_f32 v29, s55, v29
  v_mul_f32 v57, s55, v57
  v_mul_f32 v30, s55, v30
  v_mul_f32 v58, s55, v58
  v_mul_f32 v31, s55, v31
  v_mul_f32 v59, s55, v59
  v_cvt_pk_bf16_f32 v28, v28, v29
  v_cvt_pk_bf16_f32 v29, v30, v31
  v_cvt_pk_bf16_f32 v30, v56, v57
  v_cvt_pk_bf16_f32 v31, v58, v59
  s_mul_i32 s53, s71, 7
  s_add_u32 s53, s53, 5
  s_mul_i32 s54, s70, 28
  s_add_u32 s53, s53, s54
  s_mul_i32 s53, s53, 14
  s_add_u32 s53, s53, s74
  s_add_u32 s53, s53, 0
  s_lshl_b32 s53, s53, 10
  buffer_store_dwordx4 v[28:31], v3, s[32:35], s53 offen
  v_mul_f32 v32, s55, v32
  v_mul_f32 v60, s55, v60
  v_mul_f32 v33, s55, v33
  v_mul_f32 v61, s55, v61
  v_mul_f32 v34, s55, v34
  v_mul_f32 v62, s55, v62
  v_mul_f32 v35, s55, v35
  v_mul_f32 v63, s55, v63
  v_cvt_pk_bf16_f32 v32, v32, v33
  v_cvt_pk_bf16_f32 v33, v34, v35
  v_cvt_pk_bf16_f32 v34, v60, v61
  v_cvt_pk_bf16_f32 v35, v62, v63
  s_mul_i32 s53, s71, 7
  s_add_u32 s53, s53, 6
  s_mul_i32 s54, s70, 28
  s_add_u32 s53, s53, s54
  s_mul_i32 s53, s53, 14
  s_add_u32 s53, s53, s74
  s_add_u32 s53, s53, 0
  s_lshl_b32 s53, s53, 10
  buffer_store_dwordx4 v[32:35], v3, s[32:35], s53 offen
  s_cmp_eq_u32 s73, 3
  s_cbranch_scc1 fin_20
  v_mul_f32 v64, s55, v64
  v_mul_f32 v92, s55, v92
  v_mul_f32 v65, s55, v65
  v_mul_f32 v93, s55, v93
  v_mul_f32 v66, s55, v66
  v_mul_f32 v94, s55, v94
  v_mul_f32 v67, s55, v67
  v_mul_f32 v95, s55, v95
  v_cvt_pk_bf16_f32 v64, v64, v65
  v_cvt_pk_bf16_f32 v65, v66, v67
  v_cvt_pk_bf16_f32 v66, v92, v93
  v_cvt_pk_bf16_f32 v67, v94, v95
  s_mul_i32 s53, s71, 7
  s_add_u32 s53, s53, 0
  s_mul_i32 s54, s70, 28
  s_add_u32 s53, s53, s54
  s_mul_i32 s53, s53, 14
  s_add_u32 s53, s53, s75
  s_add_u32 s53, s53, 0
  s_lshl_b32 s53, s53, 10
  buffer_store_dwordx4 v[64:67], v3, s[32:35], s53 offen
  v_mul_f32 v68, s55, v68
  v_mul_f32 v96, s55, v96
  v_mul_f32 v69, s55, v69
  v_mul_f32 v97, s55, v97
  v_mul_f32 v70, s55, v70
  v_mul_f32 v98, s55, v98
  v_mul_f32 v71, s55, v71
  v_mul_f32 v99, s55, v99
  v_cvt_pk_bf16_f32 v68, v68, v69
  v_cvt_pk_bf16_f32 v69, v70, v71
  v_cvt_pk_bf16_f32 v70, v96, v97
  v_cvt_pk_bf16_f32 v71, v98, v99
  s_mul_i32 s53, s71, 7
  s_add_u32 s53, s53, 1
  s_mul_i32 s54, s70, 28
  s_add_u32 s53, s53, s54
  s_mul_i32 s53, s53, 14
  s_add_u32 s53, s53, s75
  s_add_u32 s53, s53, 0
  s_lshl_b32 s53, s53, 10
  buffer_store_dwordx4 v[68:71], v3, s[32:35], s53 offen
  v_mul_f32 v72, s55, v72
  v_mul_f32 v100, s55, v100
  v_mul_f32 v73, s55, v73
  v_mul_f32 v101, s55, v101
  v_mul_f32 v74, s55, v74
  v_mul_f32 v102, s55, v102
  v_mul_f32 v75, s55, v75
  v_mul_f32 v103, s55, v103
  v_cvt_pk_bf16_f32 v72, v72, v73
  v_cvt_pk_bf16_f32 v73, v74, v75
  v_cvt_pk_bf16_f32 v74, v100, v101
  v_cvt_pk_bf16_f32 v75, v102, v103
  s_mul_i32 s53, s71, 7
  s_add_u32 s53, s53, 2
  s_mul_i32 s54, s70, 28
  s_add_u32 s53, s53, s54
  s_mul_i32 s53, s53, 14
  s_add_u32 s53, s53, s75
  s_add_u32 s53, s53, 0
  s_lshl_b32 s53, s53, 10
  buffer_store_dwordx4 v[72:75], v3, s[32:35], s53 offen
  v_mul_f32 v76, s55, v76
  v_mul_f32 v104, s55, v104
  v_mul_f32 v77, s55, v77
  v_mul_f32 v105, s55, v105
  v_mul_f32 v78, s55, v78
  v_mul_f32 v106, s55, v106
  v_mul_f32 v79, s55, v79
  v_mul_f32 v107, s55, v107
  v_cvt_pk_bf16_f32 v76, v76, v77
  v_cvt_pk_bf16_f32 v77, v78, v79
  v_cvt_pk_bf16_f32 v78, v104, v105
  v_cvt_pk_bf16_f32 v79, v106, v107
  s_mul_i32 s53, s71, 7
  s_add_u32 s53, s53, 3
  s_mul_i32 s54, s70, 28
  s_add_u32 s53, s53, s54
  s_mul_i32 s53, s53, 14
  s_add_u32 s53, s53, s75
  s_add_u32 s53, s53, 0
  s_lshl_b32 s53, s53, 10
  buffer_store_dwordx4 v[76:79], v3, s[32:35], s53 offen
  v_mul_f32 v80, s55, v80
  v_mul_f32 v108, s55, v108
  v_mul_f32 v81, s55, v81
  v_mul_f32 v109, s55, v109
  v_mul_f32 v82, s55, v82
  v_mul_f32 v110, s55, v110
  v_mul_f32 v83, s55, v83
  v_mul_f32 v111, s55, v111
  v_cvt_pk_bf16_f32 v80, v80, v81
  v_cvt_pk_bf16_f32 v81, v82, v83
  v_cvt_pk_bf16_f32 v82, v108, v109
  v_cvt_pk_bf16_f32 v83, v110, v111
  s_mul_i32 s53, s71, 7
  s_add_u32 s53, s53, 4
  s_mul_i32 s54, s70, 28
  s_add_u32 s53, s53, s54
  s_mul_i32 s53, s53, 14
  s_add_u32 s53, s53, s75
  s_add_u32 s53, s53, 0
  s_lshl_b32 s53, s53, 10
  buffer_store_dwordx4 v[80:83], v3, s[32:35], s53 offen
  v_mul_f32 v84, s55, v84
  v_mul_f32 v112, s55, v112
  v_mul_f32 v85, s55, v85
  v_mul_f32 v113, s55, v113
  v_mul_f32 v86, s55, v86
  v_mul_f32 v114, s55, v114
  v_mul_f32 v87, s55, v87
  v_mul_f32 v115, s55, v115
  v_cvt_pk_bf16_f32 v84, v84, v85
  v_cvt_pk_bf16_f32 v85, v86, v87
  v_cvt_pk_bf16_f32 v86, v112, v113
  v_cvt_pk_bf16_f32 v87, v114, v115
  s_mul_i32 s53, s71, 7
  s_add_u32 s53, s53, 5
  s_mul_i32 s54, s70, 28
  s_add_u32 s53, s53, s54
  s_mul_i32 s53, s53, 14
  s_add_u32 s53, s53, s75
  s_add_u32 s53, s53, 0
  s_lshl_b32 s53, s53, 10
  buffer_store_dwordx4 v[84:87], v3, s[32:35], s53 offen
  v_mul_f32 v88, s55, v88
  v_mul_f32 v116, s55, v116
  v_mul_f32 v89, s55, v89
  v_mul_f32 v117, s55, v117
  v_mul_f32 v90, s55, v90
  v_mul_f32 v118, s55, v118
  v_mul_f32 v91, s55, v91
  v_mul_f32 v119, s55, v119
  v_cvt_pk_bf16_f32 v88, v88, v89
  v_cvt_pk_bf16_f32 v89, v90, v91
  v_cvt_pk_bf16_f32 v90, v116, v117
  v_cvt_pk_bf16_f32 v91, v118, v119
  s_mul_i32 s53, s71, 7
  s_add_u32 s53, s53, 6
  s_mul_i32 s54, s70, 28
  s_add_u32 s53, s53, s54
  s_mul_i32 s53, s53, 14
  s_add_u32 s53, s53, s75
  s_add_u32 s53, s53, 0
  s_lshl_b32 s53, s53, 10
  buffer_store_dwordx4 v[88:91], v3, s[32:35], s53 offen
fin_20:
  s_endpgm
k0_rb:
  v_and_b32 v1, 63, v0
  v_lshlrev_b32 v3, 4, v1
  v_and_b32 v4, 15, v1
  v_lshrrev_b32 v5, 4, v1
  v_add_u32 v6, 0, v5
  v_xor_b32 v6, v6, v4
  v_lshlrev_b32 v6, 4, v6
  v_lshl_add_u32 v184, v4, 8, v6
  s_lshl_b32 s53, s73, 15
  s_add_u32 s53, s53, 65536
  v_add_u32 v188, s53, v184
  v_add_u32 v6, 4, v5
  v_xor_b32 v6, v6, v4
  v_lshlrev_b32 v6, 4, v6
  v_lshl_add_u32 v185, v4, 8, v6
  s_lshl_b32 s53, s73, 15
  s_add_u32 s53, s53, 65536
  v_add_u32 v189, s53, v185
  v_add_u32 v6, 8, v5
  v_xor_b32 v6, v6, v4
  v_lshlrev_b32 v6, 4, v6
  v_lshl_add_u32 v186, v4, 8, v6
  s_lshl_b32 s53, s73, 15
  s_add_u32 s53, s53, 65536
  v_add_u32 v190, s53, v186
  v_add_u32 v6, 12, v5
  v_xor_b32 v6, v6, v4
  v_lshlrev_b32 v6, 4, v6
  v_lshl_add_u32 v187, v4, 8, v6
  s_lshl_b32 s53, s73, 15
  s_add_u32 s53, s53, 65536
  v_add_u32 v191, s53, v187
  v_lshrrev_b32 v4, 4, v1
  v_lshlrev_b32 v4, 3, v4
  v_bfe_u32 v5, v1, 2, 2
  v_add_u32 v4, v4, v5
  v_lshlrev_b32 v4, 8, v4
  v_and_b32 v6, 3, v1
  v_lshl_add_u32 v6, v5, 2, v6
  s_and_b32 s53, s71, 1
  s_add_u32 s53, s53, 0
  s_lshr_b32 s54, s53, 1
  s_lshl_b32 s54, s54, 2
  s_and_b32 s53, s53, 1
  s_lshl_b32 s53, s53, 3
  v_add_u32 v7, s54, v6
  v_and_b32 v7, 15, v7
  v_lshl_add_u32 v7, v7, 4, v4
  v_add_u32 v176, s53, v7
  s_and_b32 s53, s71, 1
  s_add_u32 s53, s53, 1
  s_lshr_b32 s54, s53, 1
  s_lshl_b32 s54, s54, 2
  s_and_b32 s53, s53, 1
  s_lshl_b32 s53, s53, 3
  v_add_u32 v7, s54, v6
  v_and_b32 v7, 15, v7
  v_lshl_add_u32 v7, v7, 4, v4
  v_add_u32 v177, s53, v7
  s_and_b32 s53, s71, 1
  s_add_u32 s53, s53, 2
  s_lshr_b32 s54, s53, 1
  s_lshl_b32 s54, s54, 2
  s_and_b32 s53, s53, 1
  s_lshl_b32 s53, s53, 3
  v_add_u32 v7, s54, v6
  v_and_b32 v7, 15, v7
  v_lshl_add_u32 v7, v7, 4, v4
  v_add_u32 v178, s53, v7
  s_and_b32 s53, s71, 1
  s_add_u32 s53, s53, 3
  s_lshr_b32 s54, s53, 1
  s_lshl_b32 s54, s54, 2
  s_and_b32 s53, s53, 1
  s_lshl_b32 s53, s53, 3
  v_add_u32 v7, s54, v6
  v_and_b32 v7, 15, v7
  v_lshl_add_u32 v7, v7, 4, v4
  v_add_u32 v179, s53, v7
  s_and_b32 s53, s71, 1
  s_add_u32 s53, s53, 4
  s_lshr_b32 s54, s53, 1
  s_lshl_b32 s54, s54, 2
  s_and_b32 s53, s53, 1
  s_lshl_b32 s53, s53, 3
  v_add_u32 v7, s54, v6
  v_and_b32 v7, 15, v7
  v_lshl_add_u32 v7, v7, 4, v4
  v_add_u32 v180, s53, v7
  s_and_b32 s53, s71, 1
  s_add_u32 s53, s53, 5
  s_lshr_b32 s54, s53, 1
  s_lshl_b32 s54, s54, 2
  s_and_b32 s53, s53, 1
  s_lshl_b32 s53, s53, 3
  v_add_u32 v7, s54, v6
  v_and_b32 v7, 15, v7
  v_lshl_add_u32 v7, v7, 4, v4
  v_add_u32 v181, s53, v7
  s_and_b32 s53, s71, 1
  s_add_u32 s53, s53, 6
  s_lshr_b32 s54, s53, 1
  s_lshl_b32 s54, s54, 2
  s_and_b32 s53, s53, 1
  s_lshl_b32 s53, s53, 3
  v_add_u32 v7, s54, v6
  v_and_b32 v7, 15, v7
  v_lshl_add_u32 v7, v7, 4, v4
  v_add_u32 v182, s53, v7
  s_cmp_eq_u32 s73, 3
  s_cbranch_scc1 w3_22
  s_waitcnt vmcnt(24)
  s_branch w3_22_j
w3_22:
  s_waitcnt vmcnt(16)
w3_22_j:
  s_barrier
  s_cmp_eq_u32 s73, 3
  s_cbranch_scc1 nr_21
  ds_read_b128 a[0:3], v188 offset:0
  ds_read_b128 a[4:7], v188 offset:8192
  ds_read_b128 a[8:11], v188 offset:16384
  ds_read_b128 a[12:15], v188 offset:24576
  ds_read_b128 a[16:19], v189 offset:0
  ds_read_b128 a[20:23], v189 offset:8192
  ds_read_b128 a[24:27], v189 offset:16384
  ds_read_b128 a[28:31], v189 offset:24576
  s_waitcnt lgkmcnt(4)
  ds_read_b128 a[32:35], v190 offset:0
  ds_read_b128 a[36:39], v190 offset:8192
  ds_read_b128 a[40:43], v190 offset:16384
  ds_read_b128 a[44:47], v190 offset:24576
  ds_read_b128 a[48:51], v191 offset:0
  ds_read_b128 a[52:55], v191 offset:8192
  ds_read_b128 a[56:59], v191 offset:16384
  ds_read_b128 a[60:63], v191 offset:24576
  s_waitcnt lgkmcnt(4)
nr_21:
  ds_read_b64_tr_b16 v[120:121], v176 offset:0
  ds_read_b64_tr_b16 v[122:123], v176 offset:1024
  ds_read_b64_tr_b16 v[124:125], v177 offset:0
  ds_read_b64_tr_b16 v[126:127], v177 offset:1024
  ds_read_b64_tr_b16 v[128:129], v178 offset:0
  ds_read_b64_tr_b16 v[130:131], v178 offset:1024
  ds_read_b64_tr_b16 v[132:133], v179 offset:0
  ds_read_b64_tr_b16 v[134:135], v179 offset:1024
  ds_read_b64_tr_b16 v[136:137], v180 offset:0
  ds_read_b64_tr_b16 v[138:139], v180 offset:1024
  ds_read_b64_tr_b16 v[140:141], v181 offset:0
  ds_read_b64_tr_b16 v[142:143], v181 offset:1024
  ds_read_b64_tr_b16 v[144:145], v182 offset:0
  ds_read_b64_tr_b16 v[146:147], v182 offset:1024
  s_waitcnt lgkmcnt(0)
  ds_read_b64_tr_b16 v[148:149], v176 offset:8192
  ds_read_b64_tr_b16 v[150:151], v176 offset:9216
  ds_read_b64_tr_b16 v[152:153], v177 offset:8192
  ds_read_b64_tr_b16 v[154:155], v177 offset:9216
  ds_read_b64_tr_b16 v[156:157], v178 offset:8192
  ds_read_b64_tr_b16 v[158:159], v178 offset:9216
  ds_read_b64_tr_b16 v[160:161], v179 offset:8192
  ds_read_b64_tr_b16 v[162:163], v179 offset:9216
  ds_read_b64_tr_b16 v[164:165], v180 offset:8192
  ds_read_b64_tr_b16 v[166:167], v180 offset:9216
  ds_read_b64_tr_b16 v[168:169], v181 offset:8192
  ds_read_b64_tr_b16 v[170:171], v181 offset:9216
  ds_read_b64_tr_b16 v[172:173], v182 offset:8192
  ds_read_b64_tr_b16 v[174:175], v182 offset:9216
  v_mfma_f32_16x16x32_bf16 v[8:11], a[0:3], v[120:123], 0
  v_mfma_f32_16x16x32_bf16 v[12:15], a[0:3], v[124:127], 0
  v_mfma_f32_16x16x32_bf16 v[16:19], a[0:3], v[128:131], 0
  v_mfma_f32_16x16x32_bf16 v[20:23], a[0:3], v[132:135], 0
  v_mfma_f32_16x16x32_bf16 v[24:27], a[0:3], v[136:139], 0
  v_mfma_f32_16x16x32_bf16 v[28:31], a[0:3], v[140:143], 0
  v_mfma_f32_16x16x32_bf16 v[32:35], a[0:3], v[144:147], 0
  v_mfma_f32_16x16x32_bf16 v[36:39], a[4:7], v[120:123], 0
  v_mfma_f32_16x16x32_bf16 v[40:43], a[4:7], v[124:127], 0
  v_mfma_f32_16x16x32_bf16 v[44:47], a[4:7], v[128:131], 0
  v_mfma_f32_16x16x32_bf16 v[48:51], a[4:7], v[132:135], 0
  v_mfma_f32_16x16x32_bf16 v[52:55], a[4:7], v[136:139], 0
  v_mfma_f32_16x16x32_bf16 v[56:59], a[4:7], v[140:143], 0
  v_mfma_f32_16x16x32_bf16 v[60:63], a[4:7], v[144:147], 0
  v_mfma_f32_16x16x32_bf16 v[64:67], a[8:11], v[120:123], 0
  v_mfma_f32_16x16x32_bf16 v[68:71], a[8:11], v[124:127], 0
  v_mfma_f32_16x16x32_bf16 v[72:75], a[8:11], v[128:131], 0
  v_mfma_f32_16x16x32_bf16 v[76:79], a[8:11], v[132:135], 0
  v_mfma_f32_16x16x32_bf16 v[80:83], a[8:11], v[136:139], 0
  v_mfma_f32_16x16x32_bf16 v[84:87], a[8:11], v[140:143], 0
  v_mfma_f32_16x16x32_bf16 v[88:91], a[8:11], v[144:147], 0
  v_mfma_f32_16x16x32_bf16 v[92:95], a[12:15], v[120:123], 0
  v_mfma_f32_16x16x32_bf16 v[96:99], a[12:15], v[124:127], 0
  v_mfma_f32_16x16x32_bf16 v[100:103], a[12:15], v[128:131], 0
  v_mfma_f32_16x16x32_bf16 v[104:107], a[12:15], v[132:135], 0
  v_mfma_f32_16x16x32_bf16 v[108:111], a[12:15], v[136:139], 0
  v_mfma_f32_16x16x32_bf16 v[112:115], a[12:15], v[140:143], 0
  v_mfma_f32_16x16x32_bf16 v[116:119], a[12:15], v[144:147], 0
  s_waitcnt lgkmcnt(0)
  ds_read_b64_tr_b16 v[120:121], v176 offset:16384
  ds_read_b64_tr_b16 v[122:123], v176 offset:17408
  ds_read_b64_tr_b16 v[124:125], v177 offset:16384
  ds_read_b64_tr_b16 v[126:127], v177 offset:17408
  ds_read_b64_tr_b16 v[128:129], v178 offset:16384
  ds_read_b64_tr_b16 v[130:131], v178 offset:17408
  ds_read_b64_tr_b16 v[132:133], v179 offset:16384
  ds_read_b64_tr_b16 v[134:135], v179 offset:17408
  ds_read_b64_tr_b16 v[136:137], v180 offset:16384
  ds_read_b64_tr_b16 v[138:139], v180 offset:17408
  ds_read_b64_tr_b16 v[140:141], v181 offset:16384
  ds_read_b64_tr_b16 v[142:143], v181 offset:17408
  ds_read_b64_tr_b16 v[144:145], v182 offset:16384
  ds_read_b64_tr_b16 v[146:147], v182 offset:17408
  v_mfma_f32_16x16x32_bf16 v[8:11], a[16:19], v[148:151], v[8:11]
  v_mfma_f32_16x16x32_bf16 v[12:15], a[16:19], v[152:155], v[12:15]
  v_mfma_f32_16x16x32_bf16 v[16:19], a[16:19], v[156:159], v[16:19]
  v_mfma_f32_16x16x32_bf16 v[20:23], a[16:19], v[160:163], v[20:23]
  v_mfma_f32_16x16x32_bf16 v[24:27], a[16:19], v[164:167], v[24:27]
  v_mfma_f32_16x16x32_bf16 v[28:31], a[16:19], v[168:171], v[28:31]
  v_mfma_f32_16x16x32_bf16 v[32:35], a[16:19], v[172:175], v[32:35]
  v_mfma_f32_16x16x32_bf16 v[36:39], a[20:23], v[148:151], v[36:39]
  v_mfma_f32_16x16x32_bf16 v[40:43], a[20:23], v[152:155], v[40:43]
  v_mfma_f32_16x16x32_bf16 v[44:47], a[20:23], v[156:159], v[44:47]
  v_mfma_f32_16x16x32_bf16 v[48:51], a[20:23], v[160:163], v[48:51]
  v_mfma_f32_16x16x32_bf16 v[52:55], a[20:23], v[164:167], v[52:55]
  v_mfma_f32_16x16x32_bf16 v[56:59], a[20:23], v[168:171], v[56:59]
  v_mfma_f32_16x16x32_bf16 v[60:63], a[20:23], v[172:175], v[60:63]
  v_mfma_f32_16x16x32_bf16 v[64:67], a[24:27], v[148:151], v[64:67]
  v_mfma_f32_16x16x32_bf16 v[68:71], a[24:27], v[152:155], v[68:71]
  v_mfma_f32_16x16x32_bf16 v[72:75], a[24:27], v[156:159], v[72:75]
  v_mfma_f32_16x16x32_bf16 v[76:79], a[24:27], v[160:163], v[76:79]
  v_mfma_f32_16x16x32_bf16 v[80:83], a[24:27], v[164:167], v[80:83]
  v_mfma_f32_16x16x32_bf16 v[84:87], a[24:27], v[168:171], v[84:87]
  v_mfma_f32_16x16x32_bf16 v[88:91], a[24:27], v[172:175], v[88:91]
  v_mfma_f32_16x16x32_bf16 v[92:95], a[28:31], v[148:151], v[92:95]
  v_mfma_f32_16x16x32_bf16 v[96:99], a[28:31], v[152:155], v[96:99]
  v_mfma_f32_16x16x32_bf16 v[100:103], a[28:31], v[156:159], v[100:103]
  v_mfma_f32_16x16x32_bf16 v[104:107], a[28:31], v[160:163], v[104:107]
  v_mfma_f32_16x16x32_bf16 v[108:111], a[28:31], v[164:167], v[108:111]
  v_mfma_f32_16x16x32_bf16 v[112:115], a[28:31], v[168:171], v[112:115]
  v_mfma_f32_16x16x32_bf16 v[116:119], a[28:31], v[172:175], v[116:119]
  s_waitcnt lgkmcnt(0)
  ds_read_b64_tr_b16 v[148:149], v176 offset:24576
  ds_read_b64_tr_b16 v[150:151], v176 offset:25600
  ds_read_b64_tr_b16 v[152:153], v177 offset:24576
  ds_read_b64_tr_b16 v[154:155], v177 offset:25600
  ds_read_b64_tr_b16 v[156:157], v178 offset:24576
  ds_read_b64_tr_b16 v[158:159], v178 offset:25600
  ds_read_b64_tr_b16 v[160:161], v179 offset:24576
  ds_read_b64_tr_b16 v[162:163], v179 offset:25600
  ds_read_b64_tr_b16 v[164:165], v180 offset:24576
  ds_read_b64_tr_b16 v[166:167], v180 offset:25600
  ds_read_b64_tr_b16 v[168:169], v181 offset:24576
  ds_read_b64_tr_b16 v[170:171], v181 offset:25600
  ds_read_b64_tr_b16 v[172:173], v182 offset:24576
  ds_read_b64_tr_b16 v[174:175], v182 offset:25600
  v_mfma_f32_16x16x32_bf16 v[8:11], a[32:35], v[120:123], v[8:11]
  v_mfma_f32_16x16x32_bf16 v[12:15], a[32:35], v[124:127], v[12:15]
  v_mfma_f32_16x16x32_bf16 v[16:19], a[32:35], v[128:131], v[16:19]
  v_mfma_f32_16x16x32_bf16 v[20:23], a[32:35], v[132:135], v[20:23]
  v_mfma_f32_16x16x32_bf16 v[24:27], a[32:35], v[136:139], v[24:27]
  v_mfma_f32_16x16x32_bf16 v[28:31], a[32:35], v[140:143], v[28:31]
  v_mfma_f32_16x16x32_bf16 v[32:35], a[32:35], v[144:147], v[32:35]
  v_mfma_f32_16x16x32_bf16 v[36:39], a[36:39], v[120:123], v[36:39]
  v_mfma_f32_16x16x32_bf16 v[40:43], a[36:39], v[124:127], v[40:43]
  v_mfma_f32_16x16x32_bf16 v[44:47], a[36:39], v[128:131], v[44:47]
  v_mfma_f32_16x16x32_bf16 v[48:51], a[36:39], v[132:135], v[48:51]
  v_mfma_f32_16x16x32_bf16 v[52:55], a[36:39], v[136:139], v[52:55]
  v_mfma_f32_16x16x32_bf16 v[56:59], a[36:39], v[140:143], v[56:59]
  v_mfma_f32_16x16x32_bf16 v[60:63], a[36:39], v[144:147], v[60:63]
  v_mfma_f32_16x16x32_bf16 v[64:67], a[40:43], v[120:123], v[64:67]
  v_mfma_f32_16x16x32_bf16 v[68:71], a[40:43], v[124:127], v[68:71]
  v_mfma_f32_16x16x32_bf16 v[72:75], a[40:43], v[128:131], v[72:75]
  v_mfma_f32_16x16x32_bf16 v[76:79], a[40:43], v[132:135], v[76:79]
  v_mfma_f32_16x16x32_bf16 v[80:83], a[40:43], v[136:139], v[80:83]
  v_mfma_f32_16x16x32_bf16 v[84:87], a[40:43], v[140:143], v[84:87]
  v_mfma_f32_16x16x32_bf16 v[88:91], a[40:43], v[144:147], v[88:91]
  v_mfma_f32_16x16x32_bf16 v[92:95], a[44:47], v[120:123], v[92:95]
  v_mfma_f32_16x16x32_bf16 v[96:99], a[44:47], v[124:127], v[96:99]
  v_mfma_f32_16x16x32_bf16 v[100:103], a[44:47], v[128:131], v[100:103]
  v_mfma_f32_16x16x32_bf16 v[104:107], a[44:47], v[132:135], v[104:107]
  v_mfma_f32_16x16x32_bf16 v[108:111], a[44:47], v[136:139], v[108:111]
  v_mfma_f32_16x16x32_bf16 v[112:115], a[44:47], v[140:143], v[112:115]
  v_mfma_f32_16x16x32_bf16 v[116:119], a[44:47], v[144:147], v[116:119]
  s_waitcnt lgkmcnt(0)
  v_mfma_f32_16x16x32_bf16 v[8:11], a[48:51], v[148:151], v[8:11]
  v_mfma_f32_16x16x32_bf16 v[12:15], a[48:51], v[152:155], v[12:15]
  v_mfma_f32_16x16x32_bf16 v[16:19], a[48:51], v[156:159], v[16:19]
  v_mfma_f32_16x16x32_bf16 v[20:23], a[48:51], v[160:163], v[20:23]
  v_mfma_f32_16x16x32_bf16 v[24:27], a[48:51], v[164:167], v[24:27]
  v_mfma_f32_16x16x32_bf16 v[28:31], a[48:51], v[168:171], v[28:31]
  v_mfma_f32_16x16x32_bf16 v[32:35], a[48:51], v[172:175], v[32:35]
  v_mfma_f32_16x16x32_bf16 v[36:39], a[52:55], v[148:151], v[36:39]
  v_mfma_f32_16x16x32_bf16 v[40:43], a[52:55], v[152:155], v[40:43]
  v_mfma_f32_16x16x32_bf16 v[44:47], a[52:55], v[156:159], v[44:47]
  v_mfma_f32_16x16x32_bf16 v[48:51], a[52:55], v[160:163], v[48:51]
  v_mfma_f32_16x16x32_bf16 v[52:55], a[52:55], v[164:167], v[52:55]
  v_mfma_f32_16x16x32_bf16 v[56:59], a[52:55], v[168:171], v[56:59]
  v_mfma_f32_16x16x32_bf16 v[60:63], a[52:55], v[172:175], v[60:63]
  v_mfma_f32_16x16x32_bf16 v[64:67], a[56:59], v[148:151], v[64:67]
  v_mfma_f32_16x16x32_bf16 v[68:71], a[56:59], v[152:155], v[68:71]
  v_mfma_f32_16x16x32_bf16 v[72:75], a[56:59], v[156:159], v[72:75]
  v_mfma_f32_16x16x32_bf16 v[76:79], a[56:59], v[160:163], v[76:79]
  v_mfma_f32_16x16x32_bf16 v[80:83], a[56:59], v[164:167], v[80:83]
  v_mfma_f32_16x16x32_bf16 v[84:87], a[56:59], v[168:171], v[84:87]
  v_mfma_f32_16x16x32_bf16 v[88:91], a[56:59], v[172:175], v[88:91]
  v_mfma_f32_16x16x32_bf16 v[92:95], a[60:63], v[148:151], v[92:95]
  v_mfma_f32_16x16x32_bf16 v[96:99], a[60:63], v[152:155], v[96:99]
  v_mfma_f32_16x16x32_bf16 v[100:103], a[60:63], v[156:159], v[100:103]
  v_mfma_f32_16x16x32_bf16 v[104:107], a[60:63], v[160:163], v[104:107]
  v_mfma_f32_16x16x32_bf16 v[108:111], a[60:63], v[164:167], v[108:111]
  v_mfma_f32_16x16x32_bf16 v[112:115], a[60:63], v[168:171], v[112:115]
  v_mfma_f32_16x16x32_bf16 v[116:119], a[60:63], v[172:175], v[116:119]
  s_waitcnt vmcnt(0)
  s_barrier
  s_cmp_eq_u32 s73, 3
  s_cbranch_scc1 nr_23
  ds_read_b128 a[64:67], v188 offset:4096
  ds_read_b128 a[68:71], v188 offset:12288
  ds_read_b128 a[72:75], v188 offset:20480
  ds_read_b128 a[76:79], v188 offset:28672
  ds_read_b128 a[80:83], v189 offset:4096
  ds_read_b128 a[84:87], v189 offset:12288
  ds_read_b128 a[88:91], v189 offset:20480
  ds_read_b128 a[92:95], v189 offset:28672
  s_waitcnt lgkmcnt(4)
  ds_read_b128 a[96:99], v190 offset:4096
  ds_read_b128 a[100:103], v190 offset:12288
  ds_read_b128 a[104:107], v190 offset:20480
  ds_read_b128 a[108:111], v190 offset:28672
  ds_read_b128 a[112:115], v191 offset:4096
  ds_read_b128 a[116:119], v191 offset:12288
  ds_read_b128 a[120:123], v191 offset:20480
  ds_read_b128 a[124:127], v191 offset:28672
  s_waitcnt lgkmcnt(4)
nr_23:
  ds_read_b64_tr_b16 v[120:121], v176 offset:32768
  ds_read_b64_tr_b16 v[122:123], v176 offset:33792
  ds_read_b64_tr_b16 v[124:125], v177 offset:32768
  ds_read_b64_tr_b16 v[126:127], v177 offset:33792
  ds_read_b64_tr_b16 v[128:129], v178 offset:32768
  ds_read_b64_tr_b16 v[130:131], v178 offset:33792
  ds_read_b64_tr_b16 v[132:133], v179 offset:32768
  ds_read_b64_tr_b16 v[134:135], v179 offset:33792
  ds_read_b64_tr_b16 v[136:137], v180 offset:32768
  ds_read_b64_tr_b16 v[138:139], v180 offset:33792
  ds_read_b64_tr_b16 v[140:141], v181 offset:32768
  ds_read_b64_tr_b16 v[142:143], v181 offset:33792
  ds_read_b64_tr_b16 v[144:145], v182 offset:32768
  ds_read_b64_tr_b16 v[146:147], v182 offset:33792
  s_waitcnt lgkmcnt(0)
  ds_read_b64_tr_b16 v[148:149], v176 offset:40960
  ds_read_b64_tr_b16 v[150:151], v176 offset:41984
  ds_read_b64_tr_b16 v[152:153], v177 offset:40960
  ds_read_b64_tr_b16 v[154:155], v177 offset:41984
  ds_read_b64_tr_b16 v[156:157], v178 offset:40960
  ds_read_b64_tr_b16 v[158:159], v178 offset:41984
  ds_read_b64_tr_b16 v[160:161], v179 offset:40960
  ds_read_b64_tr_b16 v[162:163], v179 offset:41984
  ds_read_b64_tr_b16 v[164:165], v180 offset:40960
  ds_read_b64_tr_b16 v[166:167], v180 offset:41984
  ds_read_b64_tr_b16 v[168:169], v181 offset:40960
  ds_read_b64_tr_b16 v[170:171], v181 offset:41984
  ds_read_b64_tr_b16 v[172:173], v182 offset:40960
  ds_read_b64_tr_b16 v[174:175], v182 offset:41984
  v_mfma_f32_16x16x32_bf16 v[8:11], a[64:67], v[120:123], v[8:11]
  v_mfma_f32_16x16x32_bf16 v[12:15], a[64:67], v[124:127], v[12:15]
  v_mfma_f32_16x16x32_bf16 v[16:19], a[64:67], v[128:131], v[16:19]
  v_mfma_f32_16x16x32_bf16 v[20:23], a[64:67], v[132:135], v[20:23]
  v_mfma_f32_16x16x32_bf16 v[24:27], a[64:67], v[136:139], v[24:27]
  v_mfma_f32_16x16x32_bf16 v[28:31], a[64:67], v[140:143], v[28:31]
  v_mfma_f32_16x16x32_bf16 v[32:35], a[64:67], v[144:147], v[32:35]
  v_mfma_f32_16x16x32_bf16 v[36:39], a[68:71], v[120:123], v[36:39]
  v_mfma_f32_16x16x32_bf16 v[40:43], a[68:71], v[124:127], v[40:43]
  v_mfma_f32_16x16x32_bf16 v[44:47], a[68:71], v[128:131], v[44:47]
  v_mfma_f32_16x16x32_bf16 v[48:51], a[68:71], v[132:135], v[48:51]
  v_mfma_f32_16x16x32_bf16 v[52:55], a[68:71], v[136:139], v[52:55]
  v_mfma_f32_16x16x32_bf16 v[56:59], a[68:71], v[140:143], v[56:59]
  v_mfma_f32_16x16x32_bf16 v[60:63], a[68:71], v[144:147], v[60:63]
  v_mfma_f32_16x16x32_bf16 v[64:67], a[72:75], v[120:123], v[64:67]
  v_mfma_f32_16x16x32_bf16 v[68:71], a[72:75], v[124:127], v[68:71]
  v_mfma_f32_16x16x32_bf16 v[72:75], a[72:75], v[128:131], v[72:75]
  v_mfma_f32_16x16x32_bf16 v[76:79], a[72:75], v[132:135], v[76:79]
  v_mfma_f32_16x16x32_bf16 v[80:83], a[72:75], v[136:139], v[80:83]
  v_mfma_f32_16x16x32_bf16 v[84:87], a[72:75], v[140:143], v[84:87]
  v_mfma_f32_16x16x32_bf16 v[88:91], a[72:75], v[144:147], v[88:91]
  v_mfma_f32_16x16x32_bf16 v[92:95], a[76:79], v[120:123], v[92:95]
  v_mfma_f32_16x16x32_bf16 v[96:99], a[76:79], v[124:127], v[96:99]
  v_mfma_f32_16x16x32_bf16 v[100:103], a[76:79], v[128:131], v[100:103]
  v_mfma_f32_16x16x32_bf16 v[104:107], a[76:79], v[132:135], v[104:107]
  v_mfma_f32_16x16x32_bf16 v[108:111], a[76:79], v[136:139], v[108:111]
  v_mfma_f32_16x16x32_bf16 v[112:115], a[76:79], v[140:143], v[112:115]
  v_mfma_f32_16x16x32_bf16 v[116:119], a[76:79], v[144:147], v[116:119]
  s_waitcnt lgkmcnt(0)
  ds_read_b64_tr_b16 v[120:121], v176 offset:49152
  ds_read_b64_tr_b16 v[122:123], v176 offset:50176
  ds_read_b64_tr_b16 v[124:125], v177 offset:49152
  ds_read_b64_tr_b16 v[126:127], v177 offset:50176
  ds_read_b64_tr_b16 v[128:129], v178 offset:49152
  ds_read_b64_tr_b16 v[130:131], v178 offset:50176
  ds_read_b64_tr_b16 v[132:133], v179 offset:49152
  ds_read_b64_tr_b16 v[134:135], v179 offset:50176
  ds_read_b64_tr_b16 v[136:137], v180 offset:49152
  ds_read_b64_tr_b16 v[138:139], v180 offset:50176
  ds_read_b64_tr_b16 v[140:141], v181 offset:49152
  ds_read_b64_tr_b16 v[142:143], v181 offset:50176
  ds_read_b64_tr_b16 v[144:145], v182 offset:49152
  ds_read_b64_tr_b16 v[146:147], v182 offset:50176
  v_mfma_f32_16x16x32_bf16 v[8:11], a[80:83], v[148:151], v[8:11]
  v_mfma_f32_16x16x32_bf16 v[12:15], a[80:83], v[152:155], v[12:15]
  v_mfma_f32_16x16x32_bf16 v[16:19], a[80:83], v[156:159], v[16:19]
  v_mfma_f32_16x16x32_bf16 v[20:23], a[80:83], v[160:163], v[20:23]
  v_mfma_f32_16x16x32_bf16 v[24:27], a[80:83], v[164:167], v[24:27]
  v_mfma_f32_16x16x32_bf16 v[28:31], a[80:83], v[168:171], v[28:31]
  v_mfma_f32_16x16x32_bf16 v[32:35], a[80:83], v[172:175], v[32:35]
  v_mfma_f32_16x16x32_bf16 v[36:39], a[84:87], v[148:151], v[36:39]
  v_mfma_f32_16x16x32_bf16 v[40:43], a[84:87], v[152:155], v[40:43]
  v_mfma_f32_16x16x32_bf16 v[44:47], a[84:87], v[156:159], v[44:47]
  v_mfma_f32_16x16x32_bf16 v[48:51], a[84:87], v[160:163], v[48:51]
  v_mfma_f32_16x16x32_bf16 v[52:55], a[84:87], v[164:167], v[52:55]
  v_mfma_f32_16x16x32_bf16 v[56:59], a[84:87], v[168:171], v[56:59]
  v_mfma_f32_16x16x32_bf16 v[60:63], a[84:87], v[172:175], v[60:63]
  v_mfma_f32_16x16x32_bf16 v[64:67], a[88:91], v[148:151], v[64:67]
  v_mfma_f32_16x16x32_bf16 v[68:71], a[88:91], v[152:155], v[68:71]
  v_mfma_f32_16x16x32_bf16 v[72:75], a[88:91], v[156:159], v[72:75]
  v_mfma_f32_16x16x32_bf16 v[76:79], a[88:91], v[160:163], v[76:79]
  v_mfma_f32_16x16x32_bf16 v[80:83], a[88:91], v[164:167], v[80:83]
  v_mfma_f32_16x16x32_bf16 v[84:87], a[88:91], v[168:171], v[84:87]
  v_mfma_f32_16x16x32_bf16 v[88:91], a[88:91], v[172:175], v[88:91]
  v_mfma_f32_16x16x32_bf16 v[92:95], a[92:95], v[148:151], v[92:95]
  v_mfma_f32_16x16x32_bf16 v[96:99], a[92:95], v[152:155], v[96:99]
  v_mfma_f32_16x16x32_bf16 v[100:103], a[92:95], v[156:159], v[100:103]
  v_mfma_f32_16x16x32_bf16 v[104:107], a[92:95], v[160:163], v[104:107]
  v_mfma_f32_16x16x32_bf16 v[108:111], a[92:95], v[164:167], v[108:111]
  v_mfma_f32_16x16x32_bf16 v[112:115], a[92:95], v[168:171], v[112:115]
  v_mfma_f32_16x16x32_bf16 v[116:119], a[92:95], v[172:175], v[116:119]
  s_waitcnt lgkmcnt(0)
  ds_read_b64_tr_b16 v[148:149], v176 offset:57344
  ds_read_b64_tr_b16 v[150:151], v176 offset:58368
  ds_read_b64_tr_b16 v[152:153], v177 offset:57344
  ds_read_b64_tr_b16 v[154:155], v177 offset:58368
  ds_read_b64_tr_b16 v[156:157], v178 offset:57344
  ds_read_b64_tr_b16 v[158:159], v178 offset:58368
  ds_read_b64_tr_b16 v[160:161], v179 offset:57344
  ds_read_b64_tr_b16 v[162:163], v179 offset:58368
  ds_read_b64_tr_b16 v[164:165], v180 offset:57344
  ds_read_b64_tr_b16 v[166:167], v180 offset:58368
  ds_read_b64_tr_b16 v[168:169], v181 offset:57344
  ds_read_b64_tr_b16 v[170:171], v181 offset:58368
  ds_read_b64_tr_b16 v[172:173], v182 offset:57344
  ds_read_b64_tr_b16 v[174:175], v182 offset:58368
  v_mfma_f32_16x16x32_bf16 v[8:11], a[96:99], v[120:123], v[8:11]
  v_mfma_f32_16x16x32_bf16 v[12:15], a[96:99], v[124:127], v[12:15]
  v_mfma_f32_16x16x32_bf16 v[16:19], a[96:99], v[128:131], v[16:19]
  v_mfma_f32_16x16x32_bf16 v[20:23], a[96:99], v[132:135], v[20:23]
  v_mfma_f32_16x16x32_bf16 v[24:27], a[96:99], v[136:139], v[24:27]
  v_mfma_f32_16x16x32_bf16 v[28:31], a[96:99], v[140:143], v[28:31]
  v_mfma_f32_16x16x32_bf16 v[32:35], a[96:99], v[144:147], v[32:35]
  v_mfma_f32_16x16x32_bf16 v[36:39], a[100:103], v[120:123], v[36:39]
  v_mfma_f32_16x16x32_bf16 v[40:43], a[100:103], v[124:127], v[40:43]
  v_mfma_f32_16x16x32_bf16 v[44:47], a[100:103], v[128:131], v[44:47]
  v_mfma_f32_16x16x32_bf16 v[48:51], a[100:103], v[132:135], v[48:51]
  v_mfma_f32_16x16x32_bf16 v[52:55], a[100:103], v[136:139], v[52:55]
  v_mfma_f32_16x16x32_bf16 v[56:59], a[100:103], v[140:143], v[56:59]
  v_mfma_f32_16x16x32_bf16 v[60:63], a[100:103], v[144:147], v[60:63]
  v_mfma_f32_16x16x32_bf16 v[64:67], a[104:107], v[120:123], v[64:67]
  v_mfma_f32_16x16x32_bf16 v[68:71], a[104:107], v[124:127], v[68:71]
  v_mfma_f32_16x16x32_bf16 v[72:75], a[104:107], v[128:131], v[72:75]
  v_mfma_f32_16x16x32_bf16 v[76:79], a[104:107], v[132:135], v[76:79]
  v_mfma_f32_16x16x32_bf16 v[80:83], a[104:107], v[136:139], v[80:83]
  v_mfma_f32_16x16x32_bf16 v[84:87], a[104:107], v[140:143], v[84:87]
  v_mfma_f32_16x16x32_bf16 v[88:91], a[104:107], v[144:147], v[88:91]
  v_mfma_f32_16x16x32_bf16 v[92:95], a[108:111], v[120:123], v[92:95]
  v_mfma_f32_16x16x32_bf16 v[96:99], a[108:111], v[124:127], v[96:99]
  v_mfma_f32_16x16x32_bf16 v[100:103], a[108:111], v[128:131], v[100:103]
  v_mfma_f32_16x16x32_bf16 v[104:107], a[108:111], v[132:135], v[104:107]
  v_mfma_f32_16x16x32_bf16 v[108:111], a[108:111], v[136:139], v[108:111]
  v_mfma_f32_16x16x32_bf16 v[112:115], a[108:111], v[140:143], v[112:115]
  v_mfma_f32_16x16x32_bf16 v[116:119], a[108:111], v[144:147], v[116:119]
  s_waitcnt lgkmcnt(0)
  v_mfma_f32_16x16x32_bf16 v[8:11], a[112:115], v[148:151], v[8:11]
  v_mfma_f32_16x16x32_bf16 v[12:15], a[112:115], v[152:155], v[12:15]
  v_mfma_f32_16x16x32_bf16 v[16:19], a[112:115], v[156:159], v[16:19]
  v_mfma_f32_16x16x32_bf16 v[20:23], a[112:115], v[160:163], v[20:23]
  v_mfma_f32_16x16x32_bf16 v[24:27], a[112:115], v[164:167], v[24:27]
  v_mfma_f32_16x16x32_bf16 v[28:31], a[112:115], v[168:171], v[28:31]
  v_mfma_f32_16x16x32_bf16 v[32:35], a[112:115], v[172:175], v[32:35]
  v_mfma_f32_16x16x32_bf16 v[36:39], a[116:119], v[148:151], v[36:39]
  v_mfma_f32_16x16x32_bf16 v[40:43], a[116:119], v[152:155], v[40:43]
  v_mfma_f32_16x16x32_bf16 v[44:47], a[116:119], v[156:159], v[44:47]
  v_mfma_f32_16x16x32_bf16 v[48:51], a[116:119], v[160:163], v[48:51]
  v_mfma_f32_16x16x32_bf16 v[52:55], a[116:119], v[164:167], v[52:55]
  v_mfma_f32_16x16x32_bf16 v[56:59], a[116:119], v[168:171], v[56:59]
  v_mfma_f32_16x16x32_bf16 v[60:63], a[116:119], v[172:175], v[60:63]
  v_mfma_f32_16x16x32_bf16 v[64:67], a[120:123], v[148:151], v[64:67]
  v_mfma_f32_16x16x32_bf16 v[68:71], a[120:123], v[152:155], v[68:71]
  v_mfma_f32_16x16x32_bf16 v[72:75], a[120:123], v[156:159], v[72:75]
  v_mfma_f32_16x16x32_bf16 v[76:79], a[120:123], v[160:163], v[76:79]
  v_mfma_f32_16x16x32_bf16 v[80:83], a[120:123], v[164:167], v[80:83]
  v_mfma_f32_16x16x32_bf16 v[84:87], a[120:123], v[168:171], v[84:87]
  v_mfma_f32_16x16x32_bf16 v[88:91], a[120:123], v[172:175], v[88:91]
  v_mfma_f32_16x16x32_bf16 v[92:95], a[124:127], v[148:151], v[92:95]
  v_mfma_f32_16x16x32_bf16 v[96:99], a[124:127], v[152:155], v[96:99]
  v_mfma_f32_16x16x32_bf16 v[100:103], a[124:127], v[156:159], v[100:103]
  v_mfma_f32_16x16x32_bf16 v[104:107], a[124:127], v[160:163], v[104:107]
  v_mfma_f32_16x16x32_bf16 v[108:111], a[124:127], v[164:167], v[108:111]
  v_mfma_f32_16x16x32_bf16 v[112:115], a[124:127], v[168:171], v[112:115]
  v_mfma_f32_16x16x32_bf16 v[116:119], a[124:127], v[172:175], v[116:119]
  v_cvt_pk_bf16_f32 v8, v8, v9
  v_cvt_pk_bf16_f32 v9, v10, v11
  v_cvt_pk_bf16_f32 v10, v36, v37
  v_cvt_pk_bf16_f32 v11, v38, v39
  s_mul_i32 s53, s71, 7
  s_add_u32 s53, s53, 0
  s_lshl_b32 s53, s53, 4
  s_add_u32 s53, s53, s70
  s_mul_i32 s53, s53, 14
  s_add_u32 s53, s53, s74
  s_add_u32 s53, s53, 6272
  s_lshl_b32 s53, s53, 10
  buffer_store_dwordx4 v[8:11], v3, s[32:35], s53 offen
  v_cvt_pk_bf16_f32 v12, v12, v13
  v_cvt_pk_bf16_f32 v13, v14, v15
  v_cvt_pk_bf16_f32 v14, v40, v41
  v_cvt_pk_bf16_f32 v15, v42, v43
  s_mul_i32 s53, s71, 7
  s_add_u32 s53, s53, 1
  s_lshl_b32 s53, s53, 4
  s_add_u32 s53, s53, s70
  s_mul_i32 s53, s53, 14
  s_add_u32 s53, s53, s74
  s_add_u32 s53, s53, 6272
  s_lshl_b32 s53, s53, 10
  buffer_store_dwordx4 v[12:15], v3, s[32:35], s53 offen
  v_cvt_pk_bf16_f32 v16, v16, v17
  v_cvt_pk_bf16_f32 v17, v18, v19
  v_cvt_pk_bf16_f32 v18, v44, v45
  v_cvt_pk_bf16_f32 v19, v46, v47
  s_mul_i32 s53, s71, 7
  s_add_u32 s53, s53, 2
  s_lshl_b32 s53, s53, 4
  s_add_u32 s53, s53, s70
  s_mul_i32 s53, s53, 14
  s_add_u32 s53, s53, s74
  s_add_u32 s53, s53, 6272
  s_lshl_b32 s53, s53, 10
  buffer_store_dwordx4 v[16:19], v3, s[32:35], s53 offen
  v_cvt_pk_bf16_f32 v20, v20, v21
  v_cvt_pk_bf16_f32 v21, v22, v23
  v_cvt_pk_bf16_f32 v22, v48, v49
  v_cvt_pk_bf16_f32 v23, v50, v51
  s_mul_i32 s53, s71, 7
  s_add_u32 s53, s53, 3
  s_lshl_b32 s53, s53, 4
  s_add_u32 s53, s53, s70
  s_mul_i32 s53, s53, 14
  s_add_u32 s53, s53, s74
  s_add_u32 s53, s53, 6272
  s_lshl_b32 s53, s53, 10
  buffer_store_dwordx4 v[20:23], v3, s[32:35], s53 offen
  v_cvt_pk_bf16_f32 v24, v24, v25
  v_cvt_pk_bf16_f32 v25, v26, v27
  v_cvt_pk_bf16_f32 v26, v52, v53
  v_cvt_pk_bf16_f32 v27, v54, v55
  s_mul_i32 s53, s71, 7
  s_add_u32 s53, s53, 4
  s_lshl_b32 s53, s53, 4
  s_add_u32 s53, s53, s70
  s_mul_i32 s53, s53, 14
  s_add_u32 s53, s53, s74
  s_add_u32 s53, s53, 6272
  s_lshl_b32 s53, s53, 10
  buffer_store_dwordx4 v[24:27], v3, s[32:35], s53 offen
  v_cvt_pk_bf16_f32 v28, v28, v29
  v_cvt_pk_bf16_f32 v29, v30, v31
  v_cvt_pk_bf16_f32 v30, v56, v57
  v_cvt_pk_bf16_f32 v31, v58, v59
  s_mul_i32 s53, s71, 7
  s_add_u32 s53, s53, 5
  s_lshl_b32 s53, s53, 4
  s_add_u32 s53, s53, s70
  s_mul_i32 s53, s53, 14
  s_add_u32 s53, s53, s74
  s_add_u32 s53, s53, 6272
  s_lshl_b32 s53, s53, 10
  buffer_store_dwordx4 v[28:31], v3, s[32:35], s53 offen
  v_cvt_pk_bf16_f32 v32, v32, v33
  v_cvt_pk_bf16_f32 v33, v34, v35
  v_cvt_pk_bf16_f32 v34, v60, v61
  v_cvt_pk_bf16_f32 v35, v62, v63
  s_mul_i32 s53, s71, 7
  s_add_u32 s53, s53, 6
  s_lshl_b32 s53, s53, 4
  s_add_u32 s53, s53, s70
  s_mul_i32 s53, s53, 14
  s_add_u32 s53, s53, s74
  s_add_u32 s53, s53, 6272
  s_lshl_b32 s53, s53, 10
  buffer_store_dwordx4 v[32:35], v3, s[32:35], s53 offen
  s_cmp_eq_u32 s73, 3
  s_cbranch_scc1 fin_25
  v_cvt_pk_bf16_f32 v64, v64, v65
  v_cvt_pk_bf16_f32 v65, v66, v67
  v_cvt_pk_bf16_f32 v66, v92, v93
  v_cvt_pk_bf16_f32 v67, v94, v95
  s_mul_i32 s53, s71, 7
  s_add_u32 s53, s53, 0
  s_lshl_b32 s53, s53, 4
  s_add_u32 s53, s53, s70
  s_mul_i32 s53, s53, 14
  s_add_u32 s53, s53, s75
  s_add_u32 s53, s53, 6272
  s_lshl_b32 s53, s53, 10
  buffer_store_dwordx4 v[64:67], v3, s[32:35], s53 offen
  v_cvt_pk_bf16_f32 v68, v68, v69
  v_cvt_pk_bf16_f32 v69, v70, v71
  v_cvt_pk_bf16_f32 v70, v96, v97
  v_cvt_pk_bf16_f32 v71, v98, v99
  s_mul_i32 s53, s71, 7
  s_add_u32 s53, s53, 1
  s_lshl_b32 s53, s53, 4
  s_add_u32 s53, s53, s70
  s_mul_i32 s53, s53, 14
  s_add_u32 s53, s53, s75
  s_add_u32 s53, s53, 6272
  s_lshl_b32 s53, s53, 10
  buffer_store_dwordx4 v[68:71], v3, s[32:35], s53 offen
  v_cvt_pk_bf16_f32 v72, v72, v73
  v_cvt_pk_bf16_f32 v73, v74, v75
  v_cvt_pk_bf16_f32 v74, v100, v101
  v_cvt_pk_bf16_f32 v75, v102, v103
  s_mul_i32 s53, s71, 7
  s_add_u32 s53, s53, 2
  s_lshl_b32 s53, s53, 4
  s_add_u32 s53, s53, s70
  s_mul_i32 s53, s53, 14
  s_add_u32 s53, s53, s75
  s_add_u32 s53, s53, 6272
  s_lshl_b32 s53, s53, 10
  buffer_store_dwordx4 v[72:75], v3, s[32:35], s53 offen
  v_cvt_pk_bf16_f32 v76, v76, v77
  v_cvt_pk_bf16_f32 v77, v78, v79
  v_cvt_pk_bf16_f32 v78, v104, v105
  v_cvt_pk_bf16_f32 v79, v106, v107
  s_mul_i32 s53, s71, 7
  s_add_u32 s53, s53, 3
  s_lshl_b32 s53, s53, 4
  s_add_u32 s53, s53, s70
  s_mul_i32 s53, s53, 14
  s_add_u32 s53, s53, s75
  s_add_u32 s53, s53, 6272
  s_lshl_b32 s53, s53, 10
  buffer_store_dwordx4 v[76:79], v3, s[32:35], s53 offen
  v_cvt_pk_bf16_f32 v80, v80, v81
  v_cvt_pk_bf16_f32 v81, v82, v83
  v_cvt_pk_bf16_f32 v82, v108, v109
  v_cvt_pk_bf16_f32 v83, v110, v111
  s_mul_i32 s53, s71, 7
  s_add_u32 s53, s53, 4
  s_lshl_b32 s53, s53, 4
  s_add_u32 s53, s53, s70
  s_mul_i32 s53, s53, 14
  s_add_u32 s53, s53, s75
  s_add_u32 s53, s53, 6272
  s_lshl_b32 s53, s53, 10
  buffer_store_dwordx4 v[80:83], v3, s[32:35], s53 offen
  v_cvt_pk_bf16_f32 v84, v84, v85
  v_cvt_pk_bf16_f32 v85, v86, v87
  v_cvt_pk_bf16_f32 v86, v112, v113
  v_cvt_pk_bf16_f32 v87, v114, v115
  s_mul_i32 s53, s71, 7
  s_add_u32 s53, s53, 5
  s_lshl_b32 s53, s53, 4
  s_add_u32 s53, s53, s70
  s_mul_i32 s53, s53, 14
  s_add_u32 s53, s53, s75
  s_add_u32 s53, s53, 6272
  s_lshl_b32 s53, s53, 10
  buffer_store_dwordx4 v[84:87], v3, s[32:35], s53 offen
  v_cvt_pk_bf16_f32 v88, v88, v89
  v_cvt_pk_bf16_f32 v89, v90, v91
  v_cvt_pk_bf16_f32 v90, v116, v117
  v_cvt_pk_bf16_f32 v91, v118, v119
  s_mul_i32 s53, s71, 7
  s_add_u32 s53, s53, 6
  s_lshl_b32 s53, s53, 4
  s_add_u32 s53, s53, s70
  s_mul_i32 s53, s53, 14
  s_add_u32 s53, s53, s75
  s_add_u32 s53, s53, 6272
  s_lshl_b32 s53, s53, 10
  buffer_store_dwordx4 v[88:91], v3, s[32:35], s53 offen
fin_25:
  s_endpgm
k0_exit:
  s_endpgm
.text
.globl interleave_layers__memory_aug_recurrent_mem_tr__glu_gated_glu__prompt_kernel
.p2align 8
.type interleave_layers__memory_aug_recurrent_mem_tr__glu_gated_glu__prompt_kernel,@function
interleave_layers__memory_aug_recurrent_mem_tr__glu_gated_glu__prompt_kernel:
  s_cmp_ge_u32 s2, 256
  s_cbranch_scc1 k1_exit
  s_load_dwordx16 s[4:19], s[0:1], 0
  s_load_dwordx8 s[20:27], s[0:1], 64
  s_load_dwordx4 s[28:31], s[0:1], 96
  s_waitcnt lgkmcnt(0)
  s_mov_b32 s32, s30
  s_and_b32 s33, s31, 0xffff
  s_mov_b32 s34, 268435456
  s_mov_b32 s35, 0x20000
  s_mov_b32 s36, s28
  s_and_b32 s37, s29, 0xffff
  s_mov_b32 s38, 256
  s_mov_b32 s39, 0x20000
  v_lshrrev_b32 v1, 6, v0
  s_nop 0
  v_readfirstlane_b32 s48, v1
  v_and_b32 v1, 63, v0
  v_lshlrev_b32 v2, 4, v1
  s_mov_b32 s51, 0
  s_mov_b32 s53, 0
  s_mov_b32 s49, 999
  s_cmp_lg_u32 s48, 0
  s_cbranch_scc1 k1_role_wait
  s_getreg_b32 s55, hwreg(HW_REG_XCC_ID, 0, 4)
  s_lshl_b32 s56, s55, 7
  s_add_u32 s56, s56, 124784640
  v_mov_b32 v3, 1
  v_cmp_eq_u32 vcc, 0, v1
  v_mov_b32 v4, 1073741824
  s_nop 0
  v_cndmask_b32 v4, v4, v1, vcc
  buffer_atomic_add v3, v4, s[32:35], s56 offen sc0 sc1
  s_waitcnt vmcnt(0)
  v_readfirstlane_b32 s50, v3
  s_mov_b32 s57, 0
  s_cmp_eq_u32 s55, 0
  s_cselect_b32 s57, 30, s57
  s_cmp_eq_u32 s55, 1
  s_cselect_b32 s57, 30, s57
  s_cmp_eq_u32 s55, 2
  s_cselect_b32 s57, 32, s57
  s_cmp_eq_u32 s55, 3
  s_cselect_b32 s57, 32, s57
  s_cmp_eq_u32 s55, 4
  s_cselect_b32 s57, 31, s57
  s_cmp_eq_u32 s55, 5
  s_cselect_b32 s57, 32, s57
  s_cmp_eq_u32 s55, 6
  s_cselect_b32 s57, 32, s57
  s_cmp_eq_u32 s55, 7
  s_cselect_b32 s57, 32, s57
  s_cmp_lt_u32 s50, s57
  s_cbranch_scc0 k1_left
  s_lshl_b32 s49, s55, 5
  s_add_u32 s49, s49, s50
  s_branch k1_role_put
k1_left:
  v_mov_b32 v3, 1
  s_mov_b32 s56, 124786688
  buffer_atomic_add v3, v4, s[32:35], s56 offen sc0 sc1
  s_waitcnt vmcnt(0)
  v_readfirstlane_b32 s58, v3
  v_and_b32 v6, 15, v1
  v_lshlrev_b32 v6, 7, v6
  s_mov_b32 s56, 124784640
  s_mov_b32 s52, 60000
poll_26:
  buffer_load_dword v5, v6, s[32:35], s56 offen sc1
  s_waitcnt vmcnt(0)
  v_mov_b32 v7, v5
  s_nop 1
  v_add_u32_dpp v7, v7, v7 quad_perm:[1,0,3,2] row_mask:0xf bank_mask:0xf
  s_nop 1
  v_add_u32_dpp v7, v7, v7 quad_perm:[2,3,0,1] row_mask:0xf bank_mask:0xf
  s_nop 1
  v_add_u32_dpp v7, v7, v7 row_half_mirror row_mask:0xf bank_mask:0xf
  s_nop 1
  v_add_u32_dpp v7, v7, v7 row_mirror row_mask:0xf bank_mask:0xf
  v_cmp_ne_u32 vcc, 0x100, v7
  s_cbranch_vccz pok_27
  s_sleep 4
  s_sub_u32 s52, s52, 1
  s_cbranch_scc0 poll_26
  s_mov_b32 s54, 1
  s_branch k1_fail
pok_27:
  v_readlane_b32 s59, v5, 0
  s_nop 0
  s_min_u32 s59, s59, 30
  s_sub_u32 s60, 30, s59
  s_cmp_lt_u32 s58, s60
  s_cbranch_scc0 lf_28
  s_add_u32 s49, s59, s58
  s_add_u32 s49, s49, 0
  s_branch k1_role_put
lf_28:
  s_sub_u32 s58, s58, s60
  v_readlane_b32 s59, v5, 1
  s_nop 0
  s_min_u32 s59, s59, 30
  s_sub_u32 s60, 30, s59
  s_cmp_lt_u32 s58, s60
  s_cbranch_scc0 lf_29
  s_add_u32 s49, s59, s58
  s_add_u32 s49, s49, 32
  s_branch k1_role_put
lf_29:
  s_sub_u32 s58, s58, s60
  v_readlane_b32 s59, v5, 2
  s_nop 0
  s_min_u32 s59, s59, 32
  s_sub_u32 s60, 32, s59
  s_cmp_lt_u32 s58, s60
  s_cbranch_scc0 lf_30
  s_add_u32 s49, s59, s58
  s_add_u32 s49, s49, 64
  s_branch k1_role_put
lf_30:
  s_sub_u32 s58, s58, s60
  v_readlane_b32 s59, v5, 3
  s_nop 0
  s_min_u32 s59, s59, 32
  s_sub_u32 s60, 32, s59
  s_cmp_lt_u32 s58, s60
  s_cbranch_scc0 lf_31
  s_add_u32 s49, s59, s58
  s_add_u32 s49, s49, 96
  s_branch k1_role_put
lf_31:
  s_sub_u32 s58, s58, s60
  v_readlane_b32 s59, v5, 4
  s_nop 0
  s_min_u32 s59, s59, 31
  s_sub_u32 s60, 31, s59
  s_cmp_lt_u32 s58, s60
  s_cbranch_scc0 lf_32
  s_add_u32 s49, s59, s58
  s_add_u32 s49, s49, 128
  s_branch k1_role_put
lf_32:
  s_sub_u32 s58, s58, s60
  v_readlane_b32 s59, v5, 5
  s_nop 0
  s_min_u32 s59, s59, 32
  s_sub_u32 s60, 32, s59
  s_cmp_lt_u32 s58, s60
  s_cbranch_scc0 lf_33
  s_add_u32 s49, s59, s58
  s_add_u32 s49, s49, 160
  s_branch k1_role_put
lf_33:
  s_sub_u32 s58, s58, s60
  v_readlane_b32 s59, v5, 6
  s_nop 0
  s_min_u32 s59, s59, 32
  s_sub_u32 s60, 32, s59
  s_cmp_lt_u32 s58, s60
  s_cbranch_scc0 lf_34
  s_add_u32 s49, s59, s58
  s_add_u32 s49, s49, 192
  s_branch k1_role_put
lf_34:
  s_sub_u32 s58, s58, s60
  v_readlane_b32 s59, v5, 7
  s_nop 0
  s_min_u32 s59, s59, 32
  s_sub_u32 s60, 32, s59
  s_cmp_lt_u32 s58, s60
  s_cbranch_scc0 lf_35
  s_add_u32 s49, s59, s58
  s_add_u32 s49, s49, 224
  s_branch k1_role_put
lf_35:
  s_sub_u32 s58, s58, s60
k1_role_put:
  v_mov_b32 v3, s49
  v_mov_b32 v4, 0
  ds_write_b32 v4, v3
  s_waitcnt lgkmcnt(0)
k1_role_wait:
  s_barrier
  v_mov_b32 v4, 0
  ds_read_b32 v3, v4
  s_waitcnt lgkmcnt(0)
  v_readfirstlane_b32 s49, v3
  s_barrier
  s_and_b32 s50, s49, 31
  s_mov_b32 s57, 0
  s_bfe_u32 s58, s49, 0x10005
  s_cmp_ge_u32 s49, 64
  s_cbranch_scc1 k1_bulk
  s_cmp_eq_u32 s58, 0
  s_cbranch_scc1 ng_36
  s_mov_b32 s44, 124788608
  s_mov_b32 s52, 60000
poll_37:
  buffer_load_dword v3, off, s[32:35], s44 sc1
  s_waitcnt vmcnt(0)
  v_cmp_ne_u32 vcc, 1, v3
  s_cbranch_vccz pok_38
  s_sleep 16
  s_sub_u32 s52, s52, 1
  s_cbranch_scc0 poll_37
  s_mov_b32 s54, 5
  s_branch k1_fail
pok_38:
ng_36:
  s_cmp_lt_u32 s50, 16
  s_cbranch_scc1 r_chainA
  s_branch r_chainB
k1_bulk:
  s_cmp_lt_u32 s49, 256
  s_cbranch_scc1 r_rest
k1_exit:
  s_endpgm
k1_fail:
  s_lshl_b32 s55, s49, 16
  s_lshl_b32 s56, s51, 8
  s_or_b32 s54, s54, s55
  s_or_b32 s54, s54, s56
  v_mov_b32 v3, s54
  s_and_b32 s55, s54, 15
  s_lshl_b32 s55, s55, 2
  v_mov_b32 v4, s55
  buffer_store_dword v3, v4, s[36:39], 0 offen
  s_endpgm
r_chainA:
  s_and_b32 s46, s48, 1
  s_mul_i32 s47, s48, 7
  s_lshr_b32 s44, s47, 1
  s_add_u32 s45, s44, 4
  s_cmp_ge_u32 s45, 14
  s_cselect_b32 s55, 14, 0
  s_sub_u32 s45, s45, s55
  s_lshl_b32 s60, s45, 10
  s_add_u32 s45, s44, 5
  s_cmp_ge_u32 s45, 14
  s_cselect_b32 s55, 14, 0
  s_sub_u32 s45, s45, s55
  s_lshl_b32 s61, s45, 10
  s_add_u32 s45, s44, 6
  s_cmp_ge_u32 s45, 14
  s_cselect_b32 s55, 14, 0
  s_sub_u32 s45, s45, s55
  s_lshl_b32 s62, s45, 10
  s_add_u32 s45, s44, 7
  s_cmp_ge_u32 s45, 14
  s_cselect_b32 s55, 14, 0
  s_sub_u32 s45, s45, s55
  s_lshl_b32 s63, s45, 10
  s_add_u32 s45, s44, 8
  s_cmp_ge_u32 s45, 14
  s_cselect_b32 s55, 14, 0
  s_sub_u32 s45, s45, s55
  s_lshl_b32 s64, s45, 10
  s_add_u32 s45, s44, 9
  s_cmp_ge_u32 s45, 14
  s_cselect_b32 s55, 14, 0
  s_sub_u32 s45, s45, s55
  s_lshl_b32 s65, s45, 10
  s_add_u32 s45, s44, 10
  s_cmp_ge_u32 s45, 14
  s_cselect_b32 s55, 14, 0
  s_sub_u32 s45, s45, s55
  s_lshl_b32 s66, s45, 10
  s_add_u32 s45, s44, 11
  s_cmp_ge_u32 s45, 14
  s_cselect_b32 s55, 14, 0
  s_sub_u32 s45, s45, s55
  s_lshl_b32 s67, s45, 10
  s_add_u32 s45, s44, 12
  s_cmp_ge_u32 s45, 14
  s_cselect_b32 s55, 14, 0
  s_sub_u32 s45, s45, s55
  s_lshl_b32 s68, s45, 10
  s_add_u32 s45, s44, 13
  s_cmp_ge_u32 s45, 14
  s_cselect_b32 s55, 14, 0
  s_sub_u32 s45, s45, s55
  s_lshl_b32 s69, s45, 10
  s_add_u32 s45, s44, 0
  s_add_u32 s45, s45, s46
  s_lshl_b32 s70, s45, 10
  s_add_u32 s45, s44, 1
  s_add_u32 s45, s45, s46
  s_lshl_b32 s71, s45, 10
  s_add_u32 s45, s44, 2
  s_add_u32 s45, s45, s46
  s_lshl_b32 s72, s45, 10
  s_cmp_eq_u32 s46, 0
  s_cselect_b32 s55, 3, 0
  s_add_u32 s45, s44, s55
  s_lshl_b32 s73, s45, 10
  s_add_u32 s45, s47, 0
  s_add_u32 s45, s45, s46
  s_mul_i32 s55, s50, 28
  s_add_u32 s45, s45, s55
  s_mul_i32 s45, s45, 14336
  s_add_u32 s74, s45, 0
  s_add_u32 s45, s47, 1
  s_add_u32 s45, s45, s46
  s_mul_i32 s55, s50, 28
  s_add_u32 s45, s45, s55
  s_mul_i32 s45, s45, 14336
  s_add_u32 s75, s45, 0
  s_add_u32 s45, s47, 2
  s_add_u32 s45, s45, s46
  s_mul_i32 s55, s50, 28
  s_add_u32 s45, s45, s55
  s_mul_i32 s45, s45, 14336
  s_add_u32 s76, s45, 0
  s_add_u32 s45, s47, 3
  s_add_u32 s45, s45, s46
  s_mul_i32 s55, s50, 28
  s_add_u32 s45, s45, s55
  s_mul_i32 s45, s45, 14336
  s_add_u32 s77, s45, 0
  s_add_u32 s45, s47, 4
  s_add_u32 s45, s45, s46
  s_mul_i32 s55, s50, 28
  s_add_u32 s45, s45, s55
  s_mul_i32 s45, s45, 14336
  s_add_u32 s78, s45, 0
  s_add_u32 s45, s47, 5
  s_add_u32 s45, s45, s46
  s_mul_i32 s55, s50, 28
  s_add_u32 s45, s45, s55
  s_mul_i32 s45, s45, 14336
  s_add_u32 s79, s45, 0
  s_cmp_eq_u32 s46, 0
  s_cselect_b32 s55, 6, 0
  s_add_u32 s45, s47, s55
  s_mul_i32 s55, s50, 28
  s_add_u32 s45, s45, s55
  s_mul_i32 s45, s45, 14336
  s_add_u32 s80, s45, 0
  v_add_u32 v117, s70, v2
  s_mov_b32 s90, s70
  v_add_u32 v118, s71, v2
  s_mov_b32 s91, s71
  v_add_u32 v119, s72, v2
  s_mov_b32 s92, s72
  v_add_u32 v13, s73, v2
  s_mov_b32 s93, s73
  s_lshl_b32 s45, s48, 1
  s_add_u32 s45, s45, 0
  s_cmp_ge_u32 s45, 7
  s_cselect_b32 s55, 7, 0
  s_sub_u32 s45, s45, s55
  s_lshl_b32 s60, s45, 11
  s_add_u32 s61, s60, 1024
  s_lshl_b32 s45, s48, 1
  s_add_u32 s45, s45, 1
  s_cmp_ge_u32 s45, 7
  s_cselect_b32 s55, 7, 0
  s_sub_u32 s45, s45, s55
  s_lshl_b32 s62, s45, 11
  s_add_u32 s63, s62, 1024
  s_lshl_b32 s45, s48, 1
  s_add_u32 s45, s45, 2
  s_cmp_ge_u32 s45, 7
  s_cselect_b32 s55, 7, 0
  s_sub_u32 s45, s45, s55
  s_lshl_b32 s64, s45, 11
  s_add_u32 s65, s64, 1024
  s_lshl_b32 s45, s45, 10
  v_add_u32 v106, s45, v2
  s_lshl_b32 s45, s48, 1
  s_add_u32 s45, s45, 3
  s_cmp_ge_u32 s45, 7
  s_cselect_b32 s55, 7, 0
  s_sub_u32 s45, s45, s55
  s_lshl_b32 s66, s45, 11
  s_add_u32 s67, s66, 1024
  s_lshl_b32 s45, s45, 10
  v_add_u32 v107, s45, v2
  s_lshl_b32 s45, s48, 1
  s_add_u32 s45, s45, 4
  s_cmp_ge_u32 s45, 7
  s_cselect_b32 s55, 7, 0
  s_sub_u32 s45, s45, s55
  s_lshl_b32 s68, s45, 11
  s_add_u32 s69, s68, 1024
  s_lshl_b32 s45, s45, 10
  v_add_u32 v108, s45, v2
  s_lshl_b32 s45, s48, 1
  s_add_u32 s45, s45, 5
  s_cmp_ge_u32 s45, 7
  s_cselect_b32 s55, 7, 0
  s_sub_u32 s45, s45, s55
  s_lshl_b32 s70, s45, 11
  s_add_u32 s71, s70, 1024
  s_lshl_b32 s45, s45, 10
  v_add_u32 v109, s45, v2
  s_lshl_b32 s45, s48, 1
  s_add_u32 s45, s45, 6
  s_cmp_ge_u32 s45, 7
  s_cselect_b32 s55, 7, 0
  s_sub_u32 s45, s45, s55
  s_lshl_b32 s72, s45, 11
  s_add_u32 s73, s72, 1024
  s_lshl_b32 s45, s45, 10
  v_add_u32 v110, s45, v2
  s_add_u32 s45, s74, s60
  buffer_load_dwordx4 a[0:3], v2, s[32:35], s45 offen
  s_add_u32 s45, s74, s61
  buffer_load_dwordx4 a[4:7], v2, s[32:35], s45 offen
  s_add_u32 s45, s74, s62
  buffer_load_dwordx4 a[8:11], v2, s[32:35], s45 offen
  s_add_u32 s45, s74, s63
  buffer_load_dwordx4 a[12:15], v2, s[32:35], s45 offen
  s_add_u32 s45, s74, s64
  buffer_load_dwordx4 a[16:19], v2, s[32:35], s45 offen
  s_add_u32 s45, s74, s65
  buffer_load_dwordx4 a[20:23], v2, s[32:35], s45 offen
  s_add_u32 s45, s74, s66
  buffer_load_dwordx4 a[24:27], v2, s[32:35], s45 offen
  s_add_u32 s45, s74, s67
  buffer_load_dwordx4 a[28:31], v2, s[32:35], s45 offen
  s_add_u32 s45, s74, s68
  buffer_load_dwordx4 a[32:35], v2, s[32:35], s45 offen
  s_add_u32 s45, s74, s69
  buffer_load_dwordx4 a[36:39], v2, s[32:35], s45 offen
  s_add_u32 s45, s74, s70
  buffer_load_dwordx4 a[40:43], v2, s[32:35], s45 offen
  s_add_u32 s45, s74, s71
  buffer_load_dwordx4 a[44:47], v2, s[32:35], s45 offen
  s_add_u32 s45, s74, s72
  buffer_load_dwordx4 a[48:51], v2, s[32:35], s45 offen
  s_add_u32 s45, s74, s73
  buffer_load_dwordx4 a[52:55], v2, s[32:35], s45 offen
  s_add_u32 s45, s75, s60
  buffer_load_dwordx4 a[56:59], v2, s[32:35], s45 offen
  s_add_u32 s45, s75, s61
  buffer_load_dwordx4 a[60:63], v2, s[32:35], s45 offen
  s_add_u32 s45, s75, s62
  buffer_load_dwordx4 a[64:67], v2, s[32:35], s45 offen
  s_add_u32 s45, s75, s63
  buffer_load_dwordx4 a[68:71], v2, s[32:35], s45 offen
  s_add_u32 s45, s75, s64
  buffer_load_dwordx4 a[72:75], v2, s[32:35], s45 offen
  s_add_u32 s45, s75, s65
  buffer_load_dwordx4 a[76:79], v2, s[32:35], s45 offen
  s_add_u32 s45, s75, s66
  buffer_load_dwordx4 a[80:83], v2, s[32:35], s45 offen
  s_add_u32 s45, s75, s67
  buffer_load_dwordx4 a[84:87], v2, s[32:35], s45 offen
  s_add_u32 s45, s75, s68
  buffer_load_dwordx4 a[88:91], v2, s[32:35], s45 offen
  s_add_u32 s45, s75, s69
  buffer_load_dwordx4 a[92:95], v2, s[32:35], s45 offen
  s_add_u32 s45, s75, s70
  buffer_load_dwordx4 a[96:99], v2, s[32:35], s45 offen
  s_add_u32 s45, s75, s71
  buffer_load_dwordx4 a[100:103], v2, s[32:35], s45 offen
  s_add_u32 s45, s75, s72
  buffer_load_dwordx4 a[104:107], v2, s[32:35], s45 offen
  s_add_u32 s45, s75, s73
  buffer_load_dwordx4 a[108:111], v2, s[32:35], s45 offen
  s_add_u32 s45, s76, s60
  buffer_load_dwordx4 a[112:115], v2, s[32:35], s45 offen
  s_add_u32 s45, s76, s61
  buffer_load_dwordx4 a[116:119], v2, s[32:35], s45 offen
  s_add_u32 s45, s76, s62
  buffer_load_dwordx4 a[120:123], v2, s[32:35], s45 offen
  s_add_u32 s45, s76, s63
  buffer_load_dwordx4 a[124:127], v2, s[32:35], s45 offen
  s_add_u32 s45, s76, s64
  buffer_load_dwordx4 a[128:131], v2, s[32:35], s45 offen
  s_add_u32 s45, s76, s65
  buffer_load_dwordx4 a[132:135], v2, s[32:35], s45 offen
  s_add_u32 s45, s76, s66
  buffer_load_dwordx4 a[136:139], v2, s[32:35], s45 offen
  s_add_u32 s45, s76, s67
  buffer_load_dwordx4 a[140:143], v2, s[32:35], s45 offen
  s_add_u32 s45, s76, s68
  buffer_load_dwordx4 a[144:147], v2, s[32:35], s45 offen
  s_add_u32 s45, s76, s69
  buffer_load_dwordx4 a[148:151], v2, s[32:35], s45 offen
  s_add_u32 s45, s76, s70
  buffer_load_dwordx4 a[152:155], v2, s[32:35], s45 offen
  s_add_u32 s45, s76, s71
  buffer_load_dwordx4 a[156:159], v2, s[32:35], s45 offen
  s_add_u32 s45, s76, s72
  buffer_load_dwordx4 a[160:163], v2, s[32:35], s45 offen
  s_add_u32 s45, s76, s73
  buffer_load_dwordx4 a[164:167], v2, s[32:35], s45 offen
  s_add_u32 s45, s77, s60
  buffer_load_dwordx4 a[168:171], v2, s[32:35], s45 offen
  s_add_u32 s45, s77, s61
  buffer_load_dwordx4 a[172:175], v2, s[32:35], s45 offen
  s_add_u32 s45, s77, s62
  buffer_load_dwordx4 a[176:179], v2, s[32:35], s45 offen
  s_add_u32 s45, s77, s63
  buffer_load_dwordx4 a[180:183], v2, s[32:35], s45 offen
  s_add_u32 s45, s77, s64
  buffer_load_dwordx4 a[184:187], v2, s[32:35], s45 offen
  s_add_u32 s45, s77, s65
  buffer_load_dwordx4 a[188:191], v2, s[32:35], s45 offen
  s_add_u32 s45, s77, s66
  buffer_load_dwordx4 a[192:195], v2, s[32:35], s45 offen
  s_add_u32 s45, s77, s67
  buffer_load_dwordx4 a[196:199], v2, s[32:35], s45 offen
  s_add_u32 s45, s77, s68
  buffer_load_dwordx4 a[200:203], v2, s[32:35], s45 offen
  s_add_u32 s45, s77, s69
  buffer_load_dwordx4 a[204:207], v2, s[32:35], s45 offen
  s_add_u32 s45, s77, s70
  buffer_load_dwordx4 a[208:211], v2, s[32:35], s45 offen
  s_add_u32 s45, s77, s71
  buffer_load_dwordx4 a[212:215], v2, s[32:35], s45 offen
  s_add_u32 s45, s77, s72
  buffer_load_dwordx4 a[216:219], v2, s[32:35], s45 offen
  s_add_u32 s45, s77, s73
  buffer_load_dwordx4 a[220:223], v2, s[32:35], s45 offen
  s_add_u32 s45, s78, s60
  buffer_load_dwordx4 a[224:227], v2, s[32:35], s45 offen
  s_add_u32 s45, s78, s61
  buffer_load_dwordx4 a[228:231], v2, s[32:35], s45 offen
  s_add_u32 s45, s78, s62
  buffer_load_dwordx4 a[232:235], v2, s[32:35], s45 offen
  s_add_u32 s45, s78, s63
  buffer_load_dwordx4 a[236:239], v2, s[32:35], s45 offen
  s_add_u32 s45, s78, s64
  buffer_load_dwordx4 a[240:243], v2, s[32:35], s45 offen
  s_add_u32 s45, s78, s65
  buffer_load_dwordx4 a[244:247], v2, s[32:35], s45 offen
  s_add_u32 s45, s78, s66
  buffer_load_dwordx4 a[248:251], v2, s[32:35], s45 offen
  s_add_u32 s45, s78, s67
  buffer_load_dwordx4 a[252:255], v2, s[32:35], s45 offen
  s_add_u32 s45, s78, s68
  buffer_load_dwordx4 v[120:123], v2, s[32:35], s45 offen
  s_add_u32 s45, s78, s69
  buffer_load_dwordx4 v[124:127], v2, s[32:35], s45 offen
  s_add_u32 s45, s78, s70
  buffer_load_dwordx4 v[128:131], v2, s[32:35], s45 offen
  s_add_u32 s45, s78, s71
  buffer_load_dwordx4 v[132:135], v2, s[32:35], s45 offen
  s_add_u32 s45, s78, s72
  buffer_load_dwordx4 v[136:139], v2, s[32:35], s45 offen
  s_add_u32 s45, s78, s73
  buffer_load_dwordx4 v[140:143], v2, s[32:35], s45 offen
  s_add_u32 s45, s79, s60
  buffer_load_dwordx4 v[144:147], v2, s[32:35], s45 offen
  s_add_u32 s45, s79, s61
  buffer_load_dwordx4 v[148:151], v2, s[32:35], s45 offen
  s_add_u32 s45, s79, s62
  buffer_load_dwordx4 v[152:155], v2, s[32:35], s45 offen
  s_add_u32 s45, s79, s63
  buffer_load_dwordx4 v[156:159], v2, s[32:35], s45 offen
  s_add_u32 s45, s79, s64
  buffer_load_dwordx4 v[160:163], v2, s[32:35], s45 offen
  s_add_u32 s45, s79, s65
  buffer_load_dwordx4 v[164:167], v2, s[32:35], s45 offen
  s_add_u32 s45, s79, s66
  buffer_load_dwordx4 v[168:171], v2, s[32:35], s45 offen
  s_add_u32 s45, s79, s67
  buffer_load_dwordx4 v[172:175], v2, s[32:35], s45 offen
  s_add_u32 s45, s79, s68
  buffer_load_dwordx4 v[176:179], v2, s[32:35], s45 offen
  s_add_u32 s45, s79, s69
  buffer_load_dwordx4 v[180:183], v2, s[32:35], s45 offen
  s_add_u32 s45, s79, s70
  buffer_load_dwordx4 v[184:187], v2, s[32:35], s45 offen
  s_add_u32 s45, s79, s71
  buffer_load_dwordx4 v[188:191], v2, s[32:35], s45 offen
  s_add_u32 s45, s79, s72
  buffer_load_dwordx4 v[192:195], v2, s[32:35], s45 offen
  s_add_u32 s45, s79, s73
  buffer_load_dwordx4 v[196:199], v2, s[32:35], s45 offen
  s_add_u32 s45, s80, s60
  buffer_load_dwordx4 v[200:203], v2, s[32:35], s45 offen
  s_add_u32 s45, s80, s61
  buffer_load_dwordx4 v[204:207], v2, s[32:35], s45 offen
  s_add_u32 s45, s80, s62
  buffer_load_dwordx4 v[208:211], v2, s[32:35], s45 offen
  s_add_u32 s45, s80, s63
  buffer_load_dwordx4 v[212:215], v2, s[32:35], s45 offen
  s_add_u32 s45, s80, s64
  buffer_load_dwordx4 v[216:219], v2, s[32:35], s45 offen
  s_add_u32 s45, s80, s65
  buffer_load_dwordx4 v[220:223], v2, s[32:35], s45 offen
  s_add_u32 s45, s80, s66
  buffer_load_dwordx4 v[224:227], v2, s[32:35], s45 offen
  s_add_u32 s45, s80, s67
  buffer_load_dwordx4 v[228:231], v2, s[32:35], s45 offen
  s_add_u32 s45, s80, s68
  buffer_load_dwordx4 v[232:235], v2, s[32:35], s45 offen
  s_add_u32 s45, s80, s69
  buffer_load_dwordx4 v[236:239], v2, s[32:35], s45 offen
  s_add_u32 s45, s80, s70
  buffer_load_dwordx4 v[240:243], v2, s[32:35], s45 offen
  s_add_u32 s45, s80, s71
  buffer_load_dwordx4 v[244:247], v2, s[32:35], s45 offen
  s_add_u32 s45, s80, s72
  buffer_load_dwordx4 v[248:251], v2, s[32:35], s45 offen
  s_add_u32 s45, s80, s73
  buffer_load_dwordx4 v[252:255], v2, s[32:35], s45 offen
  v_and_b32 v9, 1, v1
  v_cmp_eq_u32 vcc, 0, v9
  v_mov_b32 v112, 0xeeee
  v_mov_b32 v9, 0x4444
  v_cndmask_b32 v112, v112, v9, vcc
  v_and_b32 v9, 15, v1
  v_lshrrev_b32 v10, 4, v1
  s_mul_i32 s45, s48, 3584
  s_add_u32 s45, s45, 49152
  v_mul_u32_u24 v3, 208, v9
  v_lshl_add_u32 v3, v10, 4, v3
  v_add_u32 v3, s45, v3
  s_and_b32 s45, s48, 1
  s_lshl_b32 s45, s45, 2
  v_add_u32 v11, s45, v10
  v_mul_u32_u24 v12, 208, v11
  v_add_u32 v12, 49152, v12
  v_lshrrev_b32 v16, 2, v9
  v_lshlrev_b32 v16, 2, v16
  v_and_b32 v14, 1, v9
  v_lshl_add_u32 v16, v14, 1, v16
  v_bfe_u32 v14, v9, 1, 1
  v_lshl_add_u32 v16, v14, 4, v16
  v_add_u32 v16, 16, v16
  v_lshl_add_u32 v4, v16, 2, v12
  v_and_b32 v16, 3, v9
  v_lshl_add_u32 v5, v16, 3, v12
  v_lshrrev_b32 v16, 2, v9
  v_lshl_add_u32 v16, v16, 3, v11
  v_lshlrev_b32 v16, 4, v16
  v_and_b32 v14, 3, v9
  v_lshl_add_u32 v6, v14, 2, v16
  s_lshl_b32 s45, s50, 9
  v_add_u32 v6, s45, v6
  v_lshl_add_u32 v7, v9, 3, v11
  v_lshlrev_b32 v7, 4, v7
  s_lshr_b32 s45, s50, 2
  s_lshl_b32 s45, s45, 9
  s_and_b32 s44, s50, 3
  s_lshl_b32 s44, s44, 2
  s_add_u32 s45, s45, s44
  s_add_u32 s45, s45, 8192
  v_add_u32 v7, s45, v7
  v_mov_b32 v16, 1073741824
  v_cmp_gt_u32 vcc, 4, v9
  s_nop 1
  v_cndmask_b32 v7, v16, v7, vcc
  v_mov_b32 v114, 0
  v_mov_b32 v14, 1.0
  v_cndmask_b32 v114, v114, v14, vcc
  s_mul_i32 s70, s58, 458752
  s_add_u32 s70, s70, 120946688
  s_mul_i32 s60, s58, 655360
  s_add_u32 s60, s60, 122781696
  s_mul_i32 s62, s58, 1835008
  s_add_u32 s62, s62, 17661952
  s_add_u32 s63, s62, 14336
  s_lshl_b32 s45, s48, 13
  s_add_u32 s67, s45, 8192
  s_mov_b32 s66, 124551168
  v_min_u32 v8, 27, v1
  v_lshlrev_b32 v8, 7, v8
  s_lshl_b32 s45, s48, 11
  s_add_u32 s45, s45, 40960
  v_lshrrev_b32 v16, 2, v9
  v_lshlrev_b32 v16, 3, v16
  v_and_b32 v14, 3, v9
  v_add_u32 v16, v16, v14
  v_lshlrev_b32 v16, 4, v16
  v_lshl_add_u32 v16, v10, 2, v16
  v_add_u32 v115, s45, v16
  v_bfe_u32 v16, v1, 2, 2
  v_lshl_add_u32 v16, v10, 3, v16
  v_lshlrev_b32 v16, 4, v16
  v_and_b32 v14, 1, v1
  v_lshl_add_u32 v16, v14, 3, v16
  v_add_u32 v116, s45, v16
  v_lshrrev_b32 v16, 1, v10
  v_lshlrev_b32 v16, 4, v16
  v_and_b32 v14, 7, v9
  v_lshl_add_u32 v16, v14, 1, v16
  v_lshlrev_b32 v16, 4, v16
  v_and_b32 v14, 1, v10
  v_lshl_add_u32 v16, v14, 3, v16
  s_lshr_b32 s45, s90, 1
  v_add_u32 v0, s45, v16
  s_lshr_b32 s45, s91, 1
  v_add_u32 v10, s45, v16
  s_lshr_b32 s45, s92, 1
  v_add_u32 v14, s45, v16
  s_lshr_b32 s45, s93, 1
  s_lshl_b32 s44, s46, 2
  s_add_u32 s45, s45, s44
  v_add_u32 v9, s45, v16
  v_add_u32 v11, s67, v2
  s_lshl_b32 s45, s46, 3
  v_add_u32 v12, s45, v11
  s_lshl_b32 s45, s48, 11
  v_add_u32 v15, s45, v2
  s_mov_b32 s45, 1024
  s_cmp_eq_u32 s48, 3
  s_cselect_b32 s72, 4294961152, s45
  v_mov_b32 v93, v5
  v_mov_b32 v94, v6
  v_mov_b32 v95, v7
  v_and_b32 v6, 15, v1
  v_lshlrev_b32 v6, 7, v6
  s_mov_b32 s56, 124784640
  s_mov_b32 s52, 60000
poll_39:
  buffer_load_dword v5, v6, s[32:35], s56 offen sc1
  s_waitcnt vmcnt(0)
  v_mov_b32 v7, v5
  s_nop 1
  v_add_u32_dpp v7, v7, v7 quad_perm:[1,0,3,2] row_mask:0xf bank_mask:0xf
  s_nop 1
  v_add_u32_dpp v7, v7, v7 quad_perm:[2,3,0,1] row_mask:0xf bank_mask:0xf
  s_nop 1
  v_add_u32_dpp v7, v7, v7 row_half_mirror row_mask:0xf bank_mask:0xf
  s_nop 1
  v_add_u32_dpp v7, v7, v7 row_mirror row_mask:0xf bank_mask:0xf
  v_cmp_ne_u32 vcc, 0x100, v7
  v_readlane_b32 s59, v5, s58
  s_nop 0
  s_cmp_ge_u32 s59, 30
  s_cselect_b32 s53, 1, 0
  s_cselect_b64 vcc, 0, vcc
  s_cbranch_vccz pok_40
  s_sleep 4
  s_sub_u32 s52, s52, 1
  s_cbranch_scc0 poll_39
  s_mov_b32 s54, 2
  s_branch k1_fail
pok_40:
  v_mov_b32 v5, v93
  v_mov_b32 v6, v94
  v_mov_b32 v7, v95
  v_add_u32 v1, s72, v15
  s_waitcnt vmcnt(0)
  v_mov_b32 v88, 1
  s_mov_b32 s44, 124788608
  buffer_store_dword v88, off, s[32:35], s44 sc1
  v_mov_b32 v113, 0
  v_cmp_gt_u32 vcc, s58, v113
  s_cbranch_vccz fxok_41
  s_mov_b32 s52, 60000
poll_42:
  buffer_load_dword v113, v8, s[32:35], s66 offen sc1
  s_waitcnt vmcnt(0)
  v_cmp_ne_u32 vcc, 1, v113
  s_cbranch_vccz pok_43
  s_sleep 1
  s_sub_u32 s52, s52, 1
  s_cbranch_scc0 poll_42
  s_mov_b32 s54, 11
  s_branch k1_fail
pok_43:
fxok_41:
  s_add_u32 m0, s67, 0
  s_nop 0
  buffer_load_dwordx4 v117, s[32:35], s62 offen sc1 lds
  s_add_u32 m0, s67, 1024
  s_nop 0
  buffer_load_dwordx4 v117, s[32:35], s63 offen sc1 lds
  s_add_u32 m0, s67, 2048
  s_nop 0
  buffer_load_dwordx4 v118, s[32:35], s62 offen sc1 lds
  s_add_u32 m0, s67, 3072
  s_nop 0
  buffer_load_dwordx4 v118, s[32:35], s63 offen sc1 lds
  s_add_u32 m0, s67, 4096
  s_nop 0
  buffer_load_dwordx4 v119, s[32:35], s62 offen sc1 lds
  s_add_u32 m0, s67, 5120
  s_nop 0
  buffer_load_dwordx4 v119, s[32:35], s63 offen sc1 lds
  s_add_u32 m0, s67, 6144
  s_nop 0
  buffer_load_dwordx4 v13, s[32:35], s62 offen sc1 lds
  s_add_u32 m0, s67, 7168
  s_nop 0
  buffer_load_dwordx4 v13, s[32:35], s63 offen sc1 lds
  s_add_u32 s62, s62, 28672
  s_add_u32 s63, s63, 28672
  s_add_u32 s66, s66, 3584
  s_mov_b32 s40, 0
  s_mov_b32 s80, 0x42700000
  v_mov_b32 v44, 0
  v_mov_b32 v45, 0
  v_mov_b32 v46, 0
  v_mov_b32 v47, 0
  v_mov_b32 v48, 0
  v_mov_b32 v49, 0
  v_mov_b32 v50, 0
  v_mov_b32 v51, 0
  v_mov_b32 v52, 0
  v_mov_b32 v53, 0
  v_mov_b32 v54, 0
  v_mov_b32 v55, 0
  v_mov_b32 v56, 0
  v_mov_b32 v57, 0
  v_mov_b32 v58, 0
  v_mov_b32 v59, 0
  v_mov_b32 v60, 0
  v_mov_b32 v61, 0
  v_mov_b32 v62, 0
  v_mov_b32 v63, 0
  v_mov_b32 v64, 0
  v_mov_b32 v65, 0
  v_mov_b32 v66, 0
  v_mov_b32 v67, 0
  v_mov_b32 v68, 0
  v_mov_b32 v69, 0
  v_mov_b32 v70, 0
  v_mov_b32 v71, 0
  s_cmp_eq_u32 s53, 1
  s_cbranch_scc0 chainA_slow
caloop_44:
  buffer_load_dwordx4 v[16:19], v15, s[32:35], s70 offen sc1
  buffer_load_dwordx4 v[20:23], v1, s[32:35], s70 offen sc1
  s_mov_b32 s52, 60000
pl_45:
  s_waitcnt vmcnt(0)
  v_max3_u32 v104, v16, v17, v18
  v_max3_u32 v104, v104, v19, v20
  v_max3_u32 v104, v104, v21, v22
  v_max_u32 v104, v104, v23
  v_cmp_eq_u32 vcc, -1, v104
  s_cbranch_vccz ok_46
  buffer_load_dwordx4 v[16:19], v15, s[32:35], s70 offen sc1
  buffer_load_dwordx4 v[20:23], v1, s[32:35], s70 offen sc1
  s_sub_u32 s52, s52, 1
  s_cbranch_scc0 pl_45
  s_mov_b32 s54, 10
  s_branch k1_fail
ok_46:
  ds_write_b128 v15, v[16:19]
  ds_write_b128 v1, v[20:23]
ok_46_w:
  v_smfmac_f32_16x16x64_bf16 v[44:47], v[16:19], a[0:7], v112
  v_smfmac_f32_16x16x64_bf16 v[48:51], v[16:19], a[56:63], v112
  v_smfmac_f32_16x16x64_bf16 v[52:55], v[16:19], a[112:119], v112
  v_smfmac_f32_16x16x64_bf16 v[56:59], v[16:19], a[168:175], v112
  v_smfmac_f32_16x16x64_bf16 v[60:63], v[16:19], a[224:231], v112
  v_smfmac_f32_16x16x64_bf16 v[64:67], v[16:19], v[144:151], v112
  v_smfmac_f32_16x16x64_bf16 v[68:71], v[16:19], v[200:207], v112
  s_waitcnt vmcnt(0) lgkmcnt(0)
  s_barrier
  ds_read_b128 v[24:27], v106
  ds_read_b128 v[28:31], v107
  ds_read_b128 v[32:35], v108
  ds_read_b128 v[36:39], v109
  ds_read_b128 v[40:43], v110
  v_smfmac_f32_16x16x64_bf16 v[44:47], v[20:23], a[8:15], v112
  s_add_u32 s70, s70, 7168
  buffer_load_dword v113, v8, s[32:35], s66 offen sc1
  v_smfmac_f32_16x16x64_bf16 v[48:51], v[20:23], a[64:71], v112
  v_smfmac_f32_16x16x64_bf16 v[52:55], v[20:23], a[120:127], v112
  v_smfmac_f32_16x16x64_bf16 v[56:59], v[20:23], a[176:183], v112
  v_smfmac_f32_16x16x64_bf16 v[60:63], v[20:23], a[232:239], v112
  v_smfmac_f32_16x16x64_bf16 v[64:67], v[20:23], v[152:159], v112
  v_smfmac_f32_16x16x64_bf16 v[68:71], v[20:23], v[208:215], v112
  s_waitcnt lgkmcnt(4)
  v_smfmac_f32_16x16x64_bf16 v[44:47], v[24:27], a[16:23], v112
  ds_read2_b32 v[72:73], v0 offset0:0 offset1:4
  v_smfmac_f32_16x16x64_bf16 v[48:51], v[24:27], a[72:79], v112
  ds_read2_b32 v[74:75], v0 offset0:1 offset1:5
  v_smfmac_f32_16x16x64_bf16 v[52:55], v[24:27], a[128:135], v112
  ds_read2_b32 v[76:77], v10 offset0:0 offset1:4
  v_smfmac_f32_16x16x64_bf16 v[56:59], v[24:27], a[184:191], v112
  ds_read2_b32 v[78:79], v10 offset0:1 offset1:5
  v_smfmac_f32_16x16x64_bf16 v[60:63], v[24:27], a[240:247], v112
  ds_read2_b32 v[80:81], v14 offset0:0 offset1:4
  v_smfmac_f32_16x16x64_bf16 v[64:67], v[24:27], v[160:167], v112
  ds_read2_b32 v[82:83], v14 offset0:1 offset1:5
  v_smfmac_f32_16x16x64_bf16 v[68:71], v[24:27], v[216:223], v112
  ds_read2_b32 v[84:85], v9 offset0:0 offset1:4
  s_waitcnt lgkmcnt(10)
  v_smfmac_f32_16x16x64_bf16 v[44:47], v[28:31], a[24:31], v112
  v_smfmac_f32_16x16x64_bf16 v[48:51], v[28:31], a[80:87], v112
  ds_read_b128 v[16:19], v11 offset:0
  v_smfmac_f32_16x16x64_bf16 v[52:55], v[28:31], a[136:143], v112
  v_smfmac_f32_16x16x64_bf16 v[56:59], v[28:31], a[192:199], v112
  v_smfmac_f32_16x16x64_bf16 v[60:63], v[28:31], a[248:255], v112
  ds_read_b128 v[20:23], v11 offset:1024
  v_smfmac_f32_16x16x64_bf16 v[64:67], v[28:31], v[168:175], v112
  v_smfmac_f32_16x16x64_bf16 v[68:71], v[28:31], v[224:231], v112
  s_waitcnt lgkmcnt(9)
  v_smfmac_f32_16x16x64_bf16 v[44:47], v[32:35], a[32:39], v112
  v_smfmac_f32_16x16x64_bf16 v[48:51], v[32:35], a[88:95], v112
  ds_read_b128 v[24:27], v11 offset:2048
  v_smfmac_f32_16x16x64_bf16 v[52:55], v[32:35], a[144:151], v112
  v_smfmac_f32_16x16x64_bf16 v[56:59], v[32:35], a[200:207], v112
  v_smfmac_f32_16x16x64_bf16 v[60:63], v[32:35], v[120:127], v112
  ds_read_b128 v[28:31], v11 offset:3072
  v_smfmac_f32_16x16x64_bf16 v[64:67], v[32:35], v[176:183], v112
  v_smfmac_f32_16x16x64_bf16 v[68:71], v[32:35], v[232:239], v112
  v_smfmac_f32_16x16x64_bf16 v[44:47], v[36:39], a[40:47], v112
  v_smfmac_f32_16x16x64_bf16 v[44:47], v[40:43], a[48:55], v112
  ds_read_b128 v[32:35], v11 offset:4096
  v_smfmac_f32_16x16x64_bf16 v[48:51], v[36:39], a[96:103], v112
  v_smfmac_f32_16x16x64_bf16 v[48:51], v[40:43], a[104:111], v112
  v_smfmac_f32_16x16x64_bf16 v[52:55], v[36:39], a[152:159], v112
  v_smfmac_f32_16x16x64_bf16 v[52:55], v[40:43], a[160:167], v112
  s_nop 2
  v_add_f32 v44, v44, v45
  v_add_f32 v46, v46, v47
  v_smfmac_f32_16x16x64_bf16 v[56:59], v[36:39], a[208:215], v112
  v_cvt_pk_bf16_f32 v44, v44, v46
  ds_write_b32 v115, v44 offset:0
  v_smfmac_f32_16x16x64_bf16 v[56:59], v[40:43], a[216:223], v112
  v_add_f32 v48, v48, v49
  v_add_f32 v50, v50, v51
  v_smfmac_f32_16x16x64_bf16 v[60:63], v[36:39], v[128:135], v112
  v_cvt_pk_bf16_f32 v48, v48, v50
  ds_write_b32 v115, v48 offset:64
  v_smfmac_f32_16x16x64_bf16 v[60:63], v[40:43], v[136:143], v112
  ds_read_b64_tr_b16 v[44:45], v116 offset:0
  ds_read_b64_tr_b16 v[46:47], v116 offset:64
  v_smfmac_f32_16x16x64_bf16 v[64:67], v[36:39], v[184:191], v112
  v_add_f32 v52, v52, v53
  v_add_f32 v54, v54, v55
  v_smfmac_f32_16x16x64_bf16 v[64:67], v[40:43], v[192:199], v112
  v_cvt_pk_bf16_f32 v52, v52, v54
  ds_write_b32 v115, v52 offset:512
  v_smfmac_f32_16x16x64_bf16 v[68:71], v[36:39], v[240:247], v112
  v_add_f32 v56, v56, v57
  v_add_f32 v58, v58, v59
  v_smfmac_f32_16x16x64_bf16 v[68:71], v[40:43], v[248:255], v112
  v_cvt_pk_bf16_f32 v56, v56, v58
  ds_write_b32 v115, v56 offset:576
  ds_read_b64_tr_b16 v[52:53], v116 offset:512
  ds_read_b64_tr_b16 v[54:55], v116 offset:576
  ds_read_b128 v[36:39], v11 offset:5120
  ds_read_b64 v[40:41], v12 offset:6144
  ds_read_b64 v[42:43], v12 offset:7168
  v_add_f32 v60, v60, v61
  v_add_f32 v64, v64, v65
  v_add_f32 v62, v62, v63
  v_add_f32 v66, v66, v67
  v_cvt_pk_bf16_f32 v60, v60, v62
  v_cvt_pk_bf16_f32 v64, v64, v66
  ds_write_b32 v115, v60 offset:1024
  ds_write_b32 v115, v64 offset:1088
  ds_read_b64_tr_b16 v[60:61], v116 offset:1024
  ds_read_b64_tr_b16 v[62:63], v116 offset:1088
  s_waitcnt lgkmcnt(11)
  v_mfma_f32_16x16x32_bf16 v[88:91], v[72:75], v[44:47], 0
  v_mfma_f32_16x16x32_bf16 v[92:95], v[16:19], v[44:47], 0
  v_mfma_f32_16x16x32_bf16 v[96:99], v[20:23], v[44:47], 0
  v_add_f32 v68, v68, v69
  v_add_f32 v70, v70, v71
  v_cvt_pk_bf16_f32 v68, v68, v70
  ds_write_b32 v115, v68 offset:1536
  ds_read_b64_tr_b16 v[68:69], v116 offset:1536
  s_waitcnt lgkmcnt(9)
  v_mfma_f32_16x16x32_bf16 v[88:91], v[76:79], v[52:55], v[88:91]
  v_mfma_f32_16x16x32_bf16 v[92:95], v[24:27], v[52:55], v[92:95]
  v_mfma_f32_16x16x32_bf16 v[96:99], v[28:31], v[52:55], v[96:99]
  s_waitcnt lgkmcnt(2)
  v_mfma_f32_16x16x32_bf16 v[88:91], v[80:83], v[60:63], v[88:91]
  v_mfma_f32_16x16x32_bf16 v[92:95], v[32:35], v[60:63], v[92:95]
  v_mfma_f32_16x16x32_bf16 v[96:99], v[36:39], v[60:63], v[96:99]
  s_waitcnt lgkmcnt(0)
  v_mfma_f32_16x16x16_bf16 v[88:91], v[84:85], v[68:69], v[88:91]
  v_mfma_f32_16x16x16_bf16 v[92:95], v[40:41], v[68:69], v[92:95]
  v_mfma_f32_16x16x16_bf16 v[96:99], v[42:43], v[68:69], v[96:99]
  s_nop 5
  ds_write_b128 v3, v[88:91] offset:0
  ds_write_b128 v3, v[92:95] offset:64
  ds_write_b128 v3, v[96:99] offset:128
  s_waitcnt lgkmcnt(0)
  s_barrier
  s_cmp_lt_u32 s48, 2
  s_cbranch_scc0 nosm_47
  ds_read2st64_b64 v[88:91], v4 offset0:0 offset1:7
  ds_read2st64_b64 v[92:95], v4 offset0:14 offset1:21
  ds_read2st64_b64 v[96:99], v5 offset0:0 offset1:7
  ds_read2st64_b64 v[100:103], v5 offset0:14 offset1:21
  s_waitcnt lgkmcnt(2)
  v_pk_add_f32 v[88:89], v[88:89], v[90:91]
  v_pk_add_f32 v[92:93], v[92:93], v[94:95]
  s_waitcnt lgkmcnt(0)
  v_pk_add_f32 v[96:97], v[96:97], v[98:99]
  v_pk_add_f32 v[100:101], v[100:101], v[102:103]
  v_pk_add_f32 v[88:89], v[88:89], v[92:93]
  v_pk_add_f32 v[96:97], v[96:97], v[100:101]
  v_exp_f32 v92, v88
  v_exp_f32 v93, v89
  v_max3_f32 v90, abs(v88), abs(v89), abs(v96)
  v_exp_f32 v100, v96
  v_exp_f32 v101, v97
  v_max_f32 v90, v90, abs(v97)
  v_cmp_nge_f32 vcc, s80, v90
  s_cbranch_vccnz smx_48
smb_49:
  v_add_f32 v90, v92, v93
  v_add_f32 v91, v100, v101
  v_fmac_f32 v90, v114, v91
  s_nop 1
  v_add_f32_dpp v90, v90, v90 quad_perm:[1,0,3,2] row_mask:0xf bank_mask:0xf
  s_nop 1
  v_add_f32_dpp v90, v90, v90 quad_perm:[2,3,0,1] row_mask:0xf bank_mask:0xf
  s_nop 1
  v_add_f32_dpp v90, v90, v90 row_half_mirror row_mask:0xf bank_mask:0xf
  s_nop 1
  v_add_f32_dpp v90, v90, v90 row_mirror row_mask:0xf bank_mask:0xf
  v_rcp_f32 v90, v90
  s_nop 0
  v_pk_mul_f32 v[92:93], v[92:93], v[90:91] op_sel_hi:[1,0]
  v_pk_mul_f32 v[100:101], v[100:101], v[90:91] op_sel_hi:[1,0]
  v_cvt_pk_bf16_f32 v88, v92, v93
  v_cvt_pk_bf16_f32 v96, v100, v101
  v_min_u32 v88, -2, v88
  v_min_u32 v96, -2, v96
sms_50:
  buffer_store_dword v88, v6, s[32:35], s60 offen
  buffer_store_dword v96, v7, s[32:35], s60 offen
nosm_47:
  s_barrier
  s_add_u32 s60, s60, 10240
  s_add_u32 s40, s40, 1
  s_cmp_ge_u32 s40, 63
  s_cbranch_scc1 caend_51
  v_mov_b32 v44, 0
  v_mov_b32 v45, 0
  v_mov_b32 v46, 0
  v_mov_b32 v47, 0
  v_mov_b32 v48, 0
  v_mov_b32 v49, 0
  v_mov_b32 v50, 0
  v_mov_b32 v51, 0
  v_mov_b32 v52, 0
  v_mov_b32 v53, 0
  v_mov_b32 v54, 0
  v_mov_b32 v55, 0
  v_mov_b32 v56, 0
  v_mov_b32 v57, 0
  v_mov_b32 v58, 0
  v_mov_b32 v59, 0
  v_mov_b32 v60, 0
  v_mov_b32 v61, 0
  v_mov_b32 v62, 0
  v_mov_b32 v63, 0
  v_mov_b32 v64, 0
  v_mov_b32 v65, 0
  v_mov_b32 v66, 0
  v_mov_b32 v67, 0
  v_mov_b32 v68, 0
  v_mov_b32 v69, 0
  v_mov_b32 v70, 0
  v_mov_b32 v71, 0
  s_waitcnt vmcnt(0)
  v_cmp_gt_u32 vcc, s58, v113
  s_cbranch_vccz fxok_52
  s_mov_b32 s52, 60000
poll_53:
  buffer_load_dword v113, v8, s[32:35], s66 offen sc1
  s_waitcnt vmcnt(0)
  v_cmp_ne_u32 vcc, 1, v113
  s_cbranch_vccz pok_54
  s_sleep 1
  s_sub_u32 s52, s52, 1
  s_cbranch_scc0 poll_53
  s_mov_b32 s54, 13
  s_branch k1_fail
pok_54:
fxok_52:
  s_add_u32 m0, s67, 0
  s_nop 0
  buffer_load_dwordx4 v117, s[32:35], s62 offen sc1 lds
  s_add_u32 m0, s67, 1024
  s_nop 0
  buffer_load_dwordx4 v117, s[32:35], s63 offen sc1 lds
  s_add_u32 m0, s67, 2048
  s_nop 0
  buffer_load_dwordx4 v118, s[32:35], s62 offen sc1 lds
  s_add_u32 m0, s67, 3072
  s_nop 0
  buffer_load_dwordx4 v118, s[32:35], s63 offen sc1 lds
  s_add_u32 m0, s67, 4096
  s_nop 0
  buffer_load_dwordx4 v119, s[32:35], s62 offen sc1 lds
  s_add_u32 m0, s67, 5120
  s_nop 0
  buffer_load_dwordx4 v119, s[32:35], s63 offen sc1 lds
  s_add_u32 m0, s67, 6144
  s_nop 0
  buffer_load_dwordx4 v13, s[32:35], s62 offen sc1 lds
  s_add_u32 m0, s67, 7168
  s_nop 0
  buffer_load_dwordx4 v13, s[32:35], s63 offen sc1 lds
  s_add_u32 s62, s62, 28672
  s_add_u32 s63, s63, 28672
  s_add_u32 s66, s66, 3584
  s_branch caloop_44
caend_51:
  s_endpgm
smx_48:
  v_max_f32 v90, v88, v89
  v_max3_f32 v90, v90, v96, v97
  s_nop 1
  v_max_f32_dpp v90, v90, v90 quad_perm:[1,0,3,2] row_mask:0xf bank_mask:0xf
  s_nop 1
  v_max_f32_dpp v90, v90, v90 quad_perm:[2,3,0,1] row_mask:0xf bank_mask:0xf
  s_nop 1
  v_max_f32_dpp v90, v90, v90 row_half_mirror row_mask:0xf bank_mask:0xf
  s_nop 1
  v_max_f32_dpp v90, v90, v90 row_mirror row_mask:0xf bank_mask:0xf
  v_sub_f32 v100, v96, v90
  v_sub_f32 v101, v97, v90
  v_sub_f32 v92, v88, v90
  v_sub_f32 v93, v89, v90
  v_exp_f32 v100, v100
  v_exp_f32 v101, v101
  v_exp_f32 v92, v92
  v_exp_f32 v93, v93
  s_nop 0
  v_add_f32 v90, v92, v93
  v_add_f32 v91, v100, v101
  v_fmac_f32 v90, v114, v91
  s_nop 1
  v_add_f32_dpp v90, v90, v90 quad_perm:[1,0,3,2] row_mask:0xf bank_mask:0xf
  s_nop 1
  v_add_f32_dpp v90, v90, v90 quad_perm:[2,3,0,1] row_mask:0xf bank_mask:0xf
  s_nop 1
  v_add_f32_dpp v90, v90, v90 row_half_mirror row_mask:0xf bank_mask:0xf
  s_nop 1
  v_add_f32_dpp v90, v90, v90 row_mirror row_mask:0xf bank_mask:0xf
  v_rcp_f32 v90, v90
  s_nop 0
  v_pk_mul_f32 v[92:93], v[92:93], v[90:91] op_sel_hi:[1,0]
  v_pk_mul_f32 v[100:101], v[100:101], v[90:91] op_sel_hi:[1,0]
  v_cvt_pk_bf16_f32 v88, v92, v93
  v_cvt_pk_bf16_f32 v96, v100, v101
  v_min_u32 v88, -2, v88
  v_min_u32 v96, -2, v96
  s_branch sms_50
chainA_slow:
caloop_55:
  buffer_load_dwordx4 v[16:19], v15, s[32:35], s70 offen sc1
  buffer_load_dwordx4 v[20:23], v1, s[32:35], s70 offen sc1
  s_mov_b32 s52, 60000
pl_56:
  s_waitcnt vmcnt(0)
  v_max3_u32 v104, v16, v17, v18
  v_max3_u32 v104, v104, v19, v20
  v_max3_u32 v104, v104, v21, v22
  v_max_u32 v104, v104, v23
  v_cmp_eq_u32 vcc, -1, v104
  s_cbranch_vccz ok_57
  buffer_load_dwordx4 v[16:19], v15, s[32:35], s70 offen sc1
  buffer_load_dwordx4 v[20:23], v1, s[32:35], s70 offen sc1
  s_sub_u32 s52, s52, 1
  s_cbranch_scc0 pl_56
  s_mov_b32 s54, 10
  s_branch k1_fail
ok_57:
  ds_write_b128 v15, v[16:19]
  ds_write_b128 v1, v[20:23]
ok_57_w:
  v_smfmac_f32_16x16x64_bf16 v[44:47], v[16:19], a[0:7], v112
  v_smfmac_f32_16x16x64_bf16 v[48:51], v[16:19], a[56:63], v112
  v_smfmac_f32_16x16x64_bf16 v[52:55], v[16:19], a[112:119], v112
  v_smfmac_f32_16x16x64_bf16 v[56:59], v[16:19], a[168:175], v112
  v_smfmac_f32_16x16x64_bf16 v[60:63], v[16:19], a[224:231], v112
  v_smfmac_f32_16x16x64_bf16 v[64:67], v[16:19], v[144:151], v112
  v_smfmac_f32_16x16x64_bf16 v[68:71], v[16:19], v[200:207], v112
  s_waitcnt vmcnt(0) lgkmcnt(0)
  s_barrier
  ds_read_b128 v[24:27], v106
  ds_read_b128 v[28:31], v107
  ds_read_b128 v[32:35], v108
  ds_read_b128 v[36:39], v109
  ds_read_b128 v[40:43], v110
  v_smfmac_f32_16x16x64_bf16 v[44:47], v[20:23], a[8:15], v112
  s_add_u32 s70, s70, 7168
  buffer_load_dword v113, v8, s[32:35], s66 offen sc1
  v_smfmac_f32_16x16x64_bf16 v[48:51], v[20:23], a[64:71], v112
  v_smfmac_f32_16x16x64_bf16 v[52:55], v[20:23], a[120:127], v112
  v_smfmac_f32_16x16x64_bf16 v[56:59], v[20:23], a[176:183], v112
  v_smfmac_f32_16x16x64_bf16 v[60:63], v[20:23], a[232:239], v112
  v_smfmac_f32_16x16x64_bf16 v[64:67], v[20:23], v[152:159], v112
  v_smfmac_f32_16x16x64_bf16 v[68:71], v[20:23], v[208:215], v112
  s_waitcnt lgkmcnt(4)
  v_smfmac_f32_16x16x64_bf16 v[44:47], v[24:27], a[16:23], v112
  ds_read2_b32 v[72:73], v0 offset0:0 offset1:4
  v_smfmac_f32_16x16x64_bf16 v[48:51], v[24:27], a[72:79], v112
  ds_read2_b32 v[74:75], v0 offset0:1 offset1:5
  v_smfmac_f32_16x16x64_bf16 v[52:55], v[24:27], a[128:135], v112
  ds_read2_b32 v[76:77], v10 offset0:0 offset1:4
  v_smfmac_f32_16x16x64_bf16 v[56:59], v[24:27], a[184:191], v112
  ds_read2_b32 v[78:79], v10 offset0:1 offset1:5
  v_smfmac_f32_16x16x64_bf16 v[60:63], v[24:27], a[240:247], v112
  ds_read2_b32 v[80:81], v14 offset0:0 offset1:4
  v_smfmac_f32_16x16x64_bf16 v[64:67], v[24:27], v[160:167], v112
  ds_read2_b32 v[82:83], v14 offset0:1 offset1:5
  v_smfmac_f32_16x16x64_bf16 v[68:71], v[24:27], v[216:223], v112
  ds_read2_b32 v[84:85], v9 offset0:0 offset1:4
  s_waitcnt lgkmcnt(10)
  v_smfmac_f32_16x16x64_bf16 v[44:47], v[28:31], a[24:31], v112
  v_smfmac_f32_16x16x64_bf16 v[48:51], v[28:31], a[80:87], v112
  ds_read_b128 v[16:19], v11 offset:0
  v_smfmac_f32_16x16x64_bf16 v[52:55], v[28:31], a[136:143], v112
  v_smfmac_f32_16x16x64_bf16 v[56:59], v[28:31], a[192:199], v112
  v_smfmac_f32_16x16x64_bf16 v[60:63], v[28:31], a[248:255], v112
  ds_read_b128 v[20:23], v11 offset:1024
  v_smfmac_f32_16x16x64_bf16 v[64:67], v[28:31], v[168:175], v112
  v_smfmac_f32_16x16x64_bf16 v[68:71], v[28:31], v[224:231], v112
  s_waitcnt lgkmcnt(9)
  v_smfmac_f32_16x16x64_bf16 v[44:47], v[32:35], a[32:39], v112
  v_smfmac_f32_16x16x64_bf16 v[48:51], v[32:35], a[88:95], v112
  ds_read_b128 v[24:27], v11 offset:2048
  v_smfmac_f32_16x16x64_bf16 v[52:55], v[32:35], a[144:151], v112
  v_smfmac_f32_16x16x64_bf16 v[56:59], v[32:35], a[200:207], v112
  v_smfmac_f32_16x16x64_bf16 v[60:63], v[32:35], v[120:127], v112
  ds_read_b128 v[28:31], v11 offset:3072
  v_smfmac_f32_16x16x64_bf16 v[64:67], v[32:35], v[176:183], v112
  v_smfmac_f32_16x16x64_bf16 v[68:71], v[32:35], v[232:239], v112
  v_smfmac_f32_16x16x64_bf16 v[44:47], v[36:39], a[40:47], v112
  v_smfmac_f32_16x16x64_bf16 v[44:47], v[40:43], a[48:55], v112
  ds_read_b128 v[32:35], v11 offset:4096
  v_smfmac_f32_16x16x64_bf16 v[48:51], v[36:39], a[96:103], v112
  v_smfmac_f32_16x16x64_bf16 v[48:51], v[40:43], a[104:111], v112
  v_smfmac_f32_16x16x64_bf16 v[52:55], v[36:39], a[152:159], v112
  v_smfmac_f32_16x16x64_bf16 v[52:55], v[40:43], a[160:167], v112
  s_nop 2
  v_add_f32 v44, v44, v45
  v_add_f32 v46, v46, v47
  v_smfmac_f32_16x16x64_bf16 v[56:59], v[36:39], a[208:215], v112
  v_cvt_pk_bf16_f32 v44, v44, v46
  ds_write_b32 v115, v44 offset:0
  v_smfmac_f32_16x16x64_bf16 v[56:59], v[40:43], a[216:223], v112
  v_add_f32 v48, v48, v49
  v_add_f32 v50, v50, v51
  v_smfmac_f32_16x16x64_bf16 v[60:63], v[36:39], v[128:135], v112
  v_cvt_pk_bf16_f32 v48, v48, v50
  ds_write_b32 v115, v48 offset:64
  v_smfmac_f32_16x16x64_bf16 v[60:63], v[40:43], v[136:143], v112
  ds_read_b64_tr_b16 v[44:45], v116 offset:0
  ds_read_b64_tr_b16 v[46:47], v116 offset:64
  v_smfmac_f32_16x16x64_bf16 v[64:67], v[36:39], v[184:191], v112
  v_add_f32 v52, v52, v53
  v_add_f32 v54, v54, v55
  v_smfmac_f32_16x16x64_bf16 v[64:67], v[40:43], v[192:199], v112
  v_cvt_pk_bf16_f32 v52, v52, v54
  ds_write_b32 v115, v52 offset:512
  v_smfmac_f32_16x16x64_bf16 v[68:71], v[36:39], v[240:247], v112
  v_add_f32 v56, v56, v57
  v_add_f32 v58, v58, v59
  v_smfmac_f32_16x16x64_bf16 v[68:71], v[40:43], v[248:255], v112
  v_cvt_pk_bf16_f32 v56, v56, v58
  ds_write_b32 v115, v56 offset:576
  ds_read_b64_tr_b16 v[52:53], v116 offset:512
  ds_read_b64_tr_b16 v[54:55], v116 offset:576
  ds_read_b128 v[36:39], v11 offset:5120
  ds_read_b64 v[40:41], v12 offset:6144
  ds_read_b64 v[42:43], v12 offset:7168
  v_add_f32 v60, v60, v61
  v_add_f32 v64, v64, v65
  v_add_f32 v62, v62, v63
  v_add_f32 v66, v66, v67
  v_cvt_pk_bf16_f32 v60, v60, v62
  v_cvt_pk_bf16_f32 v64, v64, v66
  ds_write_b32 v115, v60 offset:1024
  ds_write_b32 v115, v64 offset:1088
  ds_read_b64_tr_b16 v[60:61], v116 offset:1024
  ds_read_b64_tr_b16 v[62:63], v116 offset:1088
  s_waitcnt lgkmcnt(11)
  v_mfma_f32_16x16x32_bf16 v[88:91], v[72:75], v[44:47], 0
  v_mfma_f32_16x16x32_bf16 v[92:95], v[16:19], v[44:47], 0
  v_mfma_f32_16x16x32_bf16 v[96:99], v[20:23], v[44:47], 0
  v_add_f32 v68, v68, v69
  v_add_f32 v70, v70, v71
  v_cvt_pk_bf16_f32 v68, v68, v70
  ds_write_b32 v115, v68 offset:1536
  ds_read_b64_tr_b16 v[68:69], v116 offset:1536
  s_waitcnt lgkmcnt(9)
  v_mfma_f32_16x16x32_bf16 v[88:91], v[76:79], v[52:55], v[88:91]
  v_mfma_f32_16x16x32_bf16 v[92:95], v[24:27], v[52:55], v[92:95]
  v_mfma_f32_16x16x32_bf16 v[96:99], v[28:31], v[52:55], v[96:99]
  s_waitcnt lgkmcnt(2)
  v_mfma_f32_16x16x32_bf16 v[88:91], v[80:83], v[60:63], v[88:91]
  v_mfma_f32_16x16x32_bf16 v[92:95], v[32:35], v[60:63], v[92:95]
  v_mfma_f32_16x16x32_bf16 v[96:99], v[36:39], v[60:63], v[96:99]
  s_waitcnt lgkmcnt(0)
  v_mfma_f32_16x16x16_bf16 v[88:91], v[84:85], v[68:69], v[88:91]
  v_mfma_f32_16x16x16_bf16 v[92:95], v[40:41], v[68:69], v[92:95]
  v_mfma_f32_16x16x16_bf16 v[96:99], v[42:43], v[68:69], v[96:99]
  s_nop 5
  ds_write_b128 v3, v[88:91] offset:0
  ds_write_b128 v3, v[92:95] offset:64
  ds_write_b128 v3, v[96:99] offset:128
  s_waitcnt lgkmcnt(0)
  s_barrier
  s_cmp_lt_u32 s48, 2
  s_cbranch_scc0 nosm_58
  ds_read2st64_b64 v[88:91], v4 offset0:0 offset1:7
  ds_read2st64_b64 v[92:95], v4 offset0:14 offset1:21
  ds_read2st64_b64 v[96:99], v5 offset0:0 offset1:7
  ds_read2st64_b64 v[100:103], v5 offset0:14 offset1:21
  s_waitcnt lgkmcnt(2)
  v_pk_add_f32 v[88:89], v[88:89], v[90:91]
  v_pk_add_f32 v[92:93], v[92:93], v[94:95]
  s_waitcnt lgkmcnt(0)
  v_pk_add_f32 v[96:97], v[96:97], v[98:99]
  v_pk_add_f32 v[100:101], v[100:101], v[102:103]
  v_pk_add_f32 v[88:89], v[88:89], v[92:93]
  v_pk_add_f32 v[96:97], v[96:97], v[100:101]
  v_exp_f32 v92, v88
  v_exp_f32 v93, v89
  v_max3_f32 v90, abs(v88), abs(v89), abs(v96)
  v_exp_f32 v100, v96
  v_exp_f32 v101, v97
  v_max_f32 v90, v90, abs(v97)
  v_cmp_nge_f32 vcc, s80, v90
  s_cbranch_vccnz smx_59
smb_60:
  v_add_f32 v90, v92, v93
  v_add_f32 v91, v100, v101
  v_fmac_f32 v90, v114, v91
  s_nop 1
  v_add_f32_dpp v90, v90, v90 quad_perm:[1,0,3,2] row_mask:0xf bank_mask:0xf
  s_nop 1
  v_add_f32_dpp v90, v90, v90 quad_perm:[2,3,0,1] row_mask:0xf bank_mask:0xf
  s_nop 1
  v_add_f32_dpp v90, v90, v90 row_half_mirror row_mask:0xf bank_mask:0xf
  s_nop 1
  v_add_f32_dpp v90, v90, v90 row_mirror row_mask:0xf bank_mask:0xf
  v_rcp_f32 v90, v90
  s_nop 0
  v_pk_mul_f32 v[92:93], v[92:93], v[90:91] op_sel_hi:[1,0]
  v_pk_mul_f32 v[100:101], v[100:101], v[90:91] op_sel_hi:[1,0]
  v_cvt_pk_bf16_f32 v88, v92, v93
  v_cvt_pk_bf16_f32 v96, v100, v101
  v_min_u32 v88, -2, v88
  v_min_u32 v96, -2, v96
sms_61:
  buffer_store_dword v88, v6, s[32:35], s60 offen sc1
  buffer_store_dword v96, v7, s[32:35], s60 offen sc1
nosm_58:
  s_barrier
  s_add_u32 s60, s60, 10240
  s_add_u32 s40, s40, 1
  s_cmp_ge_u32 s40, 63
  s_cbranch_scc1 caend_62
  v_mov_b32 v44, 0
  v_mov_b32 v45, 0
  v_mov_b32 v46, 0
  v_mov_b32 v47, 0
  v_mov_b32 v48, 0
  v_mov_b32 v49, 0
  v_mov_b32 v50, 0
  v_mov_b32 v51, 0
  v_mov_b32 v52, 0
  v_mov_b32 v53, 0
  v_mov_b32 v54, 0
  v_mov_b32 v55, 0
  v_mov_b32 v56, 0
  v_mov_b32 v57, 0
  v_mov_b32 v58, 0
  v_mov_b32 v59, 0
  v_mov_b32 v60, 0
  v_mov_b32 v61, 0
  v_mov_b32 v62, 0
  v_mov_b32 v63, 0
  v_mov_b32 v64, 0
  v_mov_b32 v65, 0
  v_mov_b32 v66, 0
  v_mov_b32 v67, 0
  v_mov_b32 v68, 0
  v_mov_b32 v69, 0
  v_mov_b32 v70, 0
  v_mov_b32 v71, 0
  s_waitcnt vmcnt(0)
  v_cmp_gt_u32 vcc, s58, v113
  s_cbranch_vccz fxok_63
  s_mov_b32 s52, 60000
poll_64:
  buffer_load_dword v113, v8, s[32:35], s66 offen sc1
  s_waitcnt vmcnt(0)
  v_cmp_ne_u32 vcc, 1, v113
  s_cbranch_vccz pok_65
  s_sleep 1
  s_sub_u32 s52, s52, 1
  s_cbranch_scc0 poll_64
  s_mov_b32 s54, 13
  s_branch k1_fail
pok_65:
fxok_63:
  s_add_u32 m0, s67, 0
  s_nop 0
  buffer_load_dwordx4 v117, s[32:35], s62 offen sc1 lds
  s_add_u32 m0, s67, 1024
  s_nop 0
  buffer_load_dwordx4 v117, s[32:35], s63 offen sc1 lds
  s_add_u32 m0, s67, 2048
  s_nop 0
  buffer_load_dwordx4 v118, s[32:35], s62 offen sc1 lds
  s_add_u32 m0, s67, 3072
  s_nop 0
  buffer_load_dwordx4 v118, s[32:35], s63 offen sc1 lds
  s_add_u32 m0, s67, 4096
  s_nop 0
  buffer_load_dwordx4 v119, s[32:35], s62 offen sc1 lds
  s_add_u32 m0, s67, 5120
  s_nop 0
  buffer_load_dwordx4 v119, s[32:35], s63 offen sc1 lds
  s_add_u32 m0, s67, 6144
  s_nop 0
  buffer_load_dwordx4 v13, s[32:35], s62 offen sc1 lds
  s_add_u32 m0, s67, 7168
  s_nop 0
  buffer_load_dwordx4 v13, s[32:35], s63 offen sc1 lds
  s_add_u32 s62, s62, 28672
  s_add_u32 s63, s63, 28672
  s_add_u32 s66, s66, 3584
  s_branch caloop_55
caend_62:
  s_endpgm
smx_59:
  v_max_f32 v90, v88, v89
  v_max3_f32 v90, v90, v96, v97
  s_nop 1
  v_max_f32_dpp v90, v90, v90 quad_perm:[1,0,3,2] row_mask:0xf bank_mask:0xf
  s_nop 1
  v_max_f32_dpp v90, v90, v90 quad_perm:[2,3,0,1] row_mask:0xf bank_mask:0xf
  s_nop 1
  v_max_f32_dpp v90, v90, v90 row_half_mirror row_mask:0xf bank_mask:0xf
  s_nop 1
  v_max_f32_dpp v90, v90, v90 row_mirror row_mask:0xf bank_mask:0xf
  v_sub_f32 v100, v96, v90
  v_sub_f32 v101, v97, v90
  v_sub_f32 v92, v88, v90
  v_sub_f32 v93, v89, v90
  v_exp_f32 v100, v100
  v_exp_f32 v101, v101
  v_exp_f32 v92, v92
  v_exp_f32 v93, v93
  s_nop 0
  v_add_f32 v90, v92, v93
  v_add_f32 v91, v100, v101
  v_fmac_f32 v90, v114, v91
  s_nop 1
  v_add_f32_dpp v90, v90, v90 quad_perm:[1,0,3,2] row_mask:0xf bank_mask:0xf
  s_nop 1
  v_add_f32_dpp v90, v90, v90 quad_perm:[2,3,0,1] row_mask:0xf bank_mask:0xf
  s_nop 1
  v_add_f32_dpp v90, v90, v90 row_half_mirror row_mask:0xf bank_mask:0xf
  s_nop 1
  v_add_f32_dpp v90, v90, v90 row_mirror row_mask:0xf bank_mask:0xf
  v_rcp_f32 v90, v90
  s_nop 0
  v_pk_mul_f32 v[92:93], v[92:93], v[90:91] op_sel_hi:[1,0]
  v_pk_mul_f32 v[100:101], v[100:101], v[90:91] op_sel_hi:[1,0]
  v_cvt_pk_bf16_f32 v88, v92, v93
  v_cvt_pk_bf16_f32 v96, v100, v101
  v_min_u32 v88, -2, v88
  v_min_u32 v96, -2, v96
  s_branch sms_61
r_chainB:
  s_sub_u32 s60, s50, 16
  s_lshl_b32 s44, s60, 1
  s_add_u32 s44, s44, 0
  s_lshl_b32 s44, s44, 4
  s_lshl_b32 s45, s48, 2
  s_add_u32 s44, s44, s45
  s_add_u32 s44, s44, 0
  s_mul_i32 s44, s44, 14336
  s_add_u32 s44, s44, 6422528
  s_add_u32 s45, s44, 0
  buffer_load_dwordx4 a[32:35], v2, s[32:35], s45 offen
  s_add_u32 s45, s44, 1024
  buffer_load_dwordx4 a[36:39], v2, s[32:35], s45 offen
  s_add_u32 s45, s44, 2048
  buffer_load_dwordx4 a[96:99], v2, s[32:35], s45 offen
  s_add_u32 s45, s44, 3072
  buffer_load_dwordx4 a[100:103], v2, s[32:35], s45 offen
  s_add_u32 s45, s44, 4096
  s_lshl_b32 s47, s48, 15
  s_add_u32 m0, s47, 0
  s_nop 0
  buffer_load_dwordx4 v2, s[32:35], s45 offen lds
  s_add_u32 s45, s44, 5120
  s_lshl_b32 s47, s48, 15
  s_add_u32 m0, s47, 1024
  s_nop 0
  buffer_load_dwordx4 v2, s[32:35], s45 offen lds
  s_add_u32 s45, s44, 6144
  buffer_load_dwordx4 a[160:163], v2, s[32:35], s45 offen
  s_add_u32 s45, s44, 7168
  buffer_load_dwordx4 a[164:167], v2, s[32:35], s45 offen
  s_add_u32 s45, s44, 8192
  buffer_load_dwordx4 a[224:227], v2, s[32:35], s45 offen
  s_add_u32 s45, s44, 9216
  buffer_load_dwordx4 a[228:231], v2, s[32:35], s45 offen
  s_add_u32 s45, s44, 10240
  s_lshl_b32 s47, s48, 15
  s_add_u32 m0, s47, 16384
  s_nop 0
  buffer_load_dwordx4 v2, s[32:35], s45 offen lds
  s_add_u32 s45, s44, 11264
  s_lshl_b32 s47, s48, 15
  s_add_u32 m0, s47, 17408
  s_nop 0
  buffer_load_dwordx4 v2, s[32:35], s45 offen lds
  s_add_u32 s45, s44, 12288
  buffer_load_dwordx4 v[192:195], v2, s[32:35], s45 offen
  s_add_u32 s45, s44, 13312
  buffer_load_dwordx4 v[196:199], v2, s[32:35], s45 offen
  s_lshl_b32 s44, s60, 1
  s_add_u32 s44, s44, 1
  s_lshl_b32 s44, s44, 4
  s_lshl_b32 s45, s48, 2
  s_add_u32 s44, s44, s45
  s_add_u32 s44, s44, 0
  s_mul_i32 s44, s44, 14336
  s_add_u32 s44, s44, 6422528
  s_add_u32 s45, s44, 0
  buffer_load_dwordx4 a[40:43], v2, s[32:35], s45 offen
  s_add_u32 s45, s44, 1024
  buffer_load_dwordx4 a[44:47], v2, s[32:35], s45 offen
  s_add_u32 s45, s44, 2048
  buffer_load_dwordx4 a[104:107], v2, s[32:35], s45 offen
  s_add_u32 s45, s44, 3072
  buffer_load_dwordx4 a[108:111], v2, s[32:35], s45 offen
  s_add_u32 s45, s44, 4096
  s_lshl_b32 s47, s48, 15
  s_add_u32 m0, s47, 2048
  s_nop 0
  buffer_load_dwordx4 v2, s[32:35], s45 offen lds
  s_add_u32 s45, s44, 5120
  s_lshl_b32 s47, s48, 15
  s_add_u32 m0, s47, 3072
  s_nop 0
  buffer_load_dwordx4 v2, s[32:35], s45 offen lds
  s_add_u32 s45, s44, 6144
  buffer_load_dwordx4 a[168:171], v2, s[32:35], s45 offen
  s_add_u32 s45, s44, 7168
  buffer_load_dwordx4 a[172:175], v2, s[32:35], s45 offen
  s_add_u32 s45, s44, 8192
  buffer_load_dwordx4 a[232:235], v2, s[32:35], s45 offen
  s_add_u32 s45, s44, 9216
  buffer_load_dwordx4 a[236:239], v2, s[32:35], s45 offen
  s_add_u32 s45, s44, 10240
  s_lshl_b32 s47, s48, 15
  s_add_u32 m0, s47, 18432
  s_nop 0
  buffer_load_dwordx4 v2, s[32:35], s45 offen lds
  s_add_u32 s45, s44, 11264
  s_lshl_b32 s47, s48, 15
  s_add_u32 m0, s47, 19456
  s_nop 0
  buffer_load_dwordx4 v2, s[32:35], s45 offen lds
  s_add_u32 s45, s44, 12288
  buffer_load_dwordx4 v[200:203], v2, s[32:35], s45 offen
  s_add_u32 s45, s44, 13312
  buffer_load_dwordx4 v[204:207], v2, s[32:35], s45 offen
  s_lshl_b32 s44, s60, 1
  s_add_u32 s44, s44, 0
  s_lshl_b32 s44, s44, 4
  s_lshl_b32 s45, s48, 2
  s_add_u32 s44, s44, s45
  s_add_u32 s44, s44, 1
  s_mul_i32 s44, s44, 14336
  s_add_u32 s44, s44, 6422528
  s_add_u32 s45, s44, 0
  buffer_load_dwordx4 a[48:51], v2, s[32:35], s45 offen
  s_add_u32 s45, s44, 1024
  buffer_load_dwordx4 a[52:55], v2, s[32:35], s45 offen
  s_add_u32 s45, s44, 2048
  buffer_load_dwordx4 a[112:115], v2, s[32:35], s45 offen
  s_add_u32 s45, s44, 3072
  buffer_load_dwordx4 a[116:119], v2, s[32:35], s45 offen
  s_add_u32 s45, s44, 4096
  s_lshl_b32 s47, s48, 15
  s_add_u32 m0, s47, 4096
  s_nop 0
  buffer_load_dwordx4 v2, s[32:35], s45 offen lds
  s_add_u32 s45, s44, 5120
  s_lshl_b32 s47, s48, 15
  s_add_u32 m0, s47, 5120
  s_nop 0
  buffer_load_dwordx4 v2, s[32:35], s45 offen lds
  s_add_u32 s45, s44, 6144
  buffer_load_dwordx4 a[176:179], v2, s[32:35], s45 offen
  s_add_u32 s45, s44, 7168
  buffer_load_dwordx4 a[180:183], v2, s[32:35], s45 offen
  s_add_u32 s45, s44, 8192
  buffer_load_dwordx4 a[240:243], v2, s[32:35], s45 offen
  s_add_u32 s45, s44, 9216
  buffer_load_dwordx4 a[244:247], v2, s[32:35], s45 offen
  s_add_u32 s45, s44, 10240
  s_lshl_b32 s47, s48, 15
  s_add_u32 m0, s47, 20480
  s_nop 0
  buffer_load_dwordx4 v2, s[32:35], s45 offen lds
  s_add_u32 s45, s44, 11264
  s_lshl_b32 s47, s48, 15
  s_add_u32 m0, s47, 21504
  s_nop 0
  buffer_load_dwordx4 v2, s[32:35], s45 offen lds
  s_add_u32 s45, s44, 12288
  buffer_load_dwordx4 v[208:211], v2, s[32:35], s45 offen
  s_add_u32 s45, s44, 13312
  buffer_load_dwordx4 v[212:215], v2, s[32:35], s45 offen
  s_lshl_b32 s44, s60, 1
  s_add_u32 s44, s44, 1
  s_lshl_b32 s44, s44, 4
  s_lshl_b32 s45, s48, 2
  s_add_u32 s44, s44, s45
  s_add_u32 s44, s44, 1
  s_mul_i32 s44, s44, 14336
  s_add_u32 s44, s44, 6422528
  s_add_u32 s45, s44, 0
  buffer_load_dwordx4 a[56:59], v2, s[32:35], s45 offen
  s_add_u32 s45, s44, 1024
  buffer_load_dwordx4 a[60:63], v2, s[32:35], s45 offen
  s_add_u32 s45, s44, 2048
  buffer_load_dwordx4 a[120:123], v2, s[32:35], s45 offen
  s_add_u32 s45, s44, 3072
  buffer_load_dwordx4 a[124:127], v2, s[32:35], s45 offen
  s_add_u32 s45, s44, 4096
  s_lshl_b32 s47, s48, 15
  s_add_u32 m0, s47, 6144
  s_nop 0
  buffer_load_dwordx4 v2, s[32:35], s45 offen lds
  s_add_u32 s45, s44, 5120
  s_lshl_b32 s47, s48, 15
  s_add_u32 m0, s47, 7168
  s_nop 0
  buffer_load_dwordx4 v2, s[32:35], s45 offen lds
  s_add_u32 s45, s44, 6144
  buffer_load_dwordx4 a[184:187], v2, s[32:35], s45 offen
  s_add_u32 s45, s44, 7168
  buffer_load_dwordx4 a[188:191], v2, s[32:35], s45 offen
  s_add_u32 s45, s44, 8192
  buffer_load_dwordx4 a[248:251], v2, s[32:35], s45 offen
  s_add_u32 s45, s44, 9216
  buffer_load_dwordx4 a[252:255], v2, s[32:35], s45 offen
  s_add_u32 s45, s44, 10240
  s_lshl_b32 s47, s48, 15
  s_add_u32 m0, s47, 22528
  s_nop 0
  buffer_load_dwordx4 v2, s[32:35], s45 offen lds
  s_add_u32 s45, s44, 11264
  s_lshl_b32 s47, s48, 15
  s_add_u32 m0, s47, 23552
  s_nop 0
  buffer_load_dwordx4 v2, s[32:35], s45 offen lds
  s_add_u32 s45, s44, 12288
  buffer_load_dwordx4 v[216:219], v2, s[32:35], s45 offen
  s_add_u32 s45, s44, 13312
  buffer_load_dwordx4 v[220:223], v2, s[32:35], s45 offen
  s_lshl_b32 s44, s60, 1
  s_add_u32 s44, s44, 0
  s_lshl_b32 s44, s44, 4
  s_lshl_b32 s45, s48, 2
  s_add_u32 s44, s44, s45
  s_add_u32 s44, s44, 2
  s_mul_i32 s44, s44, 14336
  s_add_u32 s44, s44, 6422528
  s_add_u32 s45, s44, 0
  buffer_load_dwordx4 a[64:67], v2, s[32:35], s45 offen
  s_add_u32 s45, s44, 1024
  buffer_load_dwordx4 a[68:71], v2, s[32:35], s45 offen
  s_add_u32 s45, s44, 2048
  buffer_load_dwordx4 a[128:131], v2, s[32:35], s45 offen
  s_add_u32 s45, s44, 3072
  buffer_load_dwordx4 a[132:135], v2, s[32:35], s45 offen
  s_add_u32 s45, s44, 4096
  s_lshl_b32 s47, s48, 15
  s_add_u32 m0, s47, 8192
  s_nop 0
  buffer_load_dwordx4 v2, s[32:35], s45 offen lds
  s_add_u32 s45, s44, 5120
  s_lshl_b32 s47, s48, 15
  s_add_u32 m0, s47, 9216
  s_nop 0
  buffer_load_dwordx4 v2, s[32:35], s45 offen lds
  s_add_u32 s45, s44, 6144
  buffer_load_dwordx4 a[192:195], v2, s[32:35], s45 offen
  s_add_u32 s45, s44, 7168
  buffer_load_dwordx4 a[196:199], v2, s[32:35], s45 offen
  s_add_u32 s45, s44, 8192
  buffer_load_dwordx4 v[160:163], v2, s[32:35], s45 offen
  s_add_u32 s45, s44, 9216
  buffer_load_dwordx4 v[164:167], v2, s[32:35], s45 offen
  s_add_u32 s45, s44, 10240
  s_lshl_b32 s47, s48, 15
  s_add_u32 m0, s47, 24576
  s_nop 0
  buffer_load_dwordx4 v2, s[32:35], s45 offen lds
  s_add_u32 s45, s44, 11264
  s_lshl_b32 s47, s48, 15
  s_add_u32 m0, s47, 25600
  s_nop 0
  buffer_load_dwordx4 v2, s[32:35], s45 offen lds
  s_add_u32 s45, s44, 12288
  buffer_load_dwordx4 v[224:227], v2, s[32:35], s45 offen
  s_add_u32 s45, s44, 13312
  buffer_load_dwordx4 v[228:231], v2, s[32:35], s45 offen
  s_lshl_b32 s44, s60, 1
  s_add_u32 s44, s44, 1
  s_lshl_b32 s44, s44, 4
  s_lshl_b32 s45, s48, 2
  s_add_u32 s44, s44, s45
  s_add_u32 s44, s44, 2
  s_mul_i32 s44, s44, 14336
  s_add_u32 s44, s44, 6422528
  s_add_u32 s45, s44, 0
  buffer_load_dwordx4 a[72:75], v2, s[32:35], s45 offen
  s_add_u32 s45, s44, 1024
  buffer_load_dwordx4 a[76:79], v2, s[32:35], s45 offen
  s_add_u32 s45, s44, 2048
  buffer_load_dwordx4 a[136:139], v2, s[32:35], s45 offen
  s_add_u32 s45, s44, 3072
  buffer_load_dwordx4 a[140:143], v2, s[32:35], s45 offen
  s_add_u32 s45, s44, 4096
  s_lshl_b32 s47, s48, 15
  s_add_u32 m0, s47, 10240
  s_nop 0
  buffer_load_dwordx4 v2, s[32:35], s45 offen lds
  s_add_u32 s45, s44, 5120
  s_lshl_b32 s47, s48, 15
  s_add_u32 m0, s47, 11264
  s_nop 0
  buffer_load_dwordx4 v2, s[32:35], s45 offen lds
  s_add_u32 s45, s44, 6144
  buffer_load_dwordx4 a[200:203], v2, s[32:35], s45 offen
  s_add_u32 s45, s44, 7168
  buffer_load_dwordx4 a[204:207], v2, s[32:35], s45 offen
  s_add_u32 s45, s44, 8192
  buffer_load_dwordx4 v[168:171], v2, s[32:35], s45 offen
  s_add_u32 s45, s44, 9216
  buffer_load_dwordx4 v[172:175], v2, s[32:35], s45 offen
  s_add_u32 s45, s44, 10240
  s_lshl_b32 s47, s48, 15
  s_add_u32 m0, s47, 26624
  s_nop 0
  buffer_load_dwordx4 v2, s[32:35], s45 offen lds
  s_add_u32 s45, s44, 11264
  s_lshl_b32 s47, s48, 15
  s_add_u32 m0, s47, 27648
  s_nop 0
  buffer_load_dwordx4 v2, s[32:35], s45 offen lds
  s_add_u32 s45, s44, 12288
  buffer_load_dwordx4 v[232:235], v2, s[32:35], s45 offen
  s_add_u32 s45, s44, 13312
  buffer_load_dwordx4 v[236:239], v2, s[32:35], s45 offen
  s_lshl_b32 s44, s60, 1
  s_add_u32 s44, s44, 0
  s_lshl_b32 s44, s44, 4
  s_lshl_b32 s45, s48, 2
  s_add_u32 s44, s44, s45
  s_add_u32 s44, s44, 3
  s_mul_i32 s44, s44, 14336
  s_add_u32 s44, s44, 6422528
  s_add_u32 s45, s44, 0
  buffer_load_dwordx4 a[80:83], v2, s[32:35], s45 offen
  s_add_u32 s45, s44, 1024
  buffer_load_dwordx4 a[84:87], v2, s[32:35], s45 offen
  s_add_u32 s45, s44, 2048
  buffer_load_dwordx4 a[144:147], v2, s[32:35], s45 offen
  s_add_u32 s45, s44, 3072
  buffer_load_dwordx4 a[148:151], v2, s[32:35], s45 offen
  s_add_u32 s45, s44, 4096
  s_lshl_b32 s47, s48, 15
  s_add_u32 m0, s47, 12288
  s_nop 0
  buffer_load_dwordx4 v2, s[32:35], s45 offen lds
  s_add_u32 s45, s44, 5120
  s_lshl_b32 s47, s48, 15
  s_add_u32 m0, s47, 13312
  s_nop 0
  buffer_load_dwordx4 v2, s[32:35], s45 offen lds
  s_add_u32 s45, s44, 6144
  buffer_load_dwordx4 a[208:211], v2, s[32:35], s45 offen
  s_add_u32 s45, s44, 7168
  buffer_load_dwordx4 a[212:215], v2, s[32:35], s45 offen
  s_add_u32 s45, s44, 8192
  buffer_load_dwordx4 v[176:179], v2, s[32:35], s45 offen
  s_add_u32 s45, s44, 9216
  buffer_load_dwordx4 v[180:183], v2, s[32:35], s45 offen
  s_add_u32 s45, s44, 10240
  s_lshl_b32 s47, s48, 15
  s_add_u32 m0, s47, 28672
  s_nop 0
  buffer_load_dwordx4 v2, s[32:35], s45 offen lds
  s_add_u32 s45, s44, 11264
  s_lshl_b32 s47, s48, 15
  s_add_u32 m0, s47, 29696
  s_nop 0
  buffer_load_dwordx4 v2, s[32:35], s45 offen lds
  s_add_u32 s45, s44, 12288
  buffer_load_dwordx4 v[240:243], v2, s[32:35], s45 offen
  s_add_u32 s45, s44, 13312
  buffer_load_dwordx4 v[244:247], v2, s[32:35], s45 offen
  s_lshl_b32 s44, s60, 1
  s_add_u32 s44, s44, 1
  s_lshl_b32 s44, s44, 4
  s_lshl_b32 s45, s48, 2
  s_add_u32 s44, s44, s45
  s_add_u32 s44, s44, 3
  s_mul_i32 s44, s44, 14336
  s_add_u32 s44, s44, 6422528
  s_add_u32 s45, s44, 0
  buffer_load_dwordx4 a[88:91], v2, s[32:35], s45 offen
  s_add_u32 s45, s44, 1024
  buffer_load_dwordx4 a[92:95], v2, s[32:35], s45 offen
  s_add_u32 s45, s44, 2048
  buffer_load_dwordx4 a[152:155], v2, s[32:35], s45 offen
  s_add_u32 s45, s44, 3072
  buffer_load_dwordx4 a[156:159], v2, s[32:35], s45 offen
  s_add_u32 s45, s44, 4096
  s_lshl_b32 s47, s48, 15
  s_add_u32 m0, s47, 14336
  s_nop 0
  buffer_load_dwordx4 v2, s[32:35], s45 offen lds
  s_add_u32 s45, s44, 5120
  s_lshl_b32 s47, s48, 15
  s_add_u32 m0, s47, 15360
  s_nop 0
  buffer_load_dwordx4 v2, s[32:35], s45 offen lds
  s_add_u32 s45, s44, 6144
  buffer_load_dwordx4 a[216:219], v2, s[32:35], s45 offen
  s_add_u32 s45, s44, 7168
  buffer_load_dwordx4 a[220:223], v2, s[32:35], s45 offen
  s_add_u32 s45, s44, 8192
  buffer_load_dwordx4 v[184:187], v2, s[32:35], s45 offen
  s_add_u32 s45, s44, 9216
  buffer_load_dwordx4 v[188:191], v2, s[32:35], s45 offen
  s_add_u32 s45, s44, 10240
  s_lshl_b32 s47, s48, 15
  s_add_u32 m0, s47, 30720
  s_nop 0
  buffer_load_dwordx4 v2, s[32:35], s45 offen lds
  s_add_u32 s45, s44, 11264
  s_lshl_b32 s47, s48, 15
  s_add_u32 m0, s47, 31744
  s_nop 0
  buffer_load_dwordx4 v2, s[32:35], s45 offen lds
  s_add_u32 s45, s44, 12288
  buffer_load_dwordx4 v[248:251], v2, s[32:35], s45 offen
  s_add_u32 s45, s44, 13312
  buffer_load_dwordx4 v[252:255], v2, s[32:35], s45 offen
  s_lshl_b32 s45, s48, 15
  v_add_u32 v3, s45, v2
  v_and_b32 v9, 15, v1
  v_lshrrev_b32 v10, 4, v1
  v_mov_b32 v11, 1073741824
  v_cmp_gt_u32 vcc, 8, v9
  v_lshl_add_u32 v12, v10, 3, v9
  v_lshlrev_b32 v12, 4, v12
  s_lshl_b32 s45, s48, 11
  v_add_u32 v6, s45, v12
  v_add_u32 v7, 384, v6
  v_cndmask_b32 v6, v7, v6, vcc
  s_lshl_b32 s45, s48, 9
  s_add_u32 s45, s45, 8192
  v_add_u32 v7, s45, v12
  v_cndmask_b32 v7, v11, v7, vcc
  v_bfe_u32 v9, v1, 2, 3
  v_and_b32 v10, 3, v1
  v_cmp_gt_u32 vcc, 32, v1
  v_and_b32 v14, 1, v10
  v_lshl_add_u32 v14, v9, 1, v14
  v_lshlrev_b32 v14, 4, v14
  v_lshrrev_b32 v15, 1, v10
  v_lshl_add_u32 v14, v15, 2, v14
  s_lshl_b32 s45, s60, 9
  s_lshr_b32 s44, s48, 1
  s_lshl_b32 s44, s44, 8
  s_add_u32 s45, s45, s44
  s_and_b32 s44, s48, 1
  s_lshl_b32 s44, s44, 3
  s_add_u32 s45, s45, s44
  s_add_u32 s45, s45, 7168
  v_add_u32 v14, s45, v14
  v_cndmask_b32 v14, v11, v14, vcc
  s_lshl_b32 s45, s60, 9
  s_lshl_b32 s44, s48, 7
  s_add_u32 s45, s45, s44
  s_add_u32 s45, s45, 924672
  v_lshlrev_b32 v94, 2, v1
  v_add_u32 v94, s45, v94
  v_cndmask_b32 v94, v11, v94, vcc
  v_lshlrev_b32 v12, 10, v15
  v_lshl_add_u32 v12, v9, 4, v12
  v_and_b32 v15, 1, v10
  v_lshl_add_u32 v12, v15, 3, v12
  s_lshl_b32 s45, s48, 8
  s_add_u32 s45, s45, 131072
  v_add_u32 v12, s45, v12
  s_lshl_b32 s45, s48, 12
  v_add_u32 v8, s45, v2
  s_lshl_b32 s45, s48, 11
  v_add_u32 v4, s45, v2
  s_cmp_eq_u32 s48, 3
  s_cselect_b32 s45, 0, 1024
  v_add_u32 v15, s45, v4
  v_add_u32 v11, 131072, v4
  v_and_b32 v9, 1, v1
  v_cmp_eq_u32 vcc, 0, v9
  v_mov_b32 v13, 0xeeee
  v_mov_b32 v9, 0x4444
  v_cndmask_b32 v13, v13, v9, vcc
  s_lshl_b32 s45, s48, 2
  v_mov_b32 v10, s45
  s_mul_i32 s62, s58, 458752
  s_add_u32 s62, s62, 120946688
  s_mul_i32 s70, s58, 655360
  s_add_u32 s70, s70, 122781696
  s_mul_i32 s72, s58, 29360128
  s_lshl_b32 s45, s60, 15
  s_add_u32 s72, s72, s45
  s_add_u32 s72, s72, 21331968
  s_add_u32 s73, s72, 16384
  s_mul_i32 s80, s58, 229376
  s_lshl_b32 s45, s60, 8
  s_add_u32 s80, s80, s45
  s_add_u32 s80, s80, 124092416
  v_mov_b32 v105, v5
  v_mov_b32 v106, v6
  v_mov_b32 v107, v7
  v_and_b32 v6, 15, v1
  v_lshlrev_b32 v6, 7, v6
  s_mov_b32 s56, 124784640
  s_mov_b32 s52, 60000
poll_66:
  buffer_load_dword v5, v6, s[32:35], s56 offen sc1
  s_waitcnt vmcnt(0)
  v_mov_b32 v7, v5
  s_nop 1
  v_add_u32_dpp v7, v7, v7 quad_perm:[1,0,3,2] row_mask:0xf bank_mask:0xf
  s_nop 1
  v_add_u32_dpp v7, v7, v7 quad_perm:[2,3,0,1] row_mask:0xf bank_mask:0xf
  s_nop 1
  v_add_u32_dpp v7, v7, v7 row_half_mirror row_mask:0xf bank_mask:0xf
  s_nop 1
  v_add_u32_dpp v7, v7, v7 row_mirror row_mask:0xf bank_mask:0xf
  v_cmp_ne_u32 vcc, 0x100, v7
  v_readlane_b32 s59, v5, s58
  s_nop 0
  s_cmp_ge_u32 s59, 30
  s_cselect_b32 s53, 1, 0
  s_cselect_b64 vcc, 0, vcc
  s_cbranch_vccz pok_67
  s_sleep 4
  s_sub_u32 s52, s52, 1
  s_cbranch_scc0 poll_66
  s_mov_b32 s54, 3
  s_branch k1_fail
pok_67:
  v_mov_b32 v5, v105
  v_mov_b32 v6, v106
  v_mov_b32 v7, v107
  s_waitcnt vmcnt(0)
  v_add_u32 v0, 139264, v4
  v_add_u32 v5, 139264, v15
  v_add_u32 v1, 139264, v2
  s_mul_i32 s74, s58, 114688
  s_lshl_b32 s45, s60, 13
  s_add_u32 s74, s74, s45
  s_add_u32 s74, s74, 80461824
  v_mov_b32 v95, 0
  s_mov_b32 s40, 0
  v_mov_b32 v92, 0
  s_cmp_eq_u32 s53, 1
  s_cbranch_scc0 chainB_slow
cbloop_68:
  v_mov_b32 v44, 0
  v_mov_b32 v45, 0
  v_mov_b32 v46, 0
  v_mov_b32 v47, 0
  v_mov_b32 v48, 0
  v_mov_b32 v49, 0
  v_mov_b32 v50, 0
  v_mov_b32 v51, 0
  v_mov_b32 v52, 0
  v_mov_b32 v53, 0
  v_mov_b32 v54, 0
  v_mov_b32 v55, 0
  v_mov_b32 v56, 0
  v_mov_b32 v57, 0
  v_mov_b32 v58, 0
  v_mov_b32 v59, 0
  v_mov_b32 v60, 0
  v_mov_b32 v61, 0
  v_mov_b32 v62, 0
  v_mov_b32 v63, 0
  v_mov_b32 v64, 0
  v_mov_b32 v65, 0
  v_mov_b32 v66, 0
  v_mov_b32 v67, 0
  v_mov_b32 v68, 0
  v_mov_b32 v69, 0
  v_mov_b32 v70, 0
  v_mov_b32 v71, 0
  v_mov_b32 v72, 0
  v_mov_b32 v73, 0
  v_mov_b32 v74, 0
  v_mov_b32 v75, 0
  s_mov_b32 s52, 60000
poll_69:
  buffer_load_dwordx4 v[96:99], v4, s[32:35], s62 offen sc1
  buffer_load_dwordx4 v[100:103], v15, s[32:35], s62 offen sc1
  s_waitcnt vmcnt(0)
  v_max3_u32 v9, v96, v97, v98
  v_max3_u32 v9, v9, v99, v100
  v_max3_u32 v9, v9, v101, v102
  v_max_u32 v9, v9, v103
  v_cmp_eq_u32 vcc, -1, v9
  s_cbranch_vccz pok_70
  s_sub_u32 s52, s52, 1
  s_cbranch_scc0 poll_69
  s_mov_b32 s54, 20
  s_branch k1_fail
pok_70:
  ds_write_b128 v0, v[96:99]
  ds_write_b128 v5, v[100:103]
  s_cmp_le_u32 s40, 1
  s_cbranch_scc1 nw_71
  v_cmp_ne_u32 vcc, 96, v95
  s_cbranch_vccz wok_72
  s_mov_b32 s52, 60000
poll_73:
  buffer_load_dword v95, off, s[32:35], s75 sc1
  s_waitcnt vmcnt(0)
  v_cmp_ne_u32 vcc, 96, v95
  s_cbranch_vccz pok_74
  s_sleep 4
  s_sub_u32 s52, s52, 1
  s_cbranch_scc0 poll_73
  s_mov_b32 s54, 25
  s_branch k1_fail
pok_74:
wok_72:
  v_min_u32 v128, -2, v128
  v_min_u32 v129, -2, v129
  v_min_u32 v130, -2, v130
  v_min_u32 v131, -2, v131
  v_min_u32 v132, -2, v132
  v_min_u32 v133, -2, v133
  v_min_u32 v134, -2, v134
  v_min_u32 v135, -2, v135
  buffer_store_dwordx4 v[128:131], v4, s[32:35], s74 offen offset:0 sc1
  buffer_store_dwordx4 v[132:135], v4, s[32:35], s74 offen offset:1024 sc1
  s_add_u32 s74, s74, 638976
nw_71:
  s_lshr_b32 s44, s40, 3
  s_lshl_b32 s44, s44, 7
  s_add_u32 s75, s44, 124786816
  s_cmp_eq_u32 s40, 63
  s_cbranch_scc1 nfu_75
  v_and_b32 v9, v92, v93
  v_cmp_ne_u32 vcc, 1, v9
  s_cbranch_vccz fu_76
  s_mov_b32 s52, 60000
poll_77:
  buffer_load_dword v92, v10, s[32:35], s80 offen offset:0 sc1
  buffer_load_dword v93, v10, s[32:35], s80 offen offset:128 sc1
  s_waitcnt vmcnt(0)
  v_and_b32 v9, v92, v93
  v_cmp_ne_u32 vcc, 1, v9
  s_cbranch_vccz pok_78
  s_sleep 1
  s_sub_u32 s52, s52, 1
  s_cbranch_scc0 poll_77
  s_mov_b32 s54, 21
  s_branch k1_fail
pok_78:
fu_76:
nfu_75:
  s_waitcnt lgkmcnt(0)
  s_barrier
  ds_read_b128 v[16:19], v1 offset:0
  ds_read_b128 v[20:23], v1 offset:1024
  ds_read_b128 v[24:27], v1 offset:2048
  ds_read_b128 v[28:31], v1 offset:3072
  ds_read_b128 v[32:35], v1 offset:4096
  ds_read_b128 v[36:39], v1 offset:5120
  ds_read_b128 v[40:43], v1 offset:6144
  s_waitcnt lgkmcnt(6)
  v_smfmac_f32_16x16x64_bf16 v[52:55], v[16:19], a[48:55], v13
  ds_read_b128 v[96:99], v3 offset:0
  buffer_load_dwordx4 a[0:3], v8, s[32:35], s72 offen offset:0 sc1
  v_smfmac_f32_16x16x64_bf16 v[56:59], v[16:19], a[56:63], v13
  ds_read_b128 v[100:103], v3 offset:1024
  v_smfmac_f32_16x16x64_bf16 v[60:63], v[16:19], a[64:71], v13
  ds_read_b128 v[104:107], v3 offset:2048
  buffer_load_dwordx4 a[4:7], v8, s[32:35], s73 offen offset:0 sc1
  v_smfmac_f32_16x16x64_bf16 v[64:67], v[16:19], a[72:79], v13
  ds_read_b128 v[108:111], v3 offset:3072
  v_smfmac_f32_16x16x64_bf16 v[68:71], v[16:19], a[80:87], v13
  ds_read_b128 v[112:115], v3 offset:4096
  buffer_load_dwordx4 a[8:11], v8, s[32:35], s72 offen offset:1024 sc1
  v_smfmac_f32_16x16x64_bf16 v[72:75], v[16:19], a[88:95], v13
  ds_read_b128 v[116:119], v3 offset:5120
  v_smfmac_f32_16x16x64_bf16 v[44:47], v[16:19], a[32:39], v13
  ds_read_b128 v[120:123], v3 offset:6144
  buffer_load_dwordx4 a[12:15], v8, s[32:35], s73 offen offset:1024 sc1
  v_smfmac_f32_16x16x64_bf16 v[48:51], v[16:19], a[40:47], v13
  ds_read_b128 v[124:127], v3 offset:7168
  s_waitcnt lgkmcnt(13)
  v_smfmac_f32_16x16x64_bf16 v[44:47], v[20:23], a[96:103], v13
  buffer_load_dwordx4 a[16:19], v8, s[32:35], s72 offen offset:2048 sc1
  v_smfmac_f32_16x16x64_bf16 v[48:51], v[20:23], a[104:111], v13
  s_waitcnt lgkmcnt(6)
  v_smfmac_f32_16x16x64_bf16 v[44:47], v[24:27], v[96:103], v13
  buffer_load_dwordx4 a[20:23], v8, s[32:35], s73 offen offset:2048 sc1
  s_waitcnt lgkmcnt(4)
  v_smfmac_f32_16x16x64_bf16 v[48:51], v[24:27], v[104:111], v13
  s_waitcnt lgkmcnt(2)
  v_smfmac_f32_16x16x64_bf16 v[52:55], v[24:27], v[112:119], v13
  buffer_load_dwordx4 a[24:27], v8, s[32:35], s72 offen offset:3072 sc1
  s_waitcnt lgkmcnt(0)
  v_smfmac_f32_16x16x64_bf16 v[56:59], v[24:27], v[120:127], v13
  v_smfmac_f32_16x16x64_bf16 v[52:55], v[20:23], a[112:119], v13
  ds_read_b128 v[96:99], v3 offset:8192
  buffer_load_dwordx4 a[28:31], v8, s[32:35], s73 offen offset:3072 sc1
  v_smfmac_f32_16x16x64_bf16 v[56:59], v[20:23], a[120:127], v13
  ds_read_b128 v[100:103], v3 offset:9216
  v_smfmac_f32_16x16x64_bf16 v[60:63], v[20:23], a[128:135], v13
  ds_read_b128 v[104:107], v3 offset:10240
  v_smfmac_f32_16x16x64_bf16 v[64:67], v[20:23], a[136:143], v13
  ds_read_b128 v[108:111], v3 offset:11264
  s_add_u32 s72, s72, 458752
  s_add_u32 s73, s73, 458752
  s_add_u32 s80, s80, 3584
  v_smfmac_f32_16x16x64_bf16 v[68:71], v[20:23], a[144:151], v13
  ds_read_b128 v[112:115], v3 offset:12288
  v_smfmac_f32_16x16x64_bf16 v[72:75], v[20:23], a[152:159], v13
  ds_read_b128 v[116:119], v3 offset:13312
  buffer_load_dword v92, v10, s[32:35], s80 offen offset:0 sc1
  v_smfmac_f32_16x16x64_bf16 v[44:47], v[28:31], a[160:167], v13
  ds_read_b128 v[120:123], v3 offset:14336
  v_smfmac_f32_16x16x64_bf16 v[48:51], v[28:31], a[168:175], v13
  ds_read_b128 v[124:127], v3 offset:15360
  buffer_load_dword v93, v10, s[32:35], s80 offen offset:128 sc1
  v_smfmac_f32_16x16x64_bf16 v[52:55], v[28:31], a[176:183], v13
  v_smfmac_f32_16x16x64_bf16 v[56:59], v[28:31], a[184:191], v13
  buffer_load_dword v95, off, s[32:35], s75 sc1
  s_waitcnt lgkmcnt(6)
  v_smfmac_f32_16x16x64_bf16 v[60:63], v[24:27], v[96:103], v13
  s_waitcnt lgkmcnt(4)
  v_smfmac_f32_16x16x64_bf16 v[64:67], v[24:27], v[104:111], v13
  s_waitcnt lgkmcnt(2)
  v_smfmac_f32_16x16x64_bf16 v[68:71], v[24:27], v[112:119], v13
  s_waitcnt lgkmcnt(0)
  v_smfmac_f32_16x16x64_bf16 v[72:75], v[24:27], v[120:127], v13
  v_smfmac_f32_16x16x64_bf16 v[60:63], v[28:31], a[192:199], v13
  ds_read_b128 v[96:99], v3 offset:16384
  v_smfmac_f32_16x16x64_bf16 v[64:67], v[28:31], a[200:207], v13
  ds_read_b128 v[100:103], v3 offset:17408
  v_smfmac_f32_16x16x64_bf16 v[68:71], v[28:31], a[208:215], v13
  ds_read_b128 v[104:107], v3 offset:18432
  v_smfmac_f32_16x16x64_bf16 v[72:75], v[28:31], a[216:223], v13
  ds_read_b128 v[108:111], v3 offset:19456
  v_smfmac_f32_16x16x64_bf16 v[44:47], v[32:35], a[224:231], v13
  ds_read_b128 v[112:115], v3 offset:20480
  v_smfmac_f32_16x16x64_bf16 v[48:51], v[32:35], a[232:239], v13
  ds_read_b128 v[116:119], v3 offset:21504
  v_smfmac_f32_16x16x64_bf16 v[52:55], v[32:35], a[240:247], v13
  ds_read_b128 v[120:123], v3 offset:22528
  v_smfmac_f32_16x16x64_bf16 v[56:59], v[32:35], a[248:255], v13
  ds_read_b128 v[124:127], v3 offset:23552
  v_smfmac_f32_16x16x64_bf16 v[60:63], v[32:35], v[160:167], v13
  v_smfmac_f32_16x16x64_bf16 v[64:67], v[32:35], v[168:175], v13
  s_waitcnt lgkmcnt(6)
  v_smfmac_f32_16x16x64_bf16 v[44:47], v[36:39], v[96:103], v13
  s_waitcnt lgkmcnt(4)
  v_smfmac_f32_16x16x64_bf16 v[48:51], v[36:39], v[104:111], v13
  s_waitcnt lgkmcnt(2)
  v_smfmac_f32_16x16x64_bf16 v[52:55], v[36:39], v[112:119], v13
  s_waitcnt lgkmcnt(0)
  v_smfmac_f32_16x16x64_bf16 v[56:59], v[36:39], v[120:127], v13
  v_smfmac_f32_16x16x64_bf16 v[68:71], v[32:35], v[176:183], v13
  ds_read_b128 v[96:99], v3 offset:24576
  v_smfmac_f32_16x16x64_bf16 v[72:75], v[32:35], v[184:191], v13
  ds_read_b128 v[100:103], v3 offset:25600
  v_smfmac_f32_16x16x64_bf16 v[44:47], v[40:43], v[192:199], v13
  ds_read_b128 v[104:107], v3 offset:26624
  v_smfmac_f32_16x16x64_bf16 v[48:51], v[40:43], v[200:207], v13
  ds_read_b128 v[108:111], v3 offset:27648
  v_smfmac_f32_16x16x64_bf16 v[52:55], v[40:43], v[208:215], v13
  ds_read_b128 v[112:115], v3 offset:28672
  v_smfmac_f32_16x16x64_bf16 v[56:59], v[40:43], v[216:223], v13
  ds_read_b128 v[116:119], v3 offset:29696
  v_smfmac_f32_16x16x64_bf16 v[60:63], v[40:43], v[224:231], v13
  ds_read_b128 v[120:123], v3 offset:30720
  v_smfmac_f32_16x16x64_bf16 v[64:67], v[40:43], v[232:239], v13
  ds_read_b128 v[124:127], v3 offset:31744
  v_smfmac_f32_16x16x64_bf16 v[68:71], v[40:43], v[240:247], v13
  v_smfmac_f32_16x16x64_bf16 v[72:75], v[40:43], v[248:255], v13
  s_waitcnt lgkmcnt(6)
  v_smfmac_f32_16x16x64_bf16 v[60:63], v[36:39], v[96:103], v13
  s_waitcnt lgkmcnt(4)
  v_smfmac_f32_16x16x64_bf16 v[64:67], v[36:39], v[104:111], v13
  s_waitcnt lgkmcnt(2)
  v_smfmac_f32_16x16x64_bf16 v[68:71], v[36:39], v[112:119], v13
  s_waitcnt lgkmcnt(0)
  v_smfmac_f32_16x16x64_bf16 v[72:75], v[36:39], v[120:127], v13
  v_add_f32 v44, v44, v45
  v_add_f32 v46, v46, v47
  v_add_f32 v48, v48, v49
  v_add_f32 v50, v50, v51
  v_add_f32 v52, v52, v53
  v_add_f32 v54, v54, v55
  v_add_f32 v56, v56, v57
  v_add_f32 v58, v58, v59
  v_add_f32 v60, v60, v61
  v_add_f32 v62, v62, v63
  v_add_f32 v64, v64, v65
  v_add_f32 v66, v66, v67
  v_add_f32 v68, v68, v69
  v_add_f32 v70, v70, v71
  v_add_f32 v72, v72, v73
  v_add_f32 v74, v74, v75
  v_cvt_pk_bf16_f32 v128, v44, v46
  v_cvt_pk_bf16_f32 v132, v48, v50
  v_cvt_pk_bf16_f32 v129, v52, v54
  v_cvt_pk_bf16_f32 v133, v56, v58
  v_cvt_pk_bf16_f32 v130, v60, v62
  v_cvt_pk_bf16_f32 v134, v64, v66
  v_cvt_pk_bf16_f32 v131, v68, v70
  v_cvt_pk_bf16_f32 v135, v72, v74
  s_cmp_eq_u32 s40, 63
  s_cbranch_scc1 last_79
  s_cmp_lg_u32 s40, 0
  s_cbranch_scc1 n0_80
  s_waitcnt vmcnt(0)
  v_cmp_ne_u32 vcc, 96, v95
  s_cbranch_vccz wok_81
  s_mov_b32 s52, 60000
poll_82:
  buffer_load_dword v95, off, s[32:35], s75 sc1
  s_waitcnt vmcnt(0)
  v_cmp_ne_u32 vcc, 96, v95
  s_cbranch_vccz pok_83
  s_sleep 4
  s_sub_u32 s52, s52, 1
  s_cbranch_scc0 poll_82
  s_mov_b32 s54, 25
  s_branch k1_fail
pok_83:
wok_81:
  v_min_u32 v128, -2, v128
  v_min_u32 v129, -2, v129
  v_min_u32 v130, -2, v130
  v_min_u32 v131, -2, v131
  v_min_u32 v132, -2, v132
  v_min_u32 v133, -2, v133
  v_min_u32 v134, -2, v134
  v_min_u32 v135, -2, v135
  buffer_store_dwordx4 v[128:131], v4, s[32:35], s74 offen offset:0 sc1
  buffer_store_dwordx4 v[132:135], v4, s[32:35], s74 offen offset:1024 sc1
  s_add_u32 s74, s74, 638976
n0_80:
  buffer_load_dwordx4 v[136:139], v7, s[32:35], s70 offen sc1
  buffer_load_dwordx4 v[140:143], v6, s[32:35], s70 offen offset:0 sc1
  buffer_load_dwordx4 v[144:147], v6, s[32:35], s70 offen offset:1024 sc1
  s_mov_b32 s52, 60000
pl_84:
  s_waitcnt vmcnt(2)
  v_max3_u32 v9, v136, v137, v138
  v_max_u32 v9, v9, v139
  v_cmp_eq_u32 vcc, -1, v9
  s_cbranch_vccz ok_85
  buffer_load_dwordx4 v[136:139], v7, s[32:35], s70 offen sc1
  buffer_load_dwordx4 v[140:143], v6, s[32:35], s70 offen offset:0 sc1
  buffer_load_dwordx4 v[144:147], v6, s[32:35], s70 offen offset:1024 sc1
  s_sub_u32 s52, s52, 1
  s_cbranch_scc0 pl_84
  s_mov_b32 s54, 22
  s_branch k1_fail
ok_85:
  v_mfma_f32_16x16x32_bf16 v[76:79], v[128:131], v[136:139], 0
  v_mfma_f32_16x16x32_bf16 v[80:83], v[132:135], v[136:139], 0
  s_waitcnt vmcnt(1)
  v_mfma_f32_16x16x32_bf16 v[84:87], a[8:11], v[140:143], 0
  v_max3_u32 v9, v140, v141, v142
  v_mfma_f32_16x16x32_bf16 v[88:91], a[12:15], v[140:143], 0
  v_max_u32 v9, v9, v143
  v_mfma_f32_16x16x32_bf16 v[76:79], a[0:3], v[140:143], v[76:79]
  v_mfma_f32_16x16x32_bf16 v[80:83], a[4:7], v[140:143], v[80:83]
  s_waitcnt vmcnt(0)
  v_mfma_f32_16x16x32_bf16 v[84:87], a[24:27], v[144:147], v[84:87]
  v_max3_u32 v9, v9, v144, v145
  v_mfma_f32_16x16x32_bf16 v[88:91], a[28:31], v[144:147], v[88:91]
  v_max3_u32 v9, v9, v146, v147
  v_mfma_f32_16x16x32_bf16 v[76:79], a[16:19], v[144:147], v[76:79]
  v_cmp_eq_u32 vcc, -1, v9
  v_mfma_f32_16x16x32_bf16 v[80:83], a[20:23], v[144:147], v[80:83]
  s_cbranch_vccnz prt_89
red_87:
  s_nop 4
  v_add_f32_dpp v76, v84, v76 row_ror:8 row_mask:0xf bank_mask:0xf
  v_add_f32_dpp v77, v85, v77 row_ror:8 row_mask:0xf bank_mask:0xf
  v_add_f32_dpp v78, v86, v78 row_ror:8 row_mask:0xf bank_mask:0xf
  v_add_f32_dpp v79, v87, v79 row_ror:8 row_mask:0xf bank_mask:0xf
  v_add_f32_dpp v80, v88, v80 row_ror:8 row_mask:0xf bank_mask:0xf
  v_add_f32_dpp v81, v89, v81 row_ror:8 row_mask:0xf bank_mask:0xf
  v_add_f32_dpp v82, v90, v82 row_ror:8 row_mask:0xf bank_mask:0xf
  v_add_f32_dpp v83, v91, v83 row_ror:8 row_mask:0xf bank_mask:0xf
  ds_write_b128 v11, v[76:79] offset:0
  ds_write_b128 v11, v[80:83] offset:1024
  s_waitcnt lgkmcnt(0)
  s_barrier
  ds_read2st64_b64 v[76:79], v12 offset0:0 offset1:4
  ds_read2st64_b64 v[80:83], v12 offset0:8 offset1:12
  s_waitcnt lgkmcnt(0)
  v_pk_add_f32 v[76:77], v[76:77], v[78:79]
  v_pk_add_f32 v[80:81], v[80:81], v[82:83]
  v_pk_add_f32 v[76:77], v[76:77], v[80:81]
  v_cvt_pk_bf16_f32 v78, v76, v77
  v_min_u32 v78, -2, v78
fin_86:
  buffer_store_dword v78, v14, s[32:35], s62 offen
  buffer_store_dword v78, v94, s[32:35], s62 offen sc1
  s_add_u32 s62, s62, 7168
  s_add_u32 s70, s70, 10240
  s_add_u32 s40, s40, 1
  s_branch cbloop_68
last_79:
  s_waitcnt vmcnt(0)
  v_cmp_ne_u32 vcc, 96, v95
  s_cbranch_vccz wok_90
  s_mov_b32 s52, 60000
poll_91:
  buffer_load_dword v95, off, s[32:35], s75 sc1
  s_waitcnt vmcnt(0)
  v_cmp_ne_u32 vcc, 96, v95
  s_cbranch_vccz pok_92
  s_sleep 4
  s_sub_u32 s52, s52, 1
  s_cbranch_scc0 poll_91
  s_mov_b32 s54, 25
  s_branch k1_fail
pok_92:
wok_90:
  v_min_u32 v128, -2, v128
  v_min_u32 v129, -2, v129
  v_min_u32 v130, -2, v130
  v_min_u32 v131, -2, v131
  v_min_u32 v132, -2, v132
  v_min_u32 v133, -2, v133
  v_min_u32 v134, -2, v134
  v_min_u32 v135, -2, v135
  buffer_store_dwordx4 v[128:131], v4, s[32:35], s74 offen offset:0 sc1
  buffer_store_dwordx4 v[132:135], v4, s[32:35], s74 offen offset:1024 sc1
  s_add_u32 s74, s74, 638976
  s_endpgm
prt_89:
  s_mov_b32 s52, 60000
poll_93:
  buffer_load_dwordx4 v[140:143], v6, s[32:35], s70 offen offset:0 sc1
  buffer_load_dwordx4 v[144:147], v6, s[32:35], s70 offen offset:1024 sc1
  s_waitcnt vmcnt(0)
  v_max3_u32 v9, v140, v141, v142
  v_max3_u32 v9, v9, v143, v144
  v_max3_u32 v9, v9, v145, v146
  v_max_u32 v9, v9, v147
  v_cmp_eq_u32 vcc, -1, v9
  s_cbranch_vccz pok_94
  s_sub_u32 s52, s52, 1
  s_cbranch_scc0 poll_93
  s_mov_b32 s54, 23
  s_branch k1_fail
pok_94:
  s_branch ok_85
chainB_slow:
cbloop_95:
  v_mov_b32 v44, 0
  v_mov_b32 v45, 0
  v_mov_b32 v46, 0
  v_mov_b32 v47, 0
  v_mov_b32 v48, 0
  v_mov_b32 v49, 0
  v_mov_b32 v50, 0
  v_mov_b32 v51, 0
  v_mov_b32 v52, 0
  v_mov_b32 v53, 0
  v_mov_b32 v54, 0
  v_mov_b32 v55, 0
  v_mov_b32 v56, 0
  v_mov_b32 v57, 0
  v_mov_b32 v58, 0
  v_mov_b32 v59, 0
  v_mov_b32 v60, 0
  v_mov_b32 v61, 0
  v_mov_b32 v62, 0
  v_mov_b32 v63, 0
  v_mov_b32 v64, 0
  v_mov_b32 v65, 0
  v_mov_b32 v66, 0
  v_mov_b32 v67, 0
  v_mov_b32 v68, 0
  v_mov_b32 v69, 0
  v_mov_b32 v70, 0
  v_mov_b32 v71, 0
  v_mov_b32 v72, 0
  v_mov_b32 v73, 0
  v_mov_b32 v74, 0
  v_mov_b32 v75, 0
  s_mov_b32 s52, 60000
poll_96:
  buffer_load_dwordx4 v[96:99], v4, s[32:35], s62 offen sc1
  buffer_load_dwordx4 v[100:103], v15, s[32:35], s62 offen sc1
  s_waitcnt vmcnt(0)
  v_max3_u32 v9, v96, v97, v98
  v_max3_u32 v9, v9, v99, v100
  v_max3_u32 v9, v9, v101, v102
  v_max_u32 v9, v9, v103
  v_cmp_eq_u32 vcc, -1, v9
  s_cbranch_vccz pok_97
  s_sub_u32 s52, s52, 1
  s_cbranch_scc0 poll_96
  s_mov_b32 s54, 20
  s_branch k1_fail
pok_97:
  ds_write_b128 v0, v[96:99]
  ds_write_b128 v5, v[100:103]
  s_cmp_le_u32 s40, 1
  s_cbranch_scc1 nw_98
  v_cmp_ne_u32 vcc, 96, v95
  s_cbranch_vccz wok_99
  s_mov_b32 s52, 60000
poll_100:
  buffer_load_dword v95, off, s[32:35], s75 sc1
  s_waitcnt vmcnt(0)
  v_cmp_ne_u32 vcc, 96, v95
  s_cbranch_vccz pok_101
  s_sleep 4
  s_sub_u32 s52, s52, 1
  s_cbranch_scc0 poll_100
  s_mov_b32 s54, 25
  s_branch k1_fail
pok_101:
wok_99:
  v_min_u32 v128, -2, v128
  v_min_u32 v129, -2, v129
  v_min_u32 v130, -2, v130
  v_min_u32 v131, -2, v131
  v_min_u32 v132, -2, v132
  v_min_u32 v133, -2, v133
  v_min_u32 v134, -2, v134
  v_min_u32 v135, -2, v135
  buffer_store_dwordx4 v[128:131], v4, s[32:35], s74 offen offset:0 sc1
  buffer_store_dwordx4 v[132:135], v4, s[32:35], s74 offen offset:1024 sc1
  s_add_u32 s74, s74, 638976
nw_98:
  s_lshr_b32 s44, s40, 3
  s_lshl_b32 s44, s44, 7
  s_add_u32 s75, s44, 124786816
  s_cmp_eq_u32 s40, 63
  s_cbranch_scc1 nfu_102
  v_and_b32 v9, v92, v93
  v_cmp_ne_u32 vcc, 1, v9
  s_cbranch_vccz fu_103
  s_mov_b32 s52, 60000
poll_104:
  buffer_load_dword v92, v10, s[32:35], s80 offen offset:0 sc1
  buffer_load_dword v93, v10, s[32:35], s80 offen offset:128 sc1
  s_waitcnt vmcnt(0)
  v_and_b32 v9, v92, v93
  v_cmp_ne_u32 vcc, 1, v9
  s_cbranch_vccz pok_105
  s_sleep 1
  s_sub_u32 s52, s52, 1
  s_cbranch_scc0 poll_104
  s_mov_b32 s54, 21
  s_branch k1_fail
pok_105:
fu_103:
nfu_102:
  s_waitcnt lgkmcnt(0)
  s_barrier
  ds_read_b128 v[16:19], v1 offset:0
  ds_read_b128 v[20:23], v1 offset:1024
  ds_read_b128 v[24:27], v1 offset:2048
  ds_read_b128 v[28:31], v1 offset:3072
  ds_read_b128 v[32:35], v1 offset:4096
  ds_read_b128 v[36:39], v1 offset:5120
  ds_read_b128 v[40:43], v1 offset:6144
  s_waitcnt lgkmcnt(6)
  v_smfmac_f32_16x16x64_bf16 v[52:55], v[16:19], a[48:55], v13
  ds_read_b128 v[96:99], v3 offset:0
  buffer_load_dwordx4 a[0:3], v8, s[32:35], s72 offen offset:0 sc1
  v_smfmac_f32_16x16x64_bf16 v[56:59], v[16:19], a[56:63], v13
  ds_read_b128 v[100:103], v3 offset:1024
  v_smfmac_f32_16x16x64_bf16 v[60:63], v[16:19], a[64:71], v13
  ds_read_b128 v[104:107], v3 offset:2048
  buffer_load_dwordx4 a[4:7], v8, s[32:35], s73 offen offset:0 sc1
  v_smfmac_f32_16x16x64_bf16 v[64:67], v[16:19], a[72:79], v13
  ds_read_b128 v[108:111], v3 offset:3072
  v_smfmac_f32_16x16x64_bf16 v[68:71], v[16:19], a[80:87], v13
  ds_read_b128 v[112:115], v3 offset:4096
  buffer_load_dwordx4 a[8:11], v8, s[32:35], s72 offen offset:1024 sc1
  v_smfmac_f32_16x16x64_bf16 v[72:75], v[16:19], a[88:95], v13
  ds_read_b128 v[116:119], v3 offset:5120
  v_smfmac_f32_16x16x64_bf16 v[44:47], v[16:19], a[32:39], v13
  ds_read_b128 v[120:123], v3 offset:6144
  buffer_load_dwordx4 a[12:15], v8, s[32:35], s73 offen offset:1024 sc1
  v_smfmac_f32_16x16x64_bf16 v[48:51], v[16:19], a[40:47], v13
  ds_read_b128 v[124:127], v3 offset:7168
  s_waitcnt lgkmcnt(13)
  v_smfmac_f32_16x16x64_bf16 v[44:47], v[20:23], a[96:103], v13
  buffer_load_dwordx4 a[16:19], v8, s[32:35], s72 offen offset:2048 sc1
  v_smfmac_f32_16x16x64_bf16 v[48:51], v[20:23], a[104:111], v13
  s_waitcnt lgkmcnt(6)
  v_smfmac_f32_16x16x64_bf16 v[44:47], v[24:27], v[96:103], v13
  buffer_load_dwordx4 a[20:23], v8, s[32:35], s73 offen offset:2048 sc1
  s_waitcnt lgkmcnt(4)
  v_smfmac_f32_16x16x64_bf16 v[48:51], v[24:27], v[104:111], v13
  s_waitcnt lgkmcnt(2)
  v_smfmac_f32_16x16x64_bf16 v[52:55], v[24:27], v[112:119], v13
  buffer_load_dwordx4 a[24:27], v8, s[32:35], s72 offen offset:3072 sc1
  s_waitcnt lgkmcnt(0)
  v_smfmac_f32_16x16x64_bf16 v[56:59], v[24:27], v[120:127], v13
  v_smfmac_f32_16x16x64_bf16 v[52:55], v[20:23], a[112:119], v13
  ds_read_b128 v[96:99], v3 offset:8192
  buffer_load_dwordx4 a[28:31], v8, s[32:35], s73 offen offset:3072 sc1
  v_smfmac_f32_16x16x64_bf16 v[56:59], v[20:23], a[120:127], v13
  ds_read_b128 v[100:103], v3 offset:9216
  v_smfmac_f32_16x16x64_bf16 v[60:63], v[20:23], a[128:135], v13
  ds_read_b128 v[104:107], v3 offset:10240
  v_smfmac_f32_16x16x64_bf16 v[64:67], v[20:23], a[136:143], v13
  ds_read_b128 v[108:111], v3 offset:11264
  s_add_u32 s72, s72, 458752
  s_add_u32 s73, s73, 458752
  s_add_u32 s80, s80, 3584
  v_smfmac_f32_16x16x64_bf16 v[68:71], v[20:23], a[144:151], v13
  ds_read_b128 v[112:115], v3 offset:12288
  v_smfmac_f32_16x16x64_bf16 v[72:75], v[20:23], a[152:159], v13
  ds_read_b128 v[116:119], v3 offset:13312
  buffer_load_dword v92, v10, s[32:35], s80 offen offset:0 sc1
  v_smfmac_f32_16x16x64_bf16 v[44:47], v[28:31], a[160:167], v13
  ds_read_b128 v[120:123], v3 offset:14336
  v_smfmac_f32_16x16x64_bf16 v[48:51], v[28:31], a[168:175], v13
  ds_read_b128 v[124:127], v3 offset:15360
  buffer_load_dword v93, v10, s[32:35], s80 offen offset:128 sc1
  v_smfmac_f32_16x16x64_bf16 v[52:55], v[28:31], a[176:183], v13
  v_smfmac_f32_16x16x64_bf16 v[56:59], v[28:31], a[184:191], v13
  buffer_load_dword v95, off, s[32:35], s75 sc1
  s_waitcnt lgkmcnt(6)
  v_smfmac_f32_16x16x64_bf16 v[60:63], v[24:27], v[96:103], v13
  s_waitcnt lgkmcnt(4)
  v_smfmac_f32_16x16x64_bf16 v[64:67], v[24:27], v[104:111], v13
  s_waitcnt lgkmcnt(2)
  v_smfmac_f32_16x16x64_bf16 v[68:71], v[24:27], v[112:119], v13
  s_waitcnt lgkmcnt(0)
  v_smfmac_f32_16x16x64_bf16 v[72:75], v[24:27], v[120:127], v13
  v_smfmac_f32_16x16x64_bf16 v[60:63], v[28:31], a[192:199], v13
  ds_read_b128 v[96:99], v3 offset:16384
  v_smfmac_f32_16x16x64_bf16 v[64:67], v[28:31], a[200:207], v13
  ds_read_b128 v[100:103], v3 offset:17408
  v_smfmac_f32_16x16x64_bf16 v[68:71], v[28:31], a[208:215], v13
  ds_read_b128 v[104:107], v3 offset:18432
  v_smfmac_f32_16x16x64_bf16 v[72:75], v[28:31], a[216:223], v13
  ds_read_b128 v[108:111], v3 offset:19456
  v_smfmac_f32_16x16x64_bf16 v[44:47], v[32:35], a[224:231], v13
  ds_read_b128 v[112:115], v3 offset:20480
  v_smfmac_f32_16x16x64_bf16 v[48:51], v[32:35], a[232:239], v13
  ds_read_b128 v[116:119], v3 offset:21504
  v_smfmac_f32_16x16x64_bf16 v[52:55], v[32:35], a[240:247], v13
  ds_read_b128 v[120:123], v3 offset:22528
  v_smfmac_f32_16x16x64_bf16 v[56:59], v[32:35], a[248:255], v13
  ds_read_b128 v[124:127], v3 offset:23552
  v_smfmac_f32_16x16x64_bf16 v[60:63], v[32:35], v[160:167], v13
  v_smfmac_f32_16x16x64_bf16 v[64:67], v[32:35], v[168:175], v13
  s_waitcnt lgkmcnt(6)
  v_smfmac_f32_16x16x64_bf16 v[44:47], v[36:39], v[96:103], v13
  s_waitcnt lgkmcnt(4)
  v_smfmac_f32_16x16x64_bf16 v[48:51], v[36:39], v[104:111], v13
  s_waitcnt lgkmcnt(2)
  v_smfmac_f32_16x16x64_bf16 v[52:55], v[36:39], v[112:119], v13
  s_waitcnt lgkmcnt(0)
  v_smfmac_f32_16x16x64_bf16 v[56:59], v[36:39], v[120:127], v13
  v_smfmac_f32_16x16x64_bf16 v[68:71], v[32:35], v[176:183], v13
  ds_read_b128 v[96:99], v3 offset:24576
  v_smfmac_f32_16x16x64_bf16 v[72:75], v[32:35], v[184:191], v13
  ds_read_b128 v[100:103], v3 offset:25600
  v_smfmac_f32_16x16x64_bf16 v[44:47], v[40:43], v[192:199], v13
  ds_read_b128 v[104:107], v3 offset:26624
  v_smfmac_f32_16x16x64_bf16 v[48:51], v[40:43], v[200:207], v13
  ds_read_b128 v[108:111], v3 offset:27648
  v_smfmac_f32_16x16x64_bf16 v[52:55], v[40:43], v[208:215], v13
  ds_read_b128 v[112:115], v3 offset:28672
  v_smfmac_f32_16x16x64_bf16 v[56:59], v[40:43], v[216:223], v13
  ds_read_b128 v[116:119], v3 offset:29696
  v_smfmac_f32_16x16x64_bf16 v[60:63], v[40:43], v[224:231], v13
  ds_read_b128 v[120:123], v3 offset:30720
  v_smfmac_f32_16x16x64_bf16 v[64:67], v[40:43], v[232:239], v13
  ds_read_b128 v[124:127], v3 offset:31744
  v_smfmac_f32_16x16x64_bf16 v[68:71], v[40:43], v[240:247], v13
  v_smfmac_f32_16x16x64_bf16 v[72:75], v[40:43], v[248:255], v13
  s_waitcnt lgkmcnt(6)
  v_smfmac_f32_16x16x64_bf16 v[60:63], v[36:39], v[96:103], v13
  s_waitcnt lgkmcnt(4)
  v_smfmac_f32_16x16x64_bf16 v[64:67], v[36:39], v[104:111], v13
  s_waitcnt lgkmcnt(2)
  v_smfmac_f32_16x16x64_bf16 v[68:71], v[36:39], v[112:119], v13
  s_waitcnt lgkmcnt(0)
  v_smfmac_f32_16x16x64_bf16 v[72:75], v[36:39], v[120:127], v13
  v_add_f32 v44, v44, v45
  v_add_f32 v46, v46, v47
  v_add_f32 v48, v48, v49
  v_add_f32 v50, v50, v51
  v_add_f32 v52, v52, v53
  v_add_f32 v54, v54, v55
  v_add_f32 v56, v56, v57
  v_add_f32 v58, v58, v59
  v_add_f32 v60, v60, v61
  v_add_f32 v62, v62, v63
  v_add_f32 v64, v64, v65
  v_add_f32 v66, v66, v67
  v_add_f32 v68, v68, v69
  v_add_f32 v70, v70, v71
  v_add_f32 v72, v72, v73
  v_add_f32 v74, v74, v75
  v_cvt_pk_bf16_f32 v128, v44, v46
  v_cvt_pk_bf16_f32 v132, v48, v50
  v_cvt_pk_bf16_f32 v129, v52, v54
  v_cvt_pk_bf16_f32 v133, v56, v58
  v_cvt_pk_bf16_f32 v130, v60, v62
  v_cvt_pk_bf16_f32 v134, v64, v66
  v_cvt_pk_bf16_f32 v131, v68, v70
  v_cvt_pk_bf16_f32 v135, v72, v74
  s_cmp_eq_u32 s40, 63
  s_cbranch_scc1 last_106
  s_cmp_lg_u32 s40, 0
  s_cbranch_scc1 n0_107
  s_waitcnt vmcnt(0)
  v_cmp_ne_u32 vcc, 96, v95
  s_cbranch_vccz wok_108
  s_mov_b32 s52, 60000
poll_109:
  buffer_load_dword v95, off, s[32:35], s75 sc1
  s_waitcnt vmcnt(0)
  v_cmp_ne_u32 vcc, 96, v95
  s_cbranch_vccz pok_110
  s_sleep 4
  s_sub_u32 s52, s52, 1
  s_cbranch_scc0 poll_109
  s_mov_b32 s54, 25
  s_branch k1_fail
pok_110:
wok_108:
  v_min_u32 v128, -2, v128
  v_min_u32 v129, -2, v129
  v_min_u32 v130, -2, v130
  v_min_u32 v131, -2, v131
  v_min_u32 v132, -2, v132
  v_min_u32 v133, -2, v133
  v_min_u32 v134, -2, v134
  v_min_u32 v135, -2, v135
  buffer_store_dwordx4 v[128:131], v4, s[32:35], s74 offen offset:0 sc1
  buffer_store_dwordx4 v[132:135], v4, s[32:35], s74 offen offset:1024 sc1
  s_add_u32 s74, s74, 638976
n0_107:
  buffer_load_dwordx4 v[136:139], v7, s[32:35], s70 offen sc1
  buffer_load_dwordx4 v[140:143], v6, s[32:35], s70 offen offset:0 sc1
  buffer_load_dwordx4 v[144:147], v6, s[32:35], s70 offen offset:1024 sc1
  s_mov_b32 s52, 60000
pl_111:
  s_waitcnt vmcnt(2)
  v_max3_u32 v9, v136, v137, v138
  v_max_u32 v9, v9, v139
  v_cmp_eq_u32 vcc, -1, v9
  s_cbranch_vccz ok_112
  buffer_load_dwordx4 v[136:139], v7, s[32:35], s70 offen sc1
  buffer_load_dwordx4 v[140:143], v6, s[32:35], s70 offen offset:0 sc1
  buffer_load_dwordx4 v[144:147], v6, s[32:35], s70 offen offset:1024 sc1
  s_sub_u32 s52, s52, 1
  s_cbranch_scc0 pl_111
  s_mov_b32 s54, 22
  s_branch k1_fail
ok_112:
  v_mfma_f32_16x16x32_bf16 v[76:79], v[128:131], v[136:139], 0
  v_mfma_f32_16x16x32_bf16 v[80:83], v[132:135], v[136:139], 0
  s_waitcnt vmcnt(1)
  v_mfma_f32_16x16x32_bf16 v[84:87], a[8:11], v[140:143], 0
  v_max3_u32 v9, v140, v141, v142
  v_mfma_f32_16x16x32_bf16 v[88:91], a[12:15], v[140:143], 0
  v_max_u32 v9, v9, v143
  v_mfma_f32_16x16x32_bf16 v[76:79], a[0:3], v[140:143], v[76:79]
  v_mfma_f32_16x16x32_bf16 v[80:83], a[4:7], v[140:143], v[80:83]
  s_waitcnt vmcnt(0)
  v_mfma_f32_16x16x32_bf16 v[84:87], a[24:27], v[144:147], v[84:87]
  v_max3_u32 v9, v9, v144, v145
  v_mfma_f32_16x16x32_bf16 v[88:91], a[28:31], v[144:147], v[88:91]
  v_max3_u32 v9, v9, v146, v147
  v_mfma_f32_16x16x32_bf16 v[76:79], a[16:19], v[144:147], v[76:79]
  v_cmp_eq_u32 vcc, -1, v9
  v_mfma_f32_16x16x32_bf16 v[80:83], a[20:23], v[144:147], v[80:83]
  s_cbranch_vccnz prt_116
red_114:
  s_nop 4
  v_add_f32_dpp v76, v84, v76 row_ror:8 row_mask:0xf bank_mask:0xf
  v_add_f32_dpp v77, v85, v77 row_ror:8 row_mask:0xf bank_mask:0xf
  v_add_f32_dpp v78, v86, v78 row_ror:8 row_mask:0xf bank_mask:0xf
  v_add_f32_dpp v79, v87, v79 row_ror:8 row_mask:0xf bank_mask:0xf
  v_add_f32_dpp v80, v88, v80 row_ror:8 row_mask:0xf bank_mask:0xf
  v_add_f32_dpp v81, v89, v81 row_ror:8 row_mask:0xf bank_mask:0xf
  v_add_f32_dpp v82, v90, v82 row_ror:8 row_mask:0xf bank_mask:0xf
  v_add_f32_dpp v83, v91, v83 row_ror:8 row_mask:0xf bank_mask:0xf
  ds_write_b128 v11, v[76:79] offset:0
  ds_write_b128 v11, v[80:83] offset:1024
  s_waitcnt lgkmcnt(0)
  s_barrier
  ds_read2st64_b64 v[76:79], v12 offset0:0 offset1:4
  ds_read2st64_b64 v[80:83], v12 offset0:8 offset1:12
  s_waitcnt lgkmcnt(0)
  v_pk_add_f32 v[76:77], v[76:77], v[78:79]
  v_pk_add_f32 v[80:81], v[80:81], v[82:83]
  v_pk_add_f32 v[76:77], v[76:77], v[80:81]
  v_cvt_pk_bf16_f32 v78, v76, v77
  v_min_u32 v78, -2, v78
fin_113:
  buffer_store_dword v78, v14, s[32:35], s62 offen sc1
  buffer_store_dword v78, v94, s[32:35], s62 offen sc1
  s_add_u32 s62, s62, 7168
  s_add_u32 s70, s70, 10240
  s_add_u32 s40, s40, 1
  s_branch cbloop_95
last_106:
  s_waitcnt vmcnt(0)
  v_cmp_ne_u32 vcc, 96, v95
  s_cbranch_vccz wok_117
  s_mov_b32 s52, 60000
poll_118:
  buffer_load_dword v95, off, s[32:35], s75 sc1
  s_waitcnt vmcnt(0)
  v_cmp_ne_u32 vcc, 96, v95
  s_cbranch_vccz pok_119
  s_sleep 4
  s_sub_u32 s52, s52, 1
  s_cbranch_scc0 poll_118
  s_mov_b32 s54, 25
  s_branch k1_fail
pok_119:
wok_117:
  v_min_u32 v128, -2, v128
  v_min_u32 v129, -2, v129
  v_min_u32 v130, -2, v130
  v_min_u32 v131, -2, v131
  v_min_u32 v132, -2, v132
  v_min_u32 v133, -2, v133
  v_min_u32 v134, -2, v134
  v_min_u32 v135, -2, v135
  buffer_store_dwordx4 v[128:131], v4, s[32:35], s74 offen offset:0 sc1
  buffer_store_dwordx4 v[132:135], v4, s[32:35], s74 offen offset:1024 sc1
  s_add_u32 s74, s74, 638976
  s_endpgm
prt_116:
  s_mov_b32 s52, 60000
poll_120:
  buffer_load_dwordx4 v[140:143], v6, s[32:35], s70 offen offset:0 sc1
  buffer_load_dwordx4 v[144:147], v6, s[32:35], s70 offen offset:1024 sc1
  s_waitcnt vmcnt(0)
  v_max3_u32 v9, v140, v141, v142
  v_max3_u32 v9, v9, v143, v144
  v_max3_u32 v9, v9, v145, v146
  v_max_u32 v9, v9, v147
  v_cmp_eq_u32 vcc, -1, v9
  s_cbranch_vccz pok_121
  s_sub_u32 s52, s52, 1
  s_cbranch_scc0 poll_120
  s_mov_b32 s54, 23
  s_branch k1_fail
pok_121:
  s_branch ok_112
r_rest:
  s_cmp_eq_u32 s58, 0
  s_cbranch_scc1 nofill_122
  s_lshr_b32 s44, s49, 6
  s_sub_u32 s44, s44, 1
  s_lshl_b32 s44, s44, 5
  s_add_u32 s44, s44, s50
  s_lshl_b32 s44, s44, 12
  s_add_u32 s55, s44, 80052224
  s_mov_b32 s45, 85164032
  s_mov_b32 s56, 124786816
  s_lshl_b32 s47, s48, 10
  v_add_u32 v8, s47, v2
  v_mov_b32 v10, -1
  v_mov_b32 v11, -1
  v_mov_b32 v12, -1
  v_mov_b32 v13, -1
  s_cmp_eq_u32 s49, 191
  s_cselect_b32 s47, 1, 1
  v_mov_b32 v9, s47
fgrp_123:
  s_mov_b32 s44, s55
fill_124:
  buffer_store_dwordx4 v[10:13], v8, s[32:35], s44 offen sc1
  s_add_u32 s44, s44, 393216
  s_cmp_lt_u32 s44, s45
  s_cbranch_scc1 fill_124
  s_waitcnt vmcnt(0)
  s_barrier
  s_cmp_lg_u32 s48, 0
  s_cbranch_scc1 fd_125
  s_mov_b64 exec, 1
  buffer_atomic_add v9, off, s[32:35], s56 sc1
  s_mov_b64 exec, -1
fd_125:
  s_add_u32 s55, s55, 5111808
  s_add_u32 s45, s45, 5111808
  s_add_u32 s56, s56, 128
  s_cmp_le_u32 s45, 85164032
  s_cbranch_scc1 fgrp_123
nofill_122:
  s_cmp_eq_u32 s58, 0
  s_cbranch_scc1 ng_126
  s_mov_b32 s44, 124788608
  s_mov_b32 s52, 60000
poll_127:
  buffer_load_dword v3, off, s[32:35], s44 sc1
  s_waitcnt vmcnt(0)
  v_cmp_ne_u32 vcc, 1, v3
  s_cbranch_vccz pok_128
  s_sleep 16
  s_sub_u32 s52, s52, 1
  s_cbranch_scc0 poll_127
  s_mov_b32 s54, 5
  s_branch k1_fail
pok_128:
ng_126:
  s_cmp_lt_u32 s49, 128
  s_cbranch_scc1 r_TA
  s_cmp_ge_u32 s49, 192
  s_cbranch_scc1 r_F
  s_cmp_lt_u32 s50, 28
  s_cbranch_scc1 r_U
  s_cmp_eq_u32 s50, 31
  s_cbranch_scc1 r_fill
r_O:
  s_cmp_ge_u32 s49, 192
  s_cselect_b32 s44, 21, 17
  s_sub_u32 s65, s50, s44
  s_mov_b32 s40, s4
  s_and_b32 s41, s5, 0xffff
  s_mov_b32 s42, 1835008
  s_mov_b32 s43, 0x20000
  v_and_b32 v9, 15, v1
  v_lshrrev_b32 v10, 4, v1
  s_lshl_b32 s45, s48, 12
  v_add_u32 v5, s45, v2
  s_lshl_b32 s45, s48, 13
  v_add_u32 v6, s45, v2
  v_lshlrev_b32 v7, 2, v1
  s_lshl_b32 s45, s48, 11
  v_add_u32 v4, s45, v2
  s_add_u32 s45, s45, 32768
  v_add_u32 v7, s45, v7
  s_lshl_b32 s45, s48, 2
  v_mov_b32 v8, s45
  v_bfe_u32 v12, v1, 1, 3
  v_and_b32 v11, 1, v1
  v_lshlrev_b32 v22, 8, v12
  v_lshl_add_u32 v22, v11, 5, v22
  s_lshl_b32 s45, s48, 11
  s_add_u32 s45, s45, 32768
  v_add_u32 v22, s45, v22
  v_lshlrev_b32 v12, 10, v12
  v_lshl_add_u32 v12, v11, 7, v12
  s_lshl_b32 s45, s48, 13
  v_add_u32 v12, s45, v12
  v_cmp_gt_u32 vcc, 16, v1
  s_nop 1
  v_cndmask_b32 v12, v22, v12, vcc
  v_mov_b32 v22, 1073741824
  v_cmp_gt_u32 vcc, 32, v1
  s_nop 1
  v_cndmask_b32 v12, v22, v12, vcc
  s_lshl_b32 s45, s48, 12
  s_add_u32 s45, s45, 0
  v_add_u32 v13, s45, v2
  s_and_b32 s46, s48, 1
  s_lshl_b32 s45, s46, 10
  s_add_u32 s45, s45, 0
  v_add_u32 v14, s45, v2
  s_mul_i32 s45, s46, 14
  s_add_u32 s45, s45, s65
  s_lshl_b32 s45, s45, 10
  v_add_u32 v15, s45, v2
  s_lshl_b32 s45, s46, 11
  s_lshl_b32 s44, s65, 7
  s_add_u32 s45, s45, s44
  v_lshlrev_b32 v16, 3, v9
  v_add_u32 v16, s45, v16
  v_mov_b32 v11, 1073741824
  v_cmp_eq_u32 vcc, 0, v10
  s_nop 1
  v_cndmask_b32 v16, v11, v16, vcc
  s_lshl_b32 s45, s46, 4
  v_add_u32 v17, s45, v9
  v_mul_u32_u24 v17, 896, v17
  v_lshl_add_u32 v17, v10, 4, v17
  s_lshl_b32 s45, s65, 6
  v_add_u32 v17, s45, v17
  s_mov_b32 s61, 0
  s_lshl_b32 s67, s58, 6
  s_add_u32 s67, s67, s61
  s_mul_i32 s67, s67, 3584
  s_add_u32 s67, s67, 124092416
  s_lshl_b32 s44, s65, 8
  s_add_u32 s67, s67, s44
  s_lshl_b32 s68, s58, 6
  s_add_u32 s68, s68, s61
  s_mul_i32 s68, s68, 458752
  s_add_u32 s68, s68, 21331968
  s_lshl_b32 s44, s65, 15
  s_add_u32 s68, s68, s44
  s_add_u32 s69, s68, 16384
  s_mul_i32 s70, s61, 638976
  s_cmp_eq_u32 s58, 0
  s_cselect_b32 s47, 0, 40960
  s_add_u32 s70, s70, s47
  s_add_u32 s70, s70, 80052224
  s_add_u32 s71, s70, 4096
  s_mul_i32 s72, s61, 638976
  s_cmp_eq_u32 s58, 0
  s_cselect_b32 s47, 0, 28672
  s_add_u32 s72, s72, s47
  s_add_u32 s72, s72, 80134144
  s_mul_i32 s73, s61, 638976
  s_cmp_eq_u32 s58, 0
  s_cselect_b32 s47, 0, 4096
  s_add_u32 s73, s73, s47
  s_add_u32 s73, s73, 80220160
  s_mul_i32 s75, s61, 638976
  s_cmp_eq_u32 s58, 0
  s_cselect_b32 s47, 0, 114688
  s_add_u32 s75, s75, s47
  s_add_u32 s75, s75, 80461824
  s_lshl_b32 s44, s65, 13
  s_add_u32 s75, s75, s44
  s_cmp_eq_u32 s58, 0
  s_cselect_b32 s74, 0, 80191488
  s_cmp_eq_u32 s58, 0
  s_cbranch_scc1 nofill_129
  s_mov_b32 s44, 124
  s_cmp_ge_u32 s49, 224
  s_cselect_b32 s44, 192, s44
  s_cmp_lt_u32 s49, 128
  s_cselect_b32 s44, 96, s44
  s_sub_u32 s44, s49, s44
  s_lshl_b32 s44, s44, 12
  s_add_u32 s55, s44, 85164032
  s_mov_b32 s45, 90275840
  s_mov_b32 s56, 124786944
  s_lshl_b32 s47, s48, 10
  v_add_u32 v24, s47, v2
  v_mov_b32 v26, -1
  v_mov_b32 v27, -1
  v_mov_b32 v28, -1
  v_mov_b32 v29, -1
  s_cmp_eq_u32 s49, 191
  s_cselect_b32 s47, 29, 1
  v_mov_b32 v25, s47
fgrp_130:
  s_mov_b32 s44, s55
fill_131:
  buffer_store_dwordx4 v[26:29], v24, s[32:35], s44 offen sc1
  s_add_u32 s44, s44, 278528
  s_cmp_lt_u32 s44, s45
  s_cbranch_scc1 fill_131
  s_waitcnt vmcnt(0)
  s_barrier
  s_cmp_lg_u32 s48, 0
  s_cbranch_scc1 fd_132
  s_mov_b64 exec, 1
  buffer_atomic_add v25, off, s[32:35], s56 sc1
  s_mov_b64 exec, -1
fd_132:
  s_add_u32 s55, s55, 5111808
  s_add_u32 s45, s45, 5111808
  s_add_u32 s56, s56, 128
  s_cmp_le_u32 s45, 120946688
  s_cbranch_scc1 fgrp_130
nofill_129:
  v_mov_b32 v140, 0
  v_and_b32 v140, v140, v141
  v_cmp_ne_u32 vcc, 1, v140
  s_cbranch_vccz fok_133
  s_mov_b32 s52, 60000
poll_134:
  buffer_load_dword v140, v8, s[32:35], s67 offen sc1
  buffer_load_dword v141, v8, s[32:35], s67 offen offset:128 sc1
  s_waitcnt vmcnt(0)
  v_and_b32 v140, v140, v141
  v_cmp_ne_u32 vcc, 1, v140
  s_cbranch_vccz pok_135
  s_sleep 2
  s_sub_u32 s52, s52, 1
  s_cbranch_scc0 poll_134
  s_mov_b32 s54, 46
  s_branch k1_fail
pok_135:
fok_133:
  s_cmp_eq_u32 s58, 0
  s_cbranch_scc0 res_136
  buffer_load_dwordx4 v[120:123], v17, s[40:43], s74 offen
  s_add_u32 s74, s74, 28672
  s_branch resd_137
res_136:
  buffer_load_dwordx4 v[120:123], v15, s[32:35], s74 offen sc1
  s_add_u32 s74, s74, 638976
resd_137:
  buffer_load_dwordx4 v[24:27], v5, s[32:35], s68 offen offset:0 sc1
  buffer_load_dwordx4 v[28:31], v5, s[32:35], s69 offen offset:0 sc1
  buffer_load_dwordx4 v[32:35], v5, s[32:35], s68 offen offset:1024 sc1
  buffer_load_dwordx4 v[36:39], v5, s[32:35], s69 offen offset:1024 sc1
  buffer_load_dwordx4 v[40:43], v5, s[32:35], s68 offen offset:2048 sc1
  buffer_load_dwordx4 v[44:47], v5, s[32:35], s69 offen offset:2048 sc1
  buffer_load_dwordx4 v[48:51], v5, s[32:35], s68 offen offset:3072 sc1
  buffer_load_dwordx4 v[52:55], v5, s[32:35], s69 offen offset:3072 sc1
  s_add_u32 s67, s67, 3584
  s_add_u32 s68, s68, 458752
  s_add_u32 s69, s69, 458752
  buffer_load_dword v140, v8, s[32:35], s67 offen sc1
  buffer_load_dword v141, v8, s[32:35], s67 offen offset:128 sc1
o_138:
  s_mov_b32 s51, s61
  s_and_b32 s44, s61, 7
  s_cmp_ge_u32 s44, 1
  s_cbranch_scc1 rdy_139
  s_lshr_b32 s44, s61, 3
  s_lshl_b32 s44, s44, 7
  s_add_u32 s44, s44, 124786816
  v_mov_b32 v10, 0
  s_mov_b32 s52, 60000
poll_140:
  buffer_load_dword v11, v10, s[32:35], s44 offen sc1
  s_waitcnt vmcnt(0)
  v_cmp_ne_u32 vcc, 96, v11
  s_cbranch_vccz pok_141
  s_sleep 8
  s_sub_u32 s52, s52, 1
  s_cbranch_scc0 poll_140
  s_mov_b32 s54, 45
  s_branch k1_fail
pok_141:
rdy_139:
  buffer_load_dword v88, v7, s[32:35], s70 offen offset:0 sc1
  buffer_load_dword v92, v7, s[32:35], s70 offen offset:256 sc1
  buffer_load_dword v89, v7, s[32:35], s70 offen offset:512 sc1
  buffer_load_dword v93, v7, s[32:35], s70 offen offset:768 sc1
  buffer_load_dword v90, v7, s[32:35], s70 offen offset:1024 sc1
  buffer_load_dword v94, v7, s[32:35], s70 offen offset:1280 sc1
  buffer_load_dword v91, v7, s[32:35], s70 offen offset:1536 sc1
  buffer_load_dword v95, v7, s[32:35], s70 offen offset:1792 sc1
  buffer_load_dwordx4 v[56:59], v6, s[32:35], s70 offen offset:0 sc1
  buffer_load_dwordx4 v[60:63], v6, s[32:35], s70 offen offset:1024 sc1
  buffer_load_dwordx4 v[64:67], v6, s[32:35], s70 offen offset:2048 sc1
  buffer_load_dwordx4 v[68:71], v6, s[32:35], s70 offen offset:3072 sc1
  buffer_load_dwordx4 v[72:75], v6, s[32:35], s71 offen offset:0 sc1
  buffer_load_dwordx4 v[76:79], v6, s[32:35], s71 offen offset:1024 sc1
  buffer_load_dwordx4 v[80:83], v6, s[32:35], s71 offen offset:2048 sc1
  buffer_load_dwordx4 v[84:87], v6, s[32:35], s71 offen offset:3072 sc1
  s_waitcnt vmcnt(0)
  v_max3_u32 v11, v56, v57, v58
  v_max3_u32 v11, v11, v59, v60
  v_max3_u32 v11, v11, v61, v62
  v_max3_u32 v11, v11, v63, v64
  v_max3_u32 v11, v11, v65, v66
  v_max3_u32 v11, v11, v67, v68
  v_max3_u32 v11, v11, v69, v70
  v_max3_u32 v11, v11, v71, v72
  v_max3_u32 v11, v11, v73, v74
  v_max3_u32 v11, v11, v75, v76
  v_max3_u32 v11, v11, v77, v78
  v_max3_u32 v11, v11, v79, v80
  v_max3_u32 v11, v11, v81, v82
  v_max3_u32 v11, v11, v83, v84
  v_max3_u32 v11, v11, v85, v86
  v_max3_u32 v11, v11, v87, v88
  v_max3_u32 v11, v11, v89, v90
  v_max3_u32 v11, v11, v91, v92
  v_max3_u32 v11, v11, v93, v94
  v_max_u32 v11, v11, v95
  v_cmp_eq_u32 vcc, -1, v11
  s_cbranch_vccz pok_142
  s_mov_b32 s52, 60000
poll_143:
  buffer_load_dword v11, v12, s[32:35], s70 offen sc1
  s_waitcnt vmcnt(0)
  v_cmp_eq_u32 vcc, -1, v11
  s_cbranch_vccz pok_144
  s_sleep 2
  s_sub_u32 s52, s52, 1
  s_cbranch_scc0 poll_143
  s_mov_b32 s54, 49
  s_branch k1_fail
pok_144:
  s_mov_b32 s52, 60000
poll_145:
  buffer_load_dword v88, v7, s[32:35], s70 offen offset:0 sc1
  buffer_load_dword v92, v7, s[32:35], s70 offen offset:256 sc1
  buffer_load_dword v89, v7, s[32:35], s70 offen offset:512 sc1
  buffer_load_dword v93, v7, s[32:35], s70 offen offset:768 sc1
  buffer_load_dword v90, v7, s[32:35], s70 offen offset:1024 sc1
  buffer_load_dword v94, v7, s[32:35], s70 offen offset:1280 sc1
  buffer_load_dword v91, v7, s[32:35], s70 offen offset:1536 sc1
  buffer_load_dword v95, v7, s[32:35], s70 offen offset:1792 sc1
  buffer_load_dwordx4 v[56:59], v6, s[32:35], s70 offen offset:0 sc1
  buffer_load_dwordx4 v[60:63], v6, s[32:35], s70 offen offset:1024 sc1
  buffer_load_dwordx4 v[64:67], v6, s[32:35], s70 offen offset:2048 sc1
  buffer_load_dwordx4 v[68:71], v6, s[32:35], s70 offen offset:3072 sc1
  buffer_load_dwordx4 v[72:75], v6, s[32:35], s71 offen offset:0 sc1
  buffer_load_dwordx4 v[76:79], v6, s[32:35], s71 offen offset:1024 sc1
  buffer_load_dwordx4 v[80:83], v6, s[32:35], s71 offen offset:2048 sc1
  buffer_load_dwordx4 v[84:87], v6, s[32:35], s71 offen offset:3072 sc1
  s_waitcnt vmcnt(0)
  v_max3_u32 v11, v56, v57, v58
  v_max3_u32 v11, v11, v59, v60
  v_max3_u32 v11, v11, v61, v62
  v_max3_u32 v11, v11, v63, v64
  v_max3_u32 v11, v11, v65, v66
  v_max3_u32 v11, v11, v67, v68
  v_max3_u32 v11, v11, v69, v70
  v_max3_u32 v11, v11, v71, v72
  v_max3_u32 v11, v11, v73, v74
  v_max3_u32 v11, v11, v75, v76
  v_max3_u32 v11, v11, v77, v78
  v_max3_u32 v11, v11, v79, v80
  v_max3_u32 v11, v11, v81, v82
  v_max3_u32 v11, v11, v83, v84
  v_max3_u32 v11, v11, v85, v86
  v_max3_u32 v11, v11, v87, v88
  v_max3_u32 v11, v11, v89, v90
  v_max3_u32 v11, v11, v91, v92
  v_max3_u32 v11, v11, v93, v94
  v_max_u32 v11, v11, v95
  v_cmp_eq_u32 vcc, -1, v11
  s_cbranch_vccz pok_146
  s_sleep 2
  s_sub_u32 s52, s52, 1
  s_cbranch_scc0 poll_145
  s_mov_b32 s54, 47
  s_branch k1_fail
pok_146:
pok_142:
  buffer_load_dwordx4 v[96:99], v4, s[32:35], s75 offen offset:0 sc1
  buffer_load_dwordx4 v[100:103], v4, s[32:35], s75 offen offset:1024 sc1
  v_mfma_f32_16x16x32_bf16 v[104:107], v[24:27], v[56:59], 0
  v_mfma_f32_16x16x32_bf16 v[108:111], v[24:27], v[60:63], 0
  v_mfma_f32_16x16x32_bf16 v[112:115], v[28:31], v[56:59], 0
  v_mfma_f32_16x16x32_bf16 v[116:119], v[28:31], v[60:63], 0
  v_mfma_f32_16x16x32_bf16 v[104:107], v[32:35], v[64:67], v[104:107]
  v_mfma_f32_16x16x32_bf16 v[108:111], v[32:35], v[68:71], v[108:111]
  v_mfma_f32_16x16x32_bf16 v[112:115], v[36:39], v[64:67], v[112:115]
  v_mfma_f32_16x16x32_bf16 v[116:119], v[36:39], v[68:71], v[116:119]
  v_mfma_f32_16x16x32_bf16 v[104:107], v[40:43], v[72:75], v[104:107]
  v_mfma_f32_16x16x32_bf16 v[108:111], v[40:43], v[76:79], v[108:111]
  v_mfma_f32_16x16x32_bf16 v[112:115], v[44:47], v[72:75], v[112:115]
  v_mfma_f32_16x16x32_bf16 v[116:119], v[44:47], v[76:79], v[116:119]
  v_mfma_f32_16x16x32_bf16 v[104:107], v[48:51], v[80:83], v[104:107]
  v_mfma_f32_16x16x32_bf16 v[108:111], v[48:51], v[84:87], v[108:111]
  v_mfma_f32_16x16x32_bf16 v[112:115], v[52:55], v[80:83], v[112:115]
  v_mfma_f32_16x16x32_bf16 v[116:119], v[52:55], v[84:87], v[116:119]
  s_waitcnt vmcnt(0)
  v_max3_u32 v11, v96, v97, v98
  v_max3_u32 v11, v11, v99, v100
  v_max3_u32 v11, v11, v101, v102
  v_max_u32 v11, v11, v103
  v_cmp_eq_u32 vcc, -1, v11
  s_cbranch_vccz wok_147
  s_mov_b32 s52, 60000
poll_148:
  buffer_load_dwordx4 v[96:99], v4, s[32:35], s75 offen offset:0 sc1
  buffer_load_dwordx4 v[100:103], v4, s[32:35], s75 offen offset:1024 sc1
  s_waitcnt vmcnt(0)
  v_max3_u32 v11, v96, v97, v98
  v_max3_u32 v11, v11, v99, v100
  v_max3_u32 v11, v11, v101, v102
  v_max_u32 v11, v11, v103
  v_cmp_eq_u32 vcc, -1, v11
  s_cbranch_vccz pok_149
  s_sleep 2
  s_sub_u32 s52, s52, 1
  s_cbranch_scc0 poll_148
  s_mov_b32 s54, 48
  s_branch k1_fail
pok_149:
wok_147:
  v_mfma_f32_16x16x32_bf16 v[104:107], v[96:99], v[88:91], v[104:107]
  v_mfma_f32_16x16x32_bf16 v[108:111], v[96:99], v[92:95], v[108:111]
  v_mfma_f32_16x16x32_bf16 v[112:115], v[100:103], v[88:91], v[112:115]
  v_mfma_f32_16x16x32_bf16 v[116:119], v[100:103], v[92:95], v[116:119]
  s_add_u32 s70, s70, 638976
  s_add_u32 s71, s71, 638976
  s_add_u32 s75, s75, 638976
  s_nop 1
  ds_write_b128 v13, v[104:107] offset:0
  ds_write_b128 v13, v[108:111] offset:1024
  ds_write_b128 v13, v[112:115] offset:2048
  ds_write_b128 v13, v[116:119] offset:3072
  s_waitcnt lgkmcnt(0)
  s_barrier
  s_cmp_ge_u32 s48, 2
  s_cbranch_scc1 noepi_150
  ds_read_b128 v[144:147], v14 offset:0
  ds_read_b128 v[148:151], v14 offset:4096
  ds_read_b128 v[152:155], v14 offset:8192
  ds_read_b128 v[156:159], v14 offset:12288
  ds_read_b128 v[160:163], v14 offset:2048
  ds_read_b128 v[164:167], v14 offset:6144
  ds_read_b128 v[168:171], v14 offset:10240
  ds_read_b128 v[172:175], v14 offset:14336
  v_lshlrev_b32 v124, 16, v120
  v_and_b32 v125, 0xffff0000, v120
  v_lshlrev_b32 v126, 16, v121
  v_and_b32 v127, 0xffff0000, v121
  v_lshlrev_b32 v128, 16, v122
  v_and_b32 v129, 0xffff0000, v122
  v_lshlrev_b32 v130, 16, v123
  v_and_b32 v131, 0xffff0000, v123
  s_waitcnt lgkmcnt(4)
  v_pk_add_f32 v[144:145], v[144:145], v[148:149]
  v_pk_add_f32 v[152:153], v[152:153], v[156:157]
  v_pk_add_f32 v[146:147], v[146:147], v[150:151]
  v_pk_add_f32 v[154:155], v[154:155], v[158:159]
  v_pk_add_f32 v[144:145], v[144:145], v[152:153]
  v_pk_add_f32 v[146:147], v[146:147], v[154:155]
  v_pk_add_f32 v[124:125], v[124:125], v[144:145]
  v_pk_add_f32 v[126:127], v[126:127], v[146:147]
  s_waitcnt lgkmcnt(0)
  v_pk_add_f32 v[160:161], v[160:161], v[164:165]
  v_pk_add_f32 v[168:169], v[168:169], v[172:173]
  v_pk_add_f32 v[162:163], v[162:163], v[166:167]
  v_pk_add_f32 v[170:171], v[170:171], v[174:175]
  v_pk_add_f32 v[160:161], v[160:161], v[168:169]
  v_pk_add_f32 v[162:163], v[162:163], v[170:171]
  v_pk_add_f32 v[128:129], v[128:129], v[160:161]
  v_pk_add_f32 v[130:131], v[130:131], v[162:163]
  v_cvt_pk_bf16_f32 v136, v124, v125
  v_cvt_pk_bf16_f32 v137, v126, v127
  v_cvt_pk_bf16_f32 v138, v128, v129
  v_cvt_pk_bf16_f32 v139, v130, v131
  v_min_u32 v136, -2, v136
  v_min_u32 v137, -2, v137
  v_min_u32 v138, -2, v138
  v_min_u32 v139, -2, v139
  buffer_store_dwordx4 v[136:139], v15, s[32:35], s72 offen sc1
  v_add_f32 v132, v124, v125
  v_add_f32 v133, v126, v127
  v_add_f32 v134, v128, v129
  v_add_f32 v135, v130, v131
  v_add_f32 v132, v132, v133
  v_add_f32 v134, v134, v135
  v_add_f32 v132, v132, v134
  v_mov_b32 v134, v132
  s_nop 1
  v_permlane16_swap_b32 v132, v134
  v_add_f32 v132, v132, v134
  v_mov_b32 v134, v132
  s_nop 1
  v_permlane32_swap_b32 v132, v134
  v_add_f32 v132, v132, v134
  v_mul_f32 v132, 0x3d000000, v132
  v_sub_f32 v124, v124, v132
  v_sub_f32 v125, v125, v132
  v_sub_f32 v126, v126, v132
  v_sub_f32 v127, v127, v132
  v_sub_f32 v128, v128, v132
  v_sub_f32 v129, v129, v132
  v_sub_f32 v130, v130, v132
  v_sub_f32 v131, v131, v132
  v_mul_f32 v133, v124, v124
  v_mul_f32 v135, v125, v125
  v_fmac_f32 v133, v126, v126
  v_fmac_f32 v135, v127, v127
  v_fmac_f32 v133, v128, v128
  v_fmac_f32 v135, v129, v129
  v_fmac_f32 v133, v130, v130
  v_fmac_f32 v135, v131, v131
  v_add_f32 v133, v133, v135
  v_mov_b32 v134, v133
  s_nop 1
  v_permlane16_swap_b32 v133, v134
  v_add_f32 v133, v133, v134
  v_mov_b32 v134, v133
  s_nop 1
  v_permlane32_swap_b32 v133, v134
  v_add_f32 v133, v133, v134
  v_min_u32 v132, -2, v132
  v_min_u32 v133, -2, v133
  buffer_store_dwordx2 v[132:133], v16, s[32:35], s73 offen sc1
noepi_150:
  s_cmp_eq_u32 s61, 63
  s_cbranch_scc1 lu_151
  v_and_b32 v140, v140, v141
  v_cmp_ne_u32 vcc, 1, v140
  s_cbranch_vccz fok_152
  s_mov_b32 s52, 60000
poll_153:
  buffer_load_dword v140, v8, s[32:35], s67 offen sc1
  buffer_load_dword v141, v8, s[32:35], s67 offen offset:128 sc1
  s_waitcnt vmcnt(0)
  v_and_b32 v140, v140, v141
  v_cmp_ne_u32 vcc, 1, v140
  s_cbranch_vccz pok_154
  s_sleep 2
  s_sub_u32 s52, s52, 1
  s_cbranch_scc0 poll_153
  s_mov_b32 s54, 46
  s_branch k1_fail
pok_154:
fok_152:
  s_cmp_eq_u32 s58, 0
  s_cbranch_scc0 res_155
  buffer_load_dwordx4 v[120:123], v17, s[40:43], s74 offen
  s_add_u32 s74, s74, 28672
  s_branch resd_156
res_155:
  buffer_load_dwordx4 v[120:123], v15, s[32:35], s74 offen sc1
  s_add_u32 s74, s74, 638976
resd_156:
  buffer_load_dwordx4 v[24:27], v5, s[32:35], s68 offen offset:0 sc1
  buffer_load_dwordx4 v[28:31], v5, s[32:35], s69 offen offset:0 sc1
  buffer_load_dwordx4 v[32:35], v5, s[32:35], s68 offen offset:1024 sc1
  buffer_load_dwordx4 v[36:39], v5, s[32:35], s69 offen offset:1024 sc1
  buffer_load_dwordx4 v[40:43], v5, s[32:35], s68 offen offset:2048 sc1
  buffer_load_dwordx4 v[44:47], v5, s[32:35], s69 offen offset:2048 sc1
  buffer_load_dwordx4 v[48:51], v5, s[32:35], s68 offen offset:3072 sc1
  buffer_load_dwordx4 v[52:55], v5, s[32:35], s69 offen offset:3072 sc1
  s_add_u32 s67, s67, 3584
  s_add_u32 s68, s68, 458752
  s_add_u32 s69, s69, 458752
  buffer_load_dword v140, v8, s[32:35], s67 offen sc1
  buffer_load_dword v141, v8, s[32:35], s67 offen offset:128 sc1
lu_151:
  v_xor_b32 v13, 0x4000, v13
  v_xor_b32 v14, 0x4000, v14
  s_add_u32 s72, s72, 638976
  s_add_u32 s73, s73, 638976
  s_add_u32 s61, s61, 1
  s_cmp_lt_u32 s61, 64
  s_cbranch_scc1 o_138
  s_endpgm
r_fill:
  s_cmp_eq_u32 s58, 0
  s_cbranch_scc1 nofill_157
  s_mov_b32 s44, 124
  s_cmp_ge_u32 s49, 224
  s_cselect_b32 s44, 192, s44
  s_cmp_lt_u32 s49, 128
  s_cselect_b32 s44, 96, s44
  s_sub_u32 s44, s49, s44
  s_lshl_b32 s44, s44, 12
  s_add_u32 s55, s44, 85164032
  s_mov_b32 s45, 90275840
  s_mov_b32 s56, 124786944
  s_lshl_b32 s47, s48, 10
  v_add_u32 v8, s47, v2
  v_mov_b32 v10, -1
  v_mov_b32 v11, -1
  v_mov_b32 v12, -1
  v_mov_b32 v13, -1
  s_cmp_eq_u32 s49, 191
  s_cselect_b32 s47, 29, 1
  v_mov_b32 v9, s47
fgrp_158:
  s_mov_b32 s44, s55
fill_159:
  buffer_store_dwordx4 v[10:13], v8, s[32:35], s44 offen sc1
  s_add_u32 s44, s44, 278528
  s_cmp_lt_u32 s44, s45
  s_cbranch_scc1 fill_159
  s_waitcnt vmcnt(0)
  s_barrier
  s_cmp_lg_u32 s48, 0
  s_cbranch_scc1 fd_160
  s_mov_b64 exec, 1
  buffer_atomic_add v9, off, s[32:35], s56 sc1
  s_mov_b64 exec, -1
fd_160:
  s_add_u32 s55, s55, 5111808
  s_add_u32 s45, s45, 5111808
  s_add_u32 s56, s56, 128
  s_cmp_le_u32 s45, 120946688
  s_cbranch_scc1 fgrp_158
nofill_157:
  s_endpgm
r_TA:
  s_and_b32 s59, s50, 15
  s_and_b32 s46, s48, 1
  s_mul_i32 s47, s48, 7
  s_lshr_b32 s44, s47, 1
  s_add_u32 s45, s44, 4
  s_cmp_ge_u32 s45, 14
  s_cselect_b32 s55, 14, 0
  s_sub_u32 s45, s45, s55
  s_lshl_b32 s60, s45, 10
  s_add_u32 s45, s44, 5
  s_cmp_ge_u32 s45, 14
  s_cselect_b32 s55, 14, 0
  s_sub_u32 s45, s45, s55
  s_lshl_b32 s61, s45, 10
  s_add_u32 s45, s44, 6
  s_cmp_ge_u32 s45, 14
  s_cselect_b32 s55, 14, 0
  s_sub_u32 s45, s45, s55
  s_lshl_b32 s62, s45, 10
  s_add_u32 s45, s44, 7
  s_cmp_ge_u32 s45, 14
  s_cselect_b32 s55, 14, 0
  s_sub_u32 s45, s45, s55
  s_lshl_b32 s63, s45, 10
  s_add_u32 s45, s44, 8
  s_cmp_ge_u32 s45, 14
  s_cselect_b32 s55, 14, 0
  s_sub_u32 s45, s45, s55
  s_lshl_b32 s64, s45, 10
  s_add_u32 s45, s44, 9
  s_cmp_ge_u32 s45, 14
  s_cselect_b32 s55, 14, 0
  s_sub_u32 s45, s45, s55
  s_lshl_b32 s65, s45, 10
  s_add_u32 s45, s44, 10
  s_cmp_ge_u32 s45, 14
  s_cselect_b32 s55, 14, 0
  s_sub_u32 s45, s45, s55
  s_lshl_b32 s66, s45, 10
  s_add_u32 s45, s44, 11
  s_cmp_ge_u32 s45, 14
  s_cselect_b32 s55, 14, 0
  s_sub_u32 s45, s45, s55
  s_lshl_b32 s67, s45, 10
  s_add_u32 s45, s44, 12
  s_cmp_ge_u32 s45, 14
  s_cselect_b32 s55, 14, 0
  s_sub_u32 s45, s45, s55
  s_lshl_b32 s68, s45, 10
  s_add_u32 s45, s44, 13
  s_cmp_ge_u32 s45, 14
  s_cselect_b32 s55, 14, 0
  s_sub_u32 s45, s45, s55
  s_lshl_b32 s69, s45, 10
  s_add_u32 s45, s44, 0
  s_add_u32 s45, s45, s46
  s_lshl_b32 s70, s45, 10
  s_add_u32 s45, s44, 1
  s_add_u32 s45, s45, s46
  s_lshl_b32 s71, s45, 10
  s_add_u32 s45, s44, 2
  s_add_u32 s45, s45, s46
  s_lshl_b32 s72, s45, 10
  s_cmp_eq_u32 s46, 0
  s_cselect_b32 s55, 3, 0
  s_add_u32 s45, s44, s55
  s_lshl_b32 s73, s45, 10
  s_add_u32 s45, s47, 0
  s_add_u32 s45, s45, s46
  s_mul_i32 s55, s59, 28
  s_add_u32 s45, s45, s55
  s_mul_i32 s45, s45, 14336
  s_add_u32 s74, s45, 0
  s_add_u32 s45, s47, 1
  s_add_u32 s45, s45, s46
  s_mul_i32 s55, s59, 28
  s_add_u32 s45, s45, s55
  s_mul_i32 s45, s45, 14336
  s_add_u32 s75, s45, 0
  s_add_u32 s45, s47, 2
  s_add_u32 s45, s45, s46
  s_mul_i32 s55, s59, 28
  s_add_u32 s45, s45, s55
  s_mul_i32 s45, s45, 14336
  s_add_u32 s76, s45, 0
  s_add_u32 s45, s47, 3
  s_add_u32 s45, s45, s46
  s_mul_i32 s55, s59, 28
  s_add_u32 s45, s45, s55
  s_mul_i32 s45, s45, 14336
  s_add_u32 s77, s45, 0
  s_add_u32 s45, s47, 4
  s_add_u32 s45, s45, s46
  s_mul_i32 s55, s59, 28
  s_add_u32 s45, s45, s55
  s_mul_i32 s45, s45, 14336
  s_add_u32 s78, s45, 0
  s_add_u32 s45, s47, 5
  s_add_u32 s45, s45, s46
  s_mul_i32 s55, s59, 28
  s_add_u32 s45, s45, s55
  s_mul_i32 s45, s45, 14336
  s_add_u32 s79, s45, 0
  s_cmp_eq_u32 s46, 0
  s_cselect_b32 s55, 6, 0
  s_add_u32 s45, s47, s55
  s_mul_i32 s55, s59, 28
  s_add_u32 s45, s45, s55
  s_mul_i32 s45, s45, 14336
  s_add_u32 s80, s45, 0
  s_mov_b32 s82, s70
  s_mov_b32 s83, s71
  s_mov_b32 s84, s72
  s_mov_b32 s85, s73
  s_mov_b32 s60, 0
  s_mov_b32 s61, 1024
  s_mov_b32 s62, 2048
  s_mov_b32 s63, 3072
  s_mov_b32 s64, 4096
  s_mov_b32 s65, 5120
  s_mov_b32 s66, 6144
  s_mov_b32 s67, 7168
  s_mov_b32 s68, 8192
  s_mov_b32 s69, 9216
  s_mov_b32 s70, 10240
  s_mov_b32 s71, 11264
  s_mov_b32 s72, 12288
  s_mov_b32 s73, 13312
  s_add_u32 s45, s74, s60
  buffer_load_dwordx4 a[0:3], v2, s[32:35], s45 offen
  s_add_u32 s45, s74, s61
  buffer_load_dwordx4 a[4:7], v2, s[32:35], s45 offen
  s_add_u32 s45, s74, s62
  buffer_load_dwordx4 a[8:11], v2, s[32:35], s45 offen
  s_add_u32 s45, s74, s63
  buffer_load_dwordx4 a[12:15], v2, s[32:35], s45 offen
  s_add_u32 s45, s74, s64
  buffer_load_dwordx4 a[16:19], v2, s[32:35], s45 offen
  s_add_u32 s45, s74, s65
  buffer_load_dwordx4 a[20:23], v2, s[32:35], s45 offen
  s_add_u32 s45, s74, s66
  buffer_load_dwordx4 a[24:27], v2, s[32:35], s45 offen
  s_add_u32 s45, s74, s67
  buffer_load_dwordx4 a[28:31], v2, s[32:35], s45 offen
  s_add_u32 s45, s74, s68
  buffer_load_dwordx4 a[32:35], v2, s[32:35], s45 offen
  s_add_u32 s45, s74, s69
  buffer_load_dwordx4 a[36:39], v2, s[32:35], s45 offen
  s_add_u32 s45, s74, s70
  buffer_load_dwordx4 a[40:43], v2, s[32:35], s45 offen
  s_add_u32 s45, s74, s71
  buffer_load_dwordx4 a[44:47], v2, s[32:35], s45 offen
  s_add_u32 s45, s74, s72
  buffer_load_dwordx4 a[48:51], v2, s[32:35], s45 offen
  s_add_u32 s45, s74, s73
  buffer_load_dwordx4 a[52:55], v2, s[32:35], s45 offen
  s_add_u32 s45, s75, s60
  buffer_load_dwordx4 a[56:59], v2, s[32:35], s45 offen
  s_add_u32 s45, s75, s61
  buffer_load_dwordx4 a[60:63], v2, s[32:35], s45 offen
  s_add_u32 s45, s75, s62
  buffer_load_dwordx4 a[64:67], v2, s[32:35], s45 offen
  s_add_u32 s45, s75, s63
  buffer_load_dwordx4 a[68:71], v2, s[32:35], s45 offen
  s_add_u32 s45, s75, s64
  buffer_load_dwordx4 a[72:75], v2, s[32:35], s45 offen
  s_add_u32 s45, s75, s65
  buffer_load_dwordx4 a[76:79], v2, s[32:35], s45 offen
  s_add_u32 s45, s75, s66
  buffer_load_dwordx4 a[80:83], v2, s[32:35], s45 offen
  s_add_u32 s45, s75, s67
  buffer_load_dwordx4 a[84:87], v2, s[32:35], s45 offen
  s_add_u32 s45, s75, s68
  buffer_load_dwordx4 a[88:91], v2, s[32:35], s45 offen
  s_add_u32 s45, s75, s69
  buffer_load_dwordx4 a[92:95], v2, s[32:35], s45 offen
  s_add_u32 s45, s75, s70
  buffer_load_dwordx4 a[96:99], v2, s[32:35], s45 offen
  s_add_u32 s45, s75, s71
  buffer_load_dwordx4 a[100:103], v2, s[32:35], s45 offen
  s_add_u32 s45, s75, s72
  buffer_load_dwordx4 a[104:107], v2, s[32:35], s45 offen
  s_add_u32 s45, s75, s73
  buffer_load_dwordx4 a[108:111], v2, s[32:35], s45 offen
  s_add_u32 s45, s76, s60
  buffer_load_dwordx4 a[112:115], v2, s[32:35], s45 offen
  s_add_u32 s45, s76, s61
  buffer_load_dwordx4 a[116:119], v2, s[32:35], s45 offen
  s_add_u32 s45, s76, s62
  buffer_load_dwordx4 a[120:123], v2, s[32:35], s45 offen
  s_add_u32 s45, s76, s63
  buffer_load_dwordx4 a[124:127], v2, s[32:35], s45 offen
  s_add_u32 s45, s76, s64
  buffer_load_dwordx4 a[128:131], v2, s[32:35], s45 offen
  s_add_u32 s45, s76, s65
  buffer_load_dwordx4 a[132:135], v2, s[32:35], s45 offen
  s_add_u32 s45, s76, s66
  buffer_load_dwordx4 a[136:139], v2, s[32:35], s45 offen
  s_add_u32 s45, s76, s67
  buffer_load_dwordx4 a[140:143], v2, s[32:35], s45 offen
  s_add_u32 s45, s76, s68
  buffer_load_dwordx4 a[144:147], v2, s[32:35], s45 offen
  s_add_u32 s45, s76, s69
  buffer_load_dwordx4 a[148:151], v2, s[32:35], s45 offen
  s_add_u32 s45, s76, s70
  buffer_load_dwordx4 a[152:155], v2, s[32:35], s45 offen
  s_add_u32 s45, s76, s71
  buffer_load_dwordx4 a[156:159], v2, s[32:35], s45 offen
  s_add_u32 s45, s76, s72
  buffer_load_dwordx4 a[160:163], v2, s[32:35], s45 offen
  s_add_u32 s45, s76, s73
  buffer_load_dwordx4 a[164:167], v2, s[32:35], s45 offen
  s_add_u32 s45, s77, s60
  buffer_load_dwordx4 a[168:171], v2, s[32:35], s45 offen
  s_add_u32 s45, s77, s61
  buffer_load_dwordx4 a[172:175], v2, s[32:35], s45 offen
  s_add_u32 s45, s77, s62
  buffer_load_dwordx4 a[176:179], v2, s[32:35], s45 offen
  s_add_u32 s45, s77, s63
  buffer_load_dwordx4 a[180:183], v2, s[32:35], s45 offen
  s_add_u32 s45, s77, s64
  buffer_load_dwordx4 a[184:187], v2, s[32:35], s45 offen
  s_add_u32 s45, s77, s65
  buffer_load_dwordx4 a[188:191], v2, s[32:35], s45 offen
  s_add_u32 s45, s77, s66
  buffer_load_dwordx4 a[192:195], v2, s[32:35], s45 offen
  s_add_u32 s45, s77, s67
  buffer_load_dwordx4 a[196:199], v2, s[32:35], s45 offen
  s_add_u32 s45, s77, s68
  buffer_load_dwordx4 a[200:203], v2, s[32:35], s45 offen
  s_add_u32 s45, s77, s69
  buffer_load_dwordx4 a[204:207], v2, s[32:35], s45 offen
  s_add_u32 s45, s77, s70
  buffer_load_dwordx4 a[208:211], v2, s[32:35], s45 offen
  s_add_u32 s45, s77, s71
  buffer_load_dwordx4 a[212:215], v2, s[32:35], s45 offen
  s_add_u32 s45, s77, s72
  buffer_load_dwordx4 a[216:219], v2, s[32:35], s45 offen
  s_add_u32 s45, s77, s73
  buffer_load_dwordx4 a[220:223], v2, s[32:35], s45 offen
  s_add_u32 s45, s78, s60
  buffer_load_dwordx4 a[224:227], v2, s[32:35], s45 offen
  s_add_u32 s45, s78, s61
  buffer_load_dwordx4 a[228:231], v2, s[32:35], s45 offen
  s_add_u32 s45, s78, s62
  buffer_load_dwordx4 a[232:235], v2, s[32:35], s45 offen
  s_add_u32 s45, s78, s63
  buffer_load_dwordx4 a[236:239], v2, s[32:35], s45 offen
  s_add_u32 s45, s78, s64
  buffer_load_dwordx4 a[240:243], v2, s[32:35], s45 offen
  s_add_u32 s45, s78, s65
  buffer_load_dwordx4 a[244:247], v2, s[32:35], s45 offen
  s_add_u32 s45, s78, s66
  buffer_load_dwordx4 a[248:251], v2, s[32:35], s45 offen
  s_add_u32 s45, s78, s67
  buffer_load_dwordx4 a[252:255], v2, s[32:35], s45 offen
  s_add_u32 s45, s78, s68
  buffer_load_dwordx4 v[120:123], v2, s[32:35], s45 offen
  s_add_u32 s45, s78, s69
  buffer_load_dwordx4 v[124:127], v2, s[32:35], s45 offen
  s_add_u32 s45, s78, s70
  buffer_load_dwordx4 v[128:131], v2, s[32:35], s45 offen
  s_add_u32 s45, s78, s71
  buffer_load_dwordx4 v[132:135], v2, s[32:35], s45 offen
  s_add_u32 s45, s78, s72
  buffer_load_dwordx4 v[136:139], v2, s[32:35], s45 offen
  s_add_u32 s45, s78, s73
  buffer_load_dwordx4 v[140:143], v2, s[32:35], s45 offen
  s_add_u32 s45, s79, s60
  buffer_load_dwordx4 v[144:147], v2, s[32:35], s45 offen
  s_add_u32 s45, s79, s61
  buffer_load_dwordx4 v[148:151], v2, s[32:35], s45 offen
  s_add_u32 s45, s79, s62
  buffer_load_dwordx4 v[152:155], v2, s[32:35], s45 offen
  s_add_u32 s45, s79, s63
  buffer_load_dwordx4 v[156:159], v2, s[32:35], s45 offen
  s_add_u32 s45, s79, s64
  buffer_load_dwordx4 v[160:163], v2, s[32:35], s45 offen
  s_add_u32 s45, s79, s65
  buffer_load_dwordx4 v[164:167], v2, s[32:35], s45 offen
  s_add_u32 s45, s79, s66
  buffer_load_dwordx4 v[168:171], v2, s[32:35], s45 offen
  s_add_u32 s45, s79, s67
  buffer_load_dwordx4 v[172:175], v2, s[32:35], s45 offen
  s_add_u32 s45, s79, s68
  buffer_load_dwordx4 v[176:179], v2, s[32:35], s45 offen
  s_add_u32 s45, s79, s69
  buffer_load_dwordx4 v[180:183], v2, s[32:35], s45 offen
  s_add_u32 s45, s79, s70
  buffer_load_dwordx4 v[184:187], v2, s[32:35], s45 offen
  s_add_u32 s45, s79, s71
  buffer_load_dwordx4 v[188:191], v2, s[32:35], s45 offen
  s_add_u32 s45, s79, s72
  buffer_load_dwordx4 v[192:195], v2, s[32:35], s45 offen
  s_add_u32 s45, s79, s73
  buffer_load_dwordx4 v[196:199], v2, s[32:35], s45 offen
  s_add_u32 s45, s80, s60
  buffer_load_dwordx4 v[200:203], v2, s[32:35], s45 offen
  s_add_u32 s45, s80, s61
  buffer_load_dwordx4 v[204:207], v2, s[32:35], s45 offen
  s_add_u32 s45, s80, s62
  buffer_load_dwordx4 v[208:211], v2, s[32:35], s45 offen
  s_add_u32 s45, s80, s63
  buffer_load_dwordx4 v[212:215], v2, s[32:35], s45 offen
  s_add_u32 s45, s80, s64
  buffer_load_dwordx4 v[216:219], v2, s[32:35], s45 offen
  s_add_u32 s45, s80, s65
  buffer_load_dwordx4 v[220:223], v2, s[32:35], s45 offen
  s_add_u32 s45, s80, s66
  buffer_load_dwordx4 v[224:227], v2, s[32:35], s45 offen
  s_add_u32 s45, s80, s67
  buffer_load_dwordx4 v[228:231], v2, s[32:35], s45 offen
  s_add_u32 s45, s80, s68
  buffer_load_dwordx4 v[232:235], v2, s[32:35], s45 offen
  s_add_u32 s45, s80, s69
  buffer_load_dwordx4 v[236:239], v2, s[32:35], s45 offen
  s_add_u32 s45, s80, s70
  buffer_load_dwordx4 v[240:243], v2, s[32:35], s45 offen
  s_add_u32 s45, s80, s71
  buffer_load_dwordx4 v[244:247], v2, s[32:35], s45 offen
  s_add_u32 s45, s80, s72
  buffer_load_dwordx4 v[248:251], v2, s[32:35], s45 offen
  s_add_u32 s45, s80, s73
  buffer_load_dwordx4 v[252:255], v2, s[32:35], s45 offen
  s_lshl_b32 s97, s46, 3
  s_mov_b32 s98, s46
  v_and_b32 v9, 15, v1
  v_lshrrev_b32 v10, 4, v1
  s_mul_i32 s45, s48, 7168
  v_add_u32 v3, s45, v2
  s_mul_i32 s45, s48, 6656
  s_add_u32 s45, s45, 65536
  v_mul_u32_u24 v4, 208, v9
  v_lshl_add_u32 v4, v10, 4, v4
  v_add_u32 v4, s45, v4
  v_lshrrev_b32 v9, 3, v0
  v_and_b32 v10, 7, v0
  v_lshrrev_b32 v11, 1, v10
  v_lshlrev_b32 v11, 2, v11
  v_and_b32 v12, 1, v10
  v_lshl_add_u32 v11, v12, 4, v11
  v_add_u32 v12, 0, v11
  v_cmp_le_u32 s[86:87], v12, v9
  v_add_u32 v12, 1, v11
  v_cmp_le_u32 s[88:89], v12, v9
  v_add_u32 v12, 2, v11
  v_cmp_le_u32 s[90:91], v12, v9
  v_add_u32 v12, 3, v11
  v_cmp_le_u32 s[92:93], v12, v9
  v_mul_u32_u24 v12, 208, v9
  v_add_u32 v12, 65536, v12
  v_lshl_add_u32 v5, v11, 2, v12
  v_add_u32 v5, 64, v5
  v_lshl_add_u32 v6, v10, 2, v12
  v_and_b32 v11, 15, v9
  v_lshrrev_b32 v12, 4, v9
  v_lshrrev_b32 v7, 1, v10
  v_lshl_add_u32 v7, v7, 4, v11
  v_lshlrev_b32 v7, 4, v7
  v_lshl_add_u32 v7, v12, 10, v7
  v_and_b32 v13, 1, v10
  v_lshl_add_u32 v7, v13, 3, v7
  s_lshl_b32 s45, s59, 11
  v_add_u32 v7, s45, v7
  v_lshrrev_b32 v8, 1, v10
  v_lshl_add_u32 v8, v8, 4, v11
  v_lshlrev_b32 v8, 2, v8
  v_lshl_add_u32 v8, v12, 8, v8
  s_lshl_b32 s45, s59, 9
  s_add_u32 s45, s45, 32768
  v_add_u32 v8, s45, v8
  v_cmp_eq_u32 vcc, 0, v13
  v_mov_b32 v12, 1073741824
  s_nop 0
  v_cndmask_b32 v8, v12, v8, vcc
  v_and_b32 v9, 15, v1
  v_lshrrev_b32 v10, 4, v1
  v_lshl_add_u32 v15, v10, 3, v9
  v_lshlrev_b32 v15, 4, v15
  v_cmp_gt_u32 vcc, 8, v9
  s_nop 1
  v_cndmask_b32 v15, v12, v15, vcc
  s_lshr_b32 s74, s82, 1
  s_lshr_b32 s75, s83, 1
  s_lshr_b32 s76, s84, 1
  s_lshr_b32 s77, s85, 1
  v_min_u32 v13, 27, v1
  v_lshlrev_b32 v13, 7, v13
  v_mov_b32 v14, 0xceabfb8f
  s_lshr_b32 s94, s50, 4
  s_cmp_eq_u32 s58, 0
  s_cbranch_scc1 nofill_161
  s_mov_b32 s44, 124
  s_cmp_ge_u32 s49, 224
  s_cselect_b32 s44, 192, s44
  s_cmp_lt_u32 s49, 128
  s_cselect_b32 s44, 96, s44
  s_sub_u32 s44, s49, s44
  s_lshl_b32 s44, s44, 12
  s_add_u32 s55, s44, 85164032
  s_mov_b32 s45, 90275840
  s_mov_b32 s56, 124786944
  s_lshl_b32 s47, s48, 10
  v_add_u32 v16, s47, v2
  v_mov_b32 v18, -1
  v_mov_b32 v19, -1
  v_mov_b32 v20, -1
  v_mov_b32 v21, -1
  s_cmp_eq_u32 s49, 191
  s_cselect_b32 s47, 29, 1
  v_mov_b32 v17, s47
fgrp_162:
  s_mov_b32 s44, s55
fill_163:
  buffer_store_dwordx4 v[18:21], v16, s[32:35], s44 offen sc1
  s_add_u32 s44, s44, 278528
  s_cmp_lt_u32 s44, s45
  s_cbranch_scc1 fill_163
  s_waitcnt vmcnt(0)
  s_barrier
  s_cmp_lg_u32 s48, 0
  s_cbranch_scc1 fd_164
  s_mov_b64 exec, 1
  buffer_atomic_add v17, off, s[32:35], s56 sc1
  s_mov_b64 exec, -1
fd_164:
  s_add_u32 s55, s55, 5111808
  s_add_u32 s45, s45, 5111808
  s_add_u32 s56, s56, 128
  s_cmp_le_u32 s45, 120946688
  s_cbranch_scc1 fgrp_162
nofill_161:
  s_lshl_b32 s60, s58, 6
  s_add_u32 s60, s60, s94
  s_mul_i32 s60, s60, 28672
  s_add_u32 s60, s60, 17661952
  s_add_u32 s61, s60, 4096
  s_mul_i32 s62, s94, 3584
  s_add_u32 s62, s62, 124551168
  s_mul_i32 s63, s48, 7168
  s_mov_b32 s64, 0
  v_mov_b32 v0, v2
  v_mov_b32 v118, 0
  s_lshl_b32 s96, s58, 6
  s_add_u32 s96, s96, s94
  s_mul_i32 s96, s96, 7168
  s_add_u32 s96, s96, 121864192
  v_add_u32 v119, s96, v15
ta_165:
  s_mov_b32 s51, s94
  s_cmp_eq_u32 s64, 1
  s_cbranch_scc1 have_167
  s_cmp_eq_u32 s58, 0
  s_cbranch_scc1 nf_166
  s_mov_b32 s52, 60000
poll_168:
  buffer_load_dword v9, v13, s[32:35], s62 offen sc1
  s_waitcnt vmcnt(0)
  v_cmp_ne_u32 vcc, 1, v9
  s_cbranch_vccz pok_169
  s_sleep 2
  s_sub_u32 s52, s52, 1
  s_cbranch_scc0 poll_168
  s_mov_b32 s54, 30
  s_branch k1_fail
pok_169:
nf_166:
  s_add_u32 m0, s63, 0
  s_nop 0
  buffer_load_dwordx4 v3, s[32:35], s60 offen offset:0 sc1 lds
  s_add_u32 m0, s63, 0
  s_nop 0
  buffer_load_dwordx4 v3, s[32:35], s60 offen offset:1024 sc1 lds
  s_add_u32 m0, s63, 0
  s_nop 0
  buffer_load_dwordx4 v3, s[32:35], s60 offen offset:2048 sc1 lds
  s_add_u32 m0, s63, 0
  s_nop 0
  buffer_load_dwordx4 v3, s[32:35], s60 offen offset:3072 sc1 lds
  s_add_u32 m0, s63, 4096
  s_nop 0
  buffer_load_dwordx4 v3, s[32:35], s61 offen offset:0 sc1 lds
  s_add_u32 m0, s63, 4096
  s_nop 0
  buffer_load_dwordx4 v3, s[32:35], s61 offen offset:1024 sc1 lds
  s_add_u32 m0, s63, 4096
  s_nop 0
  buffer_load_dwordx4 v3, s[32:35], s61 offen offset:2048 sc1 lds
  s_waitcnt vmcnt(0)
have_167:
  s_barrier
  s_add_u32 s60, s60, 57344
  s_add_u32 s61, s61, 57344
  s_add_u32 s62, s62, 7168
  s_xor_b32 s63, s63, 0x8000
  ds_read_b128 v[72:75], v0 offset:0
  ds_read_b128 v[76:79], v0 offset:14336
  ds_read_b128 v[80:83], v0 offset:1024
  ds_read_b128 v[84:87], v0 offset:15360
  s_waitcnt lgkmcnt(2)
  v_mfma_f32_16x16x32_bf16 v[16:19], a[0:3], v[72:75], 0
  ds_read_b128 v[88:91], v0 offset:2048
  v_mfma_f32_16x16x32_bf16 v[20:23], a[0:3], v[76:79], 0
  ds_read_b128 v[92:95], v0 offset:16384
  v_mfma_f32_16x16x32_bf16 v[24:27], a[56:59], v[72:75], 0
  v_mfma_f32_16x16x32_bf16 v[28:31], a[56:59], v[76:79], 0
  buffer_load_dword v118, v13, s[32:35], s62 offen sc1
  v_mfma_f32_16x16x32_bf16 v[32:35], a[112:115], v[72:75], 0
  v_mfma_f32_16x16x32_bf16 v[36:39], a[112:115], v[76:79], 0
  v_mfma_f32_16x16x32_bf16 v[40:43], a[168:171], v[72:75], 0
  v_mfma_f32_16x16x32_bf16 v[44:47], a[168:171], v[76:79], 0
  v_mfma_f32_16x16x32_bf16 v[48:51], a[224:227], v[72:75], 0
  v_mfma_f32_16x16x32_bf16 v[52:55], a[224:227], v[76:79], 0
  v_mfma_f32_16x16x32_bf16 v[56:59], v[144:147], v[72:75], 0
  v_mfma_f32_16x16x32_bf16 v[60:63], v[144:147], v[76:79], 0
  v_mfma_f32_16x16x32_bf16 v[64:67], v[200:203], v[72:75], 0
  v_mfma_f32_16x16x32_bf16 v[68:71], v[200:203], v[76:79], 0
  s_waitcnt lgkmcnt(2)
  v_mfma_f32_16x16x32_bf16 v[16:19], a[4:7], v[80:83], v[16:19]
  ds_read_b128 v[72:75], v0 offset:3072
  v_mfma_f32_16x16x32_bf16 v[20:23], a[4:7], v[84:87], v[20:23]
  ds_read_b128 v[76:79], v0 offset:17408
  v_mfma_f32_16x16x32_bf16 v[24:27], a[60:63], v[80:83], v[24:27]
  v_mfma_f32_16x16x32_bf16 v[28:31], a[60:63], v[84:87], v[28:31]
  v_mfma_f32_16x16x32_bf16 v[32:35], a[116:119], v[80:83], v[32:35]
  v_mfma_f32_16x16x32_bf16 v[36:39], a[116:119], v[84:87], v[36:39]
  v_mfma_f32_16x16x32_bf16 v[40:43], a[172:175], v[80:83], v[40:43]
  v_mfma_f32_16x16x32_bf16 v[44:47], a[172:175], v[84:87], v[44:47]
  v_mfma_f32_16x16x32_bf16 v[48:51], a[228:231], v[80:83], v[48:51]
  v_mfma_f32_16x16x32_bf16 v[52:55], a[228:231], v[84:87], v[52:55]
  v_mfma_f32_16x16x32_bf16 v[56:59], v[148:151], v[80:83], v[56:59]
  v_mfma_f32_16x16x32_bf16 v[60:63], v[148:151], v[84:87], v[60:63]
  v_mfma_f32_16x16x32_bf16 v[64:67], v[204:207], v[80:83], v[64:67]
  v_mfma_f32_16x16x32_bf16 v[68:71], v[204:207], v[84:87], v[68:71]
  s_waitcnt lgkmcnt(2)
  v_mfma_f32_16x16x32_bf16 v[16:19], a[8:11], v[88:91], v[16:19]
  ds_read_b128 v[80:83], v0 offset:4096
  v_mfma_f32_16x16x32_bf16 v[20:23], a[8:11], v[92:95], v[20:23]
  ds_read_b128 v[84:87], v0 offset:18432
  v_mfma_f32_16x16x32_bf16 v[24:27], a[64:67], v[88:91], v[24:27]
  v_mfma_f32_16x16x32_bf16 v[28:31], a[64:67], v[92:95], v[28:31]
  v_mfma_f32_16x16x32_bf16 v[32:35], a[120:123], v[88:91], v[32:35]
  v_mfma_f32_16x16x32_bf16 v[36:39], a[120:123], v[92:95], v[36:39]
  v_mfma_f32_16x16x32_bf16 v[40:43], a[176:179], v[88:91], v[40:43]
  v_mfma_f32_16x16x32_bf16 v[44:47], a[176:179], v[92:95], v[44:47]
  v_mfma_f32_16x16x32_bf16 v[48:51], a[232:235], v[88:91], v[48:51]
  v_mfma_f32_16x16x32_bf16 v[52:55], a[232:235], v[92:95], v[52:55]
  v_mfma_f32_16x16x32_bf16 v[56:59], v[152:155], v[88:91], v[56:59]
  v_mfma_f32_16x16x32_bf16 v[60:63], v[152:155], v[92:95], v[60:63]
  v_mfma_f32_16x16x32_bf16 v[64:67], v[208:211], v[88:91], v[64:67]
  v_mfma_f32_16x16x32_bf16 v[68:71], v[208:211], v[92:95], v[68:71]
  s_waitcnt lgkmcnt(2)
  v_mfma_f32_16x16x32_bf16 v[16:19], a[12:15], v[72:75], v[16:19]
  ds_read_b128 v[88:91], v0 offset:5120
  v_mfma_f32_16x16x32_bf16 v[20:23], a[12:15], v[76:79], v[20:23]
  ds_read_b128 v[92:95], v0 offset:19456
  v_mfma_f32_16x16x32_bf16 v[24:27], a[68:71], v[72:75], v[24:27]
  v_mfma_f32_16x16x32_bf16 v[28:31], a[68:71], v[76:79], v[28:31]
  v_mfma_f32_16x16x32_bf16 v[32:35], a[124:127], v[72:75], v[32:35]
  v_mfma_f32_16x16x32_bf16 v[36:39], a[124:127], v[76:79], v[36:39]
  v_mfma_f32_16x16x32_bf16 v[40:43], a[180:183], v[72:75], v[40:43]
  v_mfma_f32_16x16x32_bf16 v[44:47], a[180:183], v[76:79], v[44:47]
  v_mfma_f32_16x16x32_bf16 v[48:51], a[236:239], v[72:75], v[48:51]
  v_mfma_f32_16x16x32_bf16 v[52:55], a[236:239], v[76:79], v[52:55]
  v_mfma_f32_16x16x32_bf16 v[56:59], v[156:159], v[72:75], v[56:59]
  v_mfma_f32_16x16x32_bf16 v[60:63], v[156:159], v[76:79], v[60:63]
  v_mfma_f32_16x16x32_bf16 v[64:67], v[212:215], v[72:75], v[64:67]
  v_mfma_f32_16x16x32_bf16 v[68:71], v[212:215], v[76:79], v[68:71]
  s_waitcnt lgkmcnt(2)
  v_mfma_f32_16x16x32_bf16 v[16:19], a[16:19], v[80:83], v[16:19]
  ds_read_b128 v[72:75], v0 offset:6144
  v_mfma_f32_16x16x32_bf16 v[20:23], a[16:19], v[84:87], v[20:23]
  ds_read_b128 v[76:79], v0 offset:20480
  v_mfma_f32_16x16x32_bf16 v[24:27], a[72:75], v[80:83], v[24:27]
  v_mfma_f32_16x16x32_bf16 v[28:31], a[72:75], v[84:87], v[28:31]
  v_mfma_f32_16x16x32_bf16 v[32:35], a[128:131], v[80:83], v[32:35]
  v_mfma_f32_16x16x32_bf16 v[36:39], a[128:131], v[84:87], v[36:39]
  v_mfma_f32_16x16x32_bf16 v[40:43], a[184:187], v[80:83], v[40:43]
  v_mfma_f32_16x16x32_bf16 v[44:47], a[184:187], v[84:87], v[44:47]
  v_mfma_f32_16x16x32_bf16 v[48:51], a[240:243], v[80:83], v[48:51]
  v_mfma_f32_16x16x32_bf16 v[52:55], a[240:243], v[84:87], v[52:55]
  v_mfma_f32_16x16x32_bf16 v[56:59], v[160:163], v[80:83], v[56:59]
  v_mfma_f32_16x16x32_bf16 v[60:63], v[160:163], v[84:87], v[60:63]
  v_mfma_f32_16x16x32_bf16 v[64:67], v[216:219], v[80:83], v[64:67]
  v_mfma_f32_16x16x32_bf16 v[68:71], v[216:219], v[84:87], v[68:71]
  s_waitcnt lgkmcnt(2)
  v_mfma_f32_16x16x32_bf16 v[16:19], a[20:23], v[88:91], v[16:19]
  ds_read_b128 v[80:83], v0 offset:7168
  v_mfma_f32_16x16x32_bf16 v[20:23], a[20:23], v[92:95], v[20:23]
  ds_read_b128 v[84:87], v0 offset:21504
  v_mfma_f32_16x16x32_bf16 v[24:27], a[76:79], v[88:91], v[24:27]
  v_mfma_f32_16x16x32_bf16 v[28:31], a[76:79], v[92:95], v[28:31]
  v_mfma_f32_16x16x32_bf16 v[32:35], a[132:135], v[88:91], v[32:35]
  v_mfma_f32_16x16x32_bf16 v[36:39], a[132:135], v[92:95], v[36:39]
  v_mfma_f32_16x16x32_bf16 v[40:43], a[188:191], v[88:91], v[40:43]
  v_mfma_f32_16x16x32_bf16 v[44:47], a[188:191], v[92:95], v[44:47]
  v_mfma_f32_16x16x32_bf16 v[48:51], a[244:247], v[88:91], v[48:51]
  v_mfma_f32_16x16x32_bf16 v[52:55], a[244:247], v[92:95], v[52:55]
  v_mfma_f32_16x16x32_bf16 v[56:59], v[164:167], v[88:91], v[56:59]
  v_mfma_f32_16x16x32_bf16 v[60:63], v[164:167], v[92:95], v[60:63]
  v_mfma_f32_16x16x32_bf16 v[64:67], v[220:223], v[88:91], v[64:67]
  v_mfma_f32_16x16x32_bf16 v[68:71], v[220:223], v[92:95], v[68:71]
  s_waitcnt lgkmcnt(2)
  v_mfma_f32_16x16x32_bf16 v[16:19], a[24:27], v[72:75], v[16:19]
  ds_read_b128 v[88:91], v0 offset:8192
  v_mfma_f32_16x16x32_bf16 v[20:23], a[24:27], v[76:79], v[20:23]
  ds_read_b128 v[92:95], v0 offset:22528
  v_mfma_f32_16x16x32_bf16 v[24:27], a[80:83], v[72:75], v[24:27]
  v_mfma_f32_16x16x32_bf16 v[28:31], a[80:83], v[76:79], v[28:31]
  v_mfma_f32_16x16x32_bf16 v[32:35], a[136:139], v[72:75], v[32:35]
  v_mfma_f32_16x16x32_bf16 v[36:39], a[136:139], v[76:79], v[36:39]
  v_mfma_f32_16x16x32_bf16 v[40:43], a[192:195], v[72:75], v[40:43]
  v_mfma_f32_16x16x32_bf16 v[44:47], a[192:195], v[76:79], v[44:47]
  v_mfma_f32_16x16x32_bf16 v[48:51], a[248:251], v[72:75], v[48:51]
  v_mfma_f32_16x16x32_bf16 v[52:55], a[248:251], v[76:79], v[52:55]
  v_mfma_f32_16x16x32_bf16 v[56:59], v[168:171], v[72:75], v[56:59]
  v_mfma_f32_16x16x32_bf16 v[60:63], v[168:171], v[76:79], v[60:63]
  v_mfma_f32_16x16x32_bf16 v[64:67], v[224:227], v[72:75], v[64:67]
  v_mfma_f32_16x16x32_bf16 v[68:71], v[224:227], v[76:79], v[68:71]
  s_waitcnt lgkmcnt(2)
  v_mfma_f32_16x16x32_bf16 v[16:19], a[28:31], v[80:83], v[16:19]
  ds_read_b128 v[72:75], v0 offset:9216
  v_mfma_f32_16x16x32_bf16 v[20:23], a[28:31], v[84:87], v[20:23]
  ds_read_b128 v[76:79], v0 offset:23552
  v_mfma_f32_16x16x32_bf16 v[24:27], a[84:87], v[80:83], v[24:27]
  v_mfma_f32_16x16x32_bf16 v[28:31], a[84:87], v[84:87], v[28:31]
  v_mfma_f32_16x16x32_bf16 v[32:35], a[140:143], v[80:83], v[32:35]
  v_mfma_f32_16x16x32_bf16 v[36:39], a[140:143], v[84:87], v[36:39]
  s_waitcnt vmcnt(0)
  v_cmp_gt_u32 vcc, s58, v118
  s_nop 1
  s_cmp_eq_u64 vcc, 0
  s_cselect_b32 s64, 1, 0
  s_cselect_b32 s65, s63, 98304
  v_mfma_f32_16x16x32_bf16 v[40:43], a[196:199], v[80:83], v[40:43]
  v_mfma_f32_16x16x32_bf16 v[44:47], a[196:199], v[84:87], v[44:47]
  v_mfma_f32_16x16x32_bf16 v[48:51], a[252:255], v[80:83], v[48:51]
  v_mfma_f32_16x16x32_bf16 v[52:55], a[252:255], v[84:87], v[52:55]
  v_mfma_f32_16x16x32_bf16 v[56:59], v[172:175], v[80:83], v[56:59]
  v_mfma_f32_16x16x32_bf16 v[60:63], v[172:175], v[84:87], v[60:63]
  v_mfma_f32_16x16x32_bf16 v[64:67], v[228:231], v[80:83], v[64:67]
  v_mfma_f32_16x16x32_bf16 v[68:71], v[228:231], v[84:87], v[68:71]
  s_waitcnt lgkmcnt(2)
  v_mfma_f32_16x16x32_bf16 v[16:19], a[32:35], v[88:91], v[16:19]
  ds_read_b128 v[80:83], v0 offset:10240
  v_mfma_f32_16x16x32_bf16 v[20:23], a[32:35], v[92:95], v[20:23]
  ds_read_b128 v[84:87], v0 offset:24576
  s_add_u32 m0, s65, 0
  s_nop 0
  buffer_load_dwordx4 v3, s[32:35], s60 offen offset:0 sc1 lds
  v_mfma_f32_16x16x32_bf16 v[24:27], a[88:91], v[88:91], v[24:27]
  v_mfma_f32_16x16x32_bf16 v[28:31], a[88:91], v[92:95], v[28:31]
  v_mfma_f32_16x16x32_bf16 v[32:35], a[144:147], v[88:91], v[32:35]
  v_mfma_f32_16x16x32_bf16 v[36:39], a[144:147], v[92:95], v[36:39]
  v_mfma_f32_16x16x32_bf16 v[40:43], a[200:203], v[88:91], v[40:43]
  v_mfma_f32_16x16x32_bf16 v[44:47], a[200:203], v[92:95], v[44:47]
  v_mfma_f32_16x16x32_bf16 v[48:51], v[120:123], v[88:91], v[48:51]
  v_mfma_f32_16x16x32_bf16 v[52:55], v[120:123], v[92:95], v[52:55]
  v_mfma_f32_16x16x32_bf16 v[56:59], v[176:179], v[88:91], v[56:59]
  v_mfma_f32_16x16x32_bf16 v[60:63], v[176:179], v[92:95], v[60:63]
  s_add_u32 m0, s65, 0
  s_nop 0
  buffer_load_dwordx4 v3, s[32:35], s60 offen offset:1024 sc1 lds
  v_mfma_f32_16x16x32_bf16 v[64:67], v[232:235], v[88:91], v[64:67]
  v_mfma_f32_16x16x32_bf16 v[68:71], v[232:235], v[92:95], v[68:71]
  s_waitcnt lgkmcnt(2)
  v_mfma_f32_16x16x32_bf16 v[16:19], a[36:39], v[72:75], v[16:19]
  ds_read_b128 v[88:91], v0 offset:11264
  v_mfma_f32_16x16x32_bf16 v[20:23], a[36:39], v[76:79], v[20:23]
  ds_read_b128 v[92:95], v0 offset:25600
  v_mfma_f32_16x16x32_bf16 v[24:27], a[92:95], v[72:75], v[24:27]
  v_mfma_f32_16x16x32_bf16 v[28:31], a[92:95], v[76:79], v[28:31]
  v_mfma_f32_16x16x32_bf16 v[32:35], a[148:151], v[72:75], v[32:35]
  v_mfma_f32_16x16x32_bf16 v[36:39], a[148:151], v[76:79], v[36:39]
  v_mfma_f32_16x16x32_bf16 v[40:43], a[204:207], v[72:75], v[40:43]
  v_mfma_f32_16x16x32_bf16 v[44:47], a[204:207], v[76:79], v[44:47]
  s_add_u32 m0, s65, 0
  s_nop 0
  buffer_load_dwordx4 v3, s[32:35], s60 offen offset:2048 sc1 lds
  v_mfma_f32_16x16x32_bf16 v[48:51], v[124:127], v[72:75], v[48:51]
  v_mfma_f32_16x16x32_bf16 v[52:55], v[124:127], v[76:79], v[52:55]
  v_mfma_f32_16x16x32_bf16 v[56:59], v[180:183], v[72:75], v[56:59]
  v_mfma_f32_16x16x32_bf16 v[60:63], v[180:183], v[76:79], v[60:63]
  v_mfma_f32_16x16x32_bf16 v[64:67], v[236:239], v[72:75], v[64:67]
  v_mfma_f32_16x16x32_bf16 v[68:71], v[236:239], v[76:79], v[68:71]
  s_waitcnt lgkmcnt(2)
  v_mfma_f32_16x16x32_bf16 v[16:19], a[40:43], v[80:83], v[16:19]
  ds_read_b128 v[72:75], v0 offset:12288
  v_mfma_f32_16x16x32_bf16 v[20:23], a[40:43], v[84:87], v[20:23]
  ds_read_b128 v[76:79], v0 offset:26624
  v_mfma_f32_16x16x32_bf16 v[24:27], a[96:99], v[80:83], v[24:27]
  v_mfma_f32_16x16x32_bf16 v[28:31], a[96:99], v[84:87], v[28:31]
  s_add_u32 m0, s65, 0
  s_nop 0
  buffer_load_dwordx4 v3, s[32:35], s60 offen offset:3072 sc1 lds
  v_mfma_f32_16x16x32_bf16 v[32:35], a[152:155], v[80:83], v[32:35]
  v_mfma_f32_16x16x32_bf16 v[36:39], a[152:155], v[84:87], v[36:39]
  v_mfma_f32_16x16x32_bf16 v[40:43], a[208:211], v[80:83], v[40:43]
  v_mfma_f32_16x16x32_bf16 v[44:47], a[208:211], v[84:87], v[44:47]
  v_mfma_f32_16x16x32_bf16 v[48:51], v[128:131], v[80:83], v[48:51]
  v_mfma_f32_16x16x32_bf16 v[52:55], v[128:131], v[84:87], v[52:55]
  v_mfma_f32_16x16x32_bf16 v[56:59], v[184:187], v[80:83], v[56:59]
  v_mfma_f32_16x16x32_bf16 v[60:63], v[184:187], v[84:87], v[60:63]
  v_mfma_f32_16x16x32_bf16 v[64:67], v[240:243], v[80:83], v[64:67]
  v_mfma_f32_16x16x32_bf16 v[68:71], v[240:243], v[84:87], v[68:71]
  s_add_u32 m0, s65, 4096
  s_nop 0
  buffer_load_dwordx4 v3, s[32:35], s61 offen offset:0 sc1 lds
  s_waitcnt lgkmcnt(2)
  v_mfma_f32_16x16x32_bf16 v[16:19], a[44:47], v[88:91], v[16:19]
  ds_read_b128 v[80:83], v0 offset:13312
  v_mfma_f32_16x16x32_bf16 v[20:23], a[44:47], v[92:95], v[20:23]
  ds_read_b128 v[84:87], v0 offset:27648
  v_mfma_f32_16x16x32_bf16 v[24:27], a[100:103], v[88:91], v[24:27]
  v_mfma_f32_16x16x32_bf16 v[28:31], a[100:103], v[92:95], v[28:31]
  v_mfma_f32_16x16x32_bf16 v[32:35], a[156:159], v[88:91], v[32:35]
  v_mfma_f32_16x16x32_bf16 v[36:39], a[156:159], v[92:95], v[36:39]
  v_mfma_f32_16x16x32_bf16 v[40:43], a[212:215], v[88:91], v[40:43]
  v_mfma_f32_16x16x32_bf16 v[44:47], a[212:215], v[92:95], v[44:47]
  v_mfma_f32_16x16x32_bf16 v[48:51], v[132:135], v[88:91], v[48:51]
  v_mfma_f32_16x16x32_bf16 v[52:55], v[132:135], v[92:95], v[52:55]
  s_add_u32 m0, s65, 4096
  s_nop 0
  buffer_load_dwordx4 v3, s[32:35], s61 offen offset:1024 sc1 lds
  v_mfma_f32_16x16x32_bf16 v[56:59], v[188:191], v[88:91], v[56:59]
  v_mfma_f32_16x16x32_bf16 v[60:63], v[188:191], v[92:95], v[60:63]
  v_mfma_f32_16x16x32_bf16 v[64:67], v[244:247], v[88:91], v[64:67]
  v_mfma_f32_16x16x32_bf16 v[68:71], v[244:247], v[92:95], v[68:71]
  s_waitcnt lgkmcnt(2)
  v_mfma_f32_16x16x32_bf16 v[16:19], a[48:51], v[72:75], v[16:19]
  v_mfma_f32_16x16x32_bf16 v[20:23], a[48:51], v[76:79], v[20:23]
  v_mfma_f32_16x16x32_bf16 v[24:27], a[104:107], v[72:75], v[24:27]
  v_mfma_f32_16x16x32_bf16 v[28:31], a[104:107], v[76:79], v[28:31]
  v_mfma_f32_16x16x32_bf16 v[32:35], a[160:163], v[72:75], v[32:35]
  v_mfma_f32_16x16x32_bf16 v[36:39], a[160:163], v[76:79], v[36:39]
  s_add_u32 m0, s65, 4096
  s_nop 0
  buffer_load_dwordx4 v3, s[32:35], s61 offen offset:2048 sc1 lds
  v_mfma_f32_16x16x32_bf16 v[40:43], a[216:219], v[72:75], v[40:43]
  v_mfma_f32_16x16x32_bf16 v[44:47], a[216:219], v[76:79], v[44:47]
  v_mfma_f32_16x16x32_bf16 v[48:51], v[136:139], v[72:75], v[48:51]
  v_mfma_f32_16x16x32_bf16 v[52:55], v[136:139], v[76:79], v[52:55]
  v_mfma_f32_16x16x32_bf16 v[56:59], v[192:195], v[72:75], v[56:59]
  v_mfma_f32_16x16x32_bf16 v[60:63], v[192:195], v[76:79], v[60:63]
  v_mfma_f32_16x16x32_bf16 v[64:67], v[248:251], v[72:75], v[64:67]
  v_mfma_f32_16x16x32_bf16 v[68:71], v[248:251], v[76:79], v[68:71]
  s_waitcnt lgkmcnt(0)
  v_mfma_f32_16x16x32_bf16 v[16:19], a[52:55], v[80:83], v[16:19]
  v_mfma_f32_16x16x32_bf16 v[20:23], a[52:55], v[84:87], v[20:23]
  v_mfma_f32_16x16x32_bf16 v[24:27], a[108:111], v[80:83], v[24:27]
  v_mfma_f32_16x16x32_bf16 v[28:31], a[108:111], v[84:87], v[28:31]
  v_mfma_f32_16x16x32_bf16 v[32:35], a[164:167], v[80:83], v[32:35]
  v_mfma_f32_16x16x32_bf16 v[36:39], a[164:167], v[84:87], v[36:39]
  v_mfma_f32_16x16x32_bf16 v[40:43], a[220:223], v[80:83], v[40:43]
  v_mfma_f32_16x16x32_bf16 v[44:47], a[220:223], v[84:87], v[44:47]
  v_mfma_f32_16x16x32_bf16 v[48:51], v[140:143], v[80:83], v[48:51]
  v_mfma_f32_16x16x32_bf16 v[52:55], v[140:143], v[84:87], v[52:55]
  v_mfma_f32_16x16x32_bf16 v[56:59], v[196:199], v[80:83], v[56:59]
  v_mfma_f32_16x16x32_bf16 v[60:63], v[196:199], v[84:87], v[60:63]
  v_mfma_f32_16x16x32_bf16 v[64:67], v[252:255], v[80:83], v[64:67]
  v_mfma_f32_16x16x32_bf16 v[68:71], v[252:255], v[84:87], v[68:71]
  v_add_u32 v9, s82, v0
  ds_read_b128 v[88:91], v9 offset:0
  ds_read_b128 v[92:95], v9 offset:14336
  v_cvt_pk_bf16_f32 v16, v16, v17
  v_cvt_pk_bf16_f32 v17, v18, v19
  v_cvt_pk_bf16_f32 v18, v24, v25
  v_cvt_pk_bf16_f32 v19, v26, v27
  v_cvt_pk_bf16_f32 v20, v20, v21
  v_cvt_pk_bf16_f32 v21, v22, v23
  v_cvt_pk_bf16_f32 v22, v28, v29
  v_cvt_pk_bf16_f32 v23, v30, v31
  v_cvt_pk_bf16_f32 v32, v32, v33
  v_cvt_pk_bf16_f32 v33, v34, v35
  v_cvt_pk_bf16_f32 v34, v40, v41
  v_cvt_pk_bf16_f32 v35, v42, v43
  v_cvt_pk_bf16_f32 v36, v36, v37
  v_cvt_pk_bf16_f32 v37, v38, v39
  v_cvt_pk_bf16_f32 v38, v44, v45
  v_cvt_pk_bf16_f32 v39, v46, v47
  v_cvt_pk_bf16_f32 v48, v48, v49
  v_cvt_pk_bf16_f32 v49, v50, v51
  v_cvt_pk_bf16_f32 v50, v56, v57
  v_cvt_pk_bf16_f32 v51, v58, v59
  v_cvt_pk_bf16_f32 v52, v52, v53
  v_cvt_pk_bf16_f32 v53, v54, v55
  v_cvt_pk_bf16_f32 v54, v60, v61
  v_cvt_pk_bf16_f32 v55, v62, v63
  v_cvt_pk_bf16_f32 v64, v64, v65
  v_cvt_pk_bf16_f32 v65, v66, v67
  v_cvt_pk_bf16_f32 v68, v68, v69
  v_cvt_pk_bf16_f32 v69, v70, v71
  buffer_load_dwordx4 v[24:27], v119, s[32:35], s74 offen sc1
  buffer_load_dwordx4 v[28:31], v119, s[32:35], s75 offen sc1
  buffer_load_dwordx4 v[40:43], v119, s[32:35], s76 offen sc1
  buffer_load_dwordx4 v[44:47], v119, s[32:35], s77 offen sc1
  s_waitcnt lgkmcnt(0)
  v_add_u32 v9, s83, v0
  ds_read_b128 v[72:75], v9 offset:0
  ds_read_b128 v[76:79], v9 offset:14336
  v_mfma_f32_16x16x32_bf16 v[100:103], v[88:91], v[16:19], 0
  v_mfma_f32_16x16x32_bf16 v[108:111], v[88:91], v[20:23], 0
  v_mfma_f32_16x16x32_bf16 v[112:115], v[92:95], v[20:23], 0
  s_waitcnt lgkmcnt(0)
  v_add_u32 v9, s84, v0
  ds_read_b128 v[88:91], v9 offset:0
  ds_read_b128 v[92:95], v9 offset:14336
  v_mfma_f32_16x16x32_bf16 v[100:103], v[72:75], v[32:35], v[100:103]
  v_mfma_f32_16x16x32_bf16 v[108:111], v[72:75], v[36:39], v[108:111]
  v_mfma_f32_16x16x32_bf16 v[112:115], v[76:79], v[36:39], v[112:115]
  s_waitcnt lgkmcnt(0)
  v_add_u32 v9, s85, v0
  v_add_u32 v9, s97, v9
  ds_read_b64 v[72:73], v9 offset:0
  ds_read_b64 v[76:77], v9 offset:14336
  v_mfma_f32_16x16x32_bf16 v[100:103], v[88:91], v[48:51], v[100:103]
  v_mfma_f32_16x16x32_bf16 v[108:111], v[88:91], v[52:55], v[108:111]
  v_mfma_f32_16x16x32_bf16 v[112:115], v[92:95], v[52:55], v[112:115]
  s_waitcnt lgkmcnt(0)
  v_mfma_f32_16x16x16_bf16 v[100:103], v[72:73], v[64:65], v[100:103]
  v_mfma_f32_16x16x16_bf16 v[108:111], v[72:73], v[68:69], v[108:111]
  v_mfma_f32_16x16x16_bf16 v[112:115], v[76:77], v[68:69], v[112:115]
  s_nop 5
  ds_write_b128 v4, v[100:103] offset:64
  ds_write_b128 v4, v[108:111] offset:3392
  ds_write_b128 v4, v[112:115] offset:3456
  s_mul_i32 s95, s94, 638976
  s_cmp_eq_u32 s58, 0
  s_cselect_b32 s47, 0, 40960
  s_add_u32 s95, s95, s47
  s_add_u32 s95, s95, 80052224
  s_waitcnt vmcnt(0)
  v_max3_u32 v10, v24, v25, v26
  v_max3_u32 v10, v10, v27, v28
  v_max3_u32 v10, v10, v29, v30
  v_max3_u32 v10, v10, v31, v40
  v_max3_u32 v10, v10, v41, v42
  v_max3_u32 v10, v10, v43, v44
  v_max3_u32 v10, v10, v45, v46
  v_max_u32 v10, v10, v47
  v_cmp_eq_u32 vcc, -1, v10
  s_cbranch_vccz mok_171
  s_mov_b32 s52, 60000
poll_172:
  buffer_load_dwordx4 v[24:27], v119, s[32:35], s74 offen sc1
  buffer_load_dwordx4 v[28:31], v119, s[32:35], s75 offen sc1
  buffer_load_dwordx4 v[40:43], v119, s[32:35], s76 offen sc1
  buffer_load_dwordx4 v[44:47], v119, s[32:35], s77 offen sc1
  s_waitcnt vmcnt(0)
  v_max3_u32 v10, v24, v25, v26
  v_max3_u32 v10, v10, v27, v28
  v_max3_u32 v10, v10, v29, v30
  v_max3_u32 v10, v10, v31, v40
  v_max3_u32 v10, v10, v41, v42
  v_max3_u32 v10, v10, v43, v44
  v_max3_u32 v10, v10, v45, v46
  v_max_u32 v10, v10, v47
  v_cmp_eq_u32 vcc, -1, v10
  s_cbranch_vccz pok_173
  s_sleep 2
  s_sub_u32 s52, s52, 1
  s_cbranch_scc0 poll_172
  s_mov_b32 s54, 31
  s_branch k1_fail
pok_173:
mok_171:
  s_and_b32 s44, s94, 7
  s_cmp_ge_u32 s44, 2
  s_cbranch_scc1 rdy_174
  s_lshr_b32 s44, s94, 3
  s_lshl_b32 s44, s44, 7
  s_add_u32 s44, s44, 124786816
  v_mov_b32 v9, 0
  s_mov_b32 s52, 60000
poll_175:
  buffer_load_dword v10, v9, s[32:35], s44 offen sc1
  s_waitcnt vmcnt(0)
  v_cmp_ne_u32 vcc, 96, v10
  s_cbranch_vccz pok_176
  s_sleep 8
  s_sub_u32 s52, s52, 1
  s_cbranch_scc0 poll_175
  s_mov_b32 s54, 32
  s_branch k1_fail
pok_176:
rdy_174:
  s_cmp_eq_u32 s98, 0
  s_cselect_b64 vcc, -1, 0
  v_cndmask_b32 v44, v46, v44, vcc
  v_cndmask_b32 v45, v47, v45, vcc
  v_mfma_f32_16x16x32_bf16 v[96:99], v[24:27], v[16:19], 0
  v_mfma_f32_16x16x32_bf16 v[104:107], v[24:27], v[20:23], 0
  v_mfma_f32_16x16x32_bf16 v[96:99], v[28:31], v[32:35], v[96:99]
  v_mfma_f32_16x16x32_bf16 v[104:107], v[28:31], v[36:39], v[104:107]
  v_mfma_f32_16x16x32_bf16 v[96:99], v[40:43], v[48:51], v[96:99]
  v_mfma_f32_16x16x32_bf16 v[104:107], v[40:43], v[52:55], v[104:107]
  v_mfma_f32_16x16x16_bf16 v[96:99], v[44:45], v[64:65], v[96:99]
  v_mfma_f32_16x16x16_bf16 v[104:107], v[44:45], v[68:69], v[104:107]
  s_nop 6
  ds_write_b128 v4, v[96:99] offset:0
  ds_write_b128 v4, v[104:107] offset:3328
  s_waitcnt lgkmcnt(0)
  s_barrier
  ds_read_b128 v[16:19], v5 offset:0
  ds_read_b128 v[20:23], v5 offset:6656
  ds_read_b128 v[24:27], v5 offset:13312
  ds_read_b128 v[28:31], v5 offset:19968
  ds_read_b32 v32, v6 offset:0
  ds_read_b32 v33, v6 offset:6656
  ds_read_b32 v34, v6 offset:13312
  ds_read_b32 v35, v6 offset:19968
  s_waitcnt lgkmcnt(4)
  v_pk_add_f32 v[16:17], v[16:17], v[20:21]
  v_pk_add_f32 v[24:25], v[24:25], v[28:29]
  v_pk_add_f32 v[18:19], v[18:19], v[22:23]
  v_pk_add_f32 v[26:27], v[26:27], v[30:31]
  v_pk_add_f32 v[16:17], v[16:17], v[24:25]
  v_pk_add_f32 v[18:19], v[18:19], v[26:27]
  s_waitcnt lgkmcnt(0)
  s_barrier
  v_add_f32 v32, v32, v33
  v_add_f32 v34, v34, v35
  v_cndmask_b32 v16, v14, v16, s[86:87]
  v_cndmask_b32 v17, v14, v17, s[88:89]
  v_cndmask_b32 v18, v14, v18, s[90:91]
  v_cndmask_b32 v19, v14, v19, s[92:93]
  v_add_f32 v20, v32, v34
  v_max3_f32 v21, v16, v17, v18
  v_max3_f32 v21, v21, v19, v20
  s_nop 1
  v_max_f32_dpp v21, v21, v21 quad_perm:[1,0,3,2] row_mask:0xf bank_mask:0xf
  s_nop 1
  v_max_f32_dpp v21, v21, v21 quad_perm:[2,3,0,1] row_mask:0xf bank_mask:0xf
  s_nop 1
  v_max_f32_dpp v21, v21, v21 row_half_mirror row_mask:0xf bank_mask:0xf
  v_sub_f32 v16, v16, v21
  v_sub_f32 v17, v17, v21
  v_sub_f32 v18, v18, v21
  v_sub_f32 v19, v19, v21
  v_sub_f32 v20, v20, v21
  v_exp_f32 v16, v16
  v_exp_f32 v17, v17
  v_exp_f32 v18, v18
  v_exp_f32 v19, v19
  v_exp_f32 v20, v20
  v_add_f32 v21, v16, v17
  v_add_f32 v22, v18, v19
  v_add_f32 v21, v21, v20
  v_add_f32 v21, v21, v22
  s_nop 1
  v_add_f32_dpp v21, v21, v21 quad_perm:[1,0,3,2] row_mask:0xf bank_mask:0xf
  s_nop 1
  v_add_f32_dpp v21, v21, v21 quad_perm:[2,3,0,1] row_mask:0xf bank_mask:0xf
  s_nop 1
  v_add_f32_dpp v21, v21, v21 row_half_mirror row_mask:0xf bank_mask:0xf
  v_rcp_f32 v21, v21
  s_nop 0
  v_mul_f32 v16, v16, v21
  v_mul_f32 v17, v17, v21
  v_mul_f32 v18, v18, v21
  v_mul_f32 v19, v19, v21
  v_mul_f32 v20, v20, v21
  s_nop 1
  v_mov_b32_dpp v22, v20 quad_perm:[1,0,3,2] row_mask:0xf bank_mask:0xf
  v_cvt_pk_bf16_f32 v16, v16, v17
  v_cvt_pk_bf16_f32 v17, v18, v19
  v_cvt_pk_bf16_f32 v20, v20, v22
  v_min_u32 v16, -2, v16
  v_min_u32 v17, -2, v17
  v_min_u32 v20, -2, v20
  buffer_store_dwordx2 v[16:17], v7, s[32:35], s95 offen sc1
  buffer_store_dword v20, v8, s[32:35], s95 offen sc1
  v_xor_b32 v0, 0x8000, v0
  v_add_u32 v119, 14336, v119
  s_add_u32 s94, s94, 2
  s_cmp_lt_u32 s94, 64
  s_cbranch_scc1 ta_165
  s_endpgm
r_U:
  s_lshl_b32 s44, s50, 4
  s_lshl_b32 s45, s48, 2
  s_add_u32 s44, s44, s45
  s_add_u32 s44, s44, 0
  s_mul_i32 s44, s44, 14336
  s_add_u32 s44, s44, 6422528
  buffer_load_dwordx4 a[0:3], v2, s[32:35], s44 offen offset:0
  buffer_load_dwordx4 a[4:7], v2, s[32:35], s44 offen offset:1024
  buffer_load_dwordx4 a[8:11], v2, s[32:35], s44 offen offset:2048
  buffer_load_dwordx4 a[12:15], v2, s[32:35], s44 offen offset:3072
  s_add_u32 s44, s44, 4096
  buffer_load_dwordx4 a[16:19], v2, s[32:35], s44 offen offset:0
  buffer_load_dwordx4 a[20:23], v2, s[32:35], s44 offen offset:1024
  buffer_load_dwordx4 a[24:27], v2, s[32:35], s44 offen offset:2048
  buffer_load_dwordx4 a[28:31], v2, s[32:35], s44 offen offset:3072
  s_add_u32 s44, s44, 4096
  buffer_load_dwordx4 a[32:35], v2, s[32:35], s44 offen offset:0
  buffer_load_dwordx4 a[36:39], v2, s[32:35], s44 offen offset:1024
  buffer_load_dwordx4 a[40:43], v2, s[32:35], s44 offen offset:2048
  buffer_load_dwordx4 a[44:47], v2, s[32:35], s44 offen offset:3072
  s_add_u32 s44, s44, 4096
  buffer_load_dwordx4 a[48:51], v2, s[32:35], s44 offen offset:0
  buffer_load_dwordx4 a[52:55], v2, s[32:35], s44 offen offset:1024
  s_lshl_b32 s44, s50, 4
  s_lshl_b32 s45, s48, 2
  s_add_u32 s44, s44, s45
  s_add_u32 s44, s44, 1
  s_mul_i32 s44, s44, 14336
  s_add_u32 s44, s44, 6422528
  buffer_load_dwordx4 a[56:59], v2, s[32:35], s44 offen offset:0
  buffer_load_dwordx4 a[60:63], v2, s[32:35], s44 offen offset:1024
  buffer_load_dwordx4 a[64:67], v2, s[32:35], s44 offen offset:2048
  buffer_load_dwordx4 a[68:71], v2, s[32:35], s44 offen offset:3072
  s_add_u32 s44, s44, 4096
  buffer_load_dwordx4 a[72:75], v2, s[32:35], s44 offen offset:0
  buffer_load_dwordx4 a[76:79], v2, s[32:35], s44 offen offset:1024
  buffer_load_dwordx4 a[80:83], v2, s[32:35], s44 offen offset:2048
  buffer_load_dwordx4 a[84:87], v2, s[32:35], s44 offen offset:3072
  s_add_u32 s44, s44, 4096
  buffer_load_dwordx4 a[88:91], v2, s[32:35], s44 offen offset:0
  buffer_load_dwordx4 a[92:95], v2, s[32:35], s44 offen offset:1024
  buffer_load_dwordx4 a[96:99], v2, s[32:35], s44 offen offset:2048
  buffer_load_dwordx4 a[100:103], v2, s[32:35], s44 offen offset:3072
  s_add_u32 s44, s44, 4096
  buffer_load_dwordx4 a[104:107], v2, s[32:35], s44 offen offset:0
  buffer_load_dwordx4 a[108:111], v2, s[32:35], s44 offen offset:1024
  s_lshl_b32 s44, s50, 4
  s_lshl_b32 s45, s48, 2
  s_add_u32 s44, s44, s45
  s_add_u32 s44, s44, 2
  s_mul_i32 s44, s44, 14336
  s_add_u32 s44, s44, 6422528
  buffer_load_dwordx4 a[112:115], v2, s[32:35], s44 offen offset:0
  buffer_load_dwordx4 a[116:119], v2, s[32:35], s44 offen offset:1024
  buffer_load_dwordx4 a[120:123], v2, s[32:35], s44 offen offset:2048
  buffer_load_dwordx4 a[124:127], v2, s[32:35], s44 offen offset:3072
  s_add_u32 s44, s44, 4096
  buffer_load_dwordx4 a[128:131], v2, s[32:35], s44 offen offset:0
  buffer_load_dwordx4 a[132:135], v2, s[32:35], s44 offen offset:1024
  buffer_load_dwordx4 a[136:139], v2, s[32:35], s44 offen offset:2048
  buffer_load_dwordx4 a[140:143], v2, s[32:35], s44 offen offset:3072
  s_add_u32 s44, s44, 4096
  buffer_load_dwordx4 a[144:147], v2, s[32:35], s44 offen offset:0
  buffer_load_dwordx4 a[148:151], v2, s[32:35], s44 offen offset:1024
  buffer_load_dwordx4 a[152:155], v2, s[32:35], s44 offen offset:2048
  buffer_load_dwordx4 a[156:159], v2, s[32:35], s44 offen offset:3072
  s_add_u32 s44, s44, 4096
  buffer_load_dwordx4 a[160:163], v2, s[32:35], s44 offen offset:0
  buffer_load_dwordx4 a[164:167], v2, s[32:35], s44 offen offset:1024
  s_lshl_b32 s44, s50, 4
  s_lshl_b32 s45, s48, 2
  s_add_u32 s44, s44, s45
  s_add_u32 s44, s44, 3
  s_mul_i32 s44, s44, 14336
  s_add_u32 s44, s44, 6422528
  buffer_load_dwordx4 a[168:171], v2, s[32:35], s44 offen offset:0
  buffer_load_dwordx4 a[172:175], v2, s[32:35], s44 offen offset:1024
  buffer_load_dwordx4 a[176:179], v2, s[32:35], s44 offen offset:2048
  buffer_load_dwordx4 a[180:183], v2, s[32:35], s44 offen offset:3072
  s_add_u32 s44, s44, 4096
  buffer_load_dwordx4 a[184:187], v2, s[32:35], s44 offen offset:0
  buffer_load_dwordx4 a[188:191], v2, s[32:35], s44 offen offset:1024
  buffer_load_dwordx4 a[192:195], v2, s[32:35], s44 offen offset:2048
  buffer_load_dwordx4 a[196:199], v2, s[32:35], s44 offen offset:3072
  s_add_u32 s44, s44, 4096
  buffer_load_dwordx4 a[200:203], v2, s[32:35], s44 offen offset:0
  buffer_load_dwordx4 a[204:207], v2, s[32:35], s44 offen offset:1024
  buffer_load_dwordx4 a[208:211], v2, s[32:35], s44 offen offset:2048
  buffer_load_dwordx4 a[212:215], v2, s[32:35], s44 offen offset:3072
  s_add_u32 s44, s44, 4096
  buffer_load_dwordx4 a[216:219], v2, s[32:35], s44 offen offset:0
  buffer_load_dwordx4 a[220:223], v2, s[32:35], s44 offen offset:1024
  v_and_b32 v9, 15, v1
  v_lshrrev_b32 v10, 4, v1
  s_mul_i32 s45, s48, 7168
  v_add_u32 v3, s45, v2
  s_lshl_b32 s45, s48, 12
  v_add_u32 v5, s45, v2
  v_mov_b32 v11, 1073741824
  s_lshl_b32 s45, s48, 2
  v_mov_b32 v6, s45
  v_cmp_eq_u32 vcc, 0, v1
  s_nop 1
  v_cndmask_b32 v6, v11, v6, vcc
  v_mov_b32 v7, 1
  v_mov_b32 v4, v3
  v_mov_b32 v20, v2
  s_lshl_b32 s62, s58, 6
  s_add_u32 s62, s62, s51
  s_mul_i32 s62, s62, 458752
  s_add_u32 s62, s62, 21331968
  s_lshl_b32 s44, s50, 14
  s_add_u32 s62, s62, s44
  s_lshl_b32 s63, s58, 6
  s_add_u32 s63, s63, s51
  s_mul_i32 s63, s63, 3584
  s_add_u32 s63, s63, 124092416
  s_lshl_b32 s44, s50, 7
  s_add_u32 s63, s63, s44
  s_mov_b32 s68, 1073741824
  s_mov_b32 s61, 0
  s_cmp_eq_u32 s58, 0
  s_cbranch_scc0 r_U1
  s_mov_b32 s65, 17661952
  s_mov_b32 s66, 17666048
  buffer_load_dwordx4 v[80:83], v3, s[32:35], s65 offen offset:0
  buffer_load_dwordx4 v[84:87], v3, s[32:35], s65 offen offset:1024
  buffer_load_dwordx4 v[88:91], v3, s[32:35], s65 offen offset:2048
  buffer_load_dwordx4 v[92:95], v3, s[32:35], s65 offen offset:3072
  buffer_load_dwordx4 v[96:99], v3, s[32:35], s66 offen offset:0
  buffer_load_dwordx4 v[100:103], v3, s[32:35], s66 offen offset:1024
  buffer_load_dwordx4 v[104:107], v3, s[32:35], s66 offen offset:2048
  buffer_store_dword v7, v11, s[32:35], 0 offen
  buffer_store_dword v7, v11, s[32:35], 0 offen
  buffer_store_dword v7, v11, s[32:35], 0 offen
  buffer_store_dword v7, v11, s[32:35], 0 offen
u0_177:
  s_mov_b32 s51, s61
  s_waitcnt vmcnt(4)
  ds_write_b128 v4, v[80:83] offset:0
  ds_write_b128 v4, v[84:87] offset:1024
  ds_write_b128 v4, v[88:91] offset:2048
  ds_write_b128 v4, v[92:95] offset:3072
  ds_write_b128 v4, v[96:99] offset:4096
  ds_write_b128 v4, v[100:103] offset:5120
  ds_write_b128 v4, v[104:107] offset:6144
  s_add_u32 s65, s65, 28672
  s_add_u32 s66, s66, 28672
  s_waitcnt lgkmcnt(0)
  s_barrier
  ds_read_b128 v[56:59], v20 offset:0
  ds_read_b128 v[60:63], v20 offset:14336
  ds_read_b128 v[64:67], v20 offset:1024
  ds_read_b128 v[68:71], v20 offset:15360
  s_waitcnt lgkmcnt(2)
  v_mfma_f32_16x16x32_bf16 v[24:27], v[56:59], a[0:3], 0
  ds_read_b128 v[72:75], v20 offset:2048
  v_mfma_f32_16x16x32_bf16 v[28:31], v[60:63], a[0:3], 0
  ds_read_b128 v[76:79], v20 offset:16384
  v_mfma_f32_16x16x32_bf16 v[32:35], v[56:59], a[56:59], 0
  v_mfma_f32_16x16x32_bf16 v[36:39], v[60:63], a[56:59], 0
  buffer_load_dwordx4 v[80:83], v3, s[32:35], s65 offen offset:0
  v_mfma_f32_16x16x32_bf16 v[40:43], v[56:59], a[112:115], 0
  v_mfma_f32_16x16x32_bf16 v[44:47], v[60:63], a[112:115], 0
  v_mfma_f32_16x16x32_bf16 v[48:51], v[56:59], a[168:171], 0
  v_mfma_f32_16x16x32_bf16 v[52:55], v[60:63], a[168:171], 0
  s_waitcnt lgkmcnt(2)
  v_mfma_f32_16x16x32_bf16 v[24:27], v[64:67], a[4:7], v[24:27]
  ds_read_b128 v[56:59], v20 offset:3072
  v_mfma_f32_16x16x32_bf16 v[28:31], v[68:71], a[4:7], v[28:31]
  ds_read_b128 v[60:63], v20 offset:17408
  v_mfma_f32_16x16x32_bf16 v[32:35], v[64:67], a[60:63], v[32:35]
  v_mfma_f32_16x16x32_bf16 v[36:39], v[68:71], a[60:63], v[36:39]
  buffer_load_dwordx4 v[84:87], v3, s[32:35], s65 offen offset:1024
  v_mfma_f32_16x16x32_bf16 v[40:43], v[64:67], a[116:119], v[40:43]
  v_mfma_f32_16x16x32_bf16 v[44:47], v[68:71], a[116:119], v[44:47]
  v_mfma_f32_16x16x32_bf16 v[48:51], v[64:67], a[172:175], v[48:51]
  v_mfma_f32_16x16x32_bf16 v[52:55], v[68:71], a[172:175], v[52:55]
  s_waitcnt lgkmcnt(2)
  v_mfma_f32_16x16x32_bf16 v[24:27], v[72:75], a[8:11], v[24:27]
  ds_read_b128 v[64:67], v20 offset:4096
  v_mfma_f32_16x16x32_bf16 v[28:31], v[76:79], a[8:11], v[28:31]
  ds_read_b128 v[68:71], v20 offset:18432
  v_mfma_f32_16x16x32_bf16 v[32:35], v[72:75], a[64:67], v[32:35]
  v_mfma_f32_16x16x32_bf16 v[36:39], v[76:79], a[64:67], v[36:39]
  buffer_load_dwordx4 v[88:91], v3, s[32:35], s65 offen offset:2048
  v_mfma_f32_16x16x32_bf16 v[40:43], v[72:75], a[120:123], v[40:43]
  v_mfma_f32_16x16x32_bf16 v[44:47], v[76:79], a[120:123], v[44:47]
  v_mfma_f32_16x16x32_bf16 v[48:51], v[72:75], a[176:179], v[48:51]
  v_mfma_f32_16x16x32_bf16 v[52:55], v[76:79], a[176:179], v[52:55]
  s_waitcnt lgkmcnt(2)
  v_mfma_f32_16x16x32_bf16 v[24:27], v[56:59], a[12:15], v[24:27]
  ds_read_b128 v[72:75], v20 offset:5120
  v_mfma_f32_16x16x32_bf16 v[28:31], v[60:63], a[12:15], v[28:31]
  ds_read_b128 v[76:79], v20 offset:19456
  v_mfma_f32_16x16x32_bf16 v[32:35], v[56:59], a[68:71], v[32:35]
  v_mfma_f32_16x16x32_bf16 v[36:39], v[60:63], a[68:71], v[36:39]
  buffer_load_dwordx4 v[92:95], v3, s[32:35], s65 offen offset:3072
  v_mfma_f32_16x16x32_bf16 v[40:43], v[56:59], a[124:127], v[40:43]
  v_mfma_f32_16x16x32_bf16 v[44:47], v[60:63], a[124:127], v[44:47]
  v_mfma_f32_16x16x32_bf16 v[48:51], v[56:59], a[180:183], v[48:51]
  v_mfma_f32_16x16x32_bf16 v[52:55], v[60:63], a[180:183], v[52:55]
  s_waitcnt lgkmcnt(2)
  v_mfma_f32_16x16x32_bf16 v[24:27], v[64:67], a[16:19], v[24:27]
  ds_read_b128 v[56:59], v20 offset:6144
  v_mfma_f32_16x16x32_bf16 v[28:31], v[68:71], a[16:19], v[28:31]
  ds_read_b128 v[60:63], v20 offset:20480
  v_mfma_f32_16x16x32_bf16 v[32:35], v[64:67], a[72:75], v[32:35]
  v_mfma_f32_16x16x32_bf16 v[36:39], v[68:71], a[72:75], v[36:39]
  buffer_load_dwordx4 v[96:99], v3, s[32:35], s66 offen offset:0
  v_mfma_f32_16x16x32_bf16 v[40:43], v[64:67], a[128:131], v[40:43]
  v_mfma_f32_16x16x32_bf16 v[44:47], v[68:71], a[128:131], v[44:47]
  v_mfma_f32_16x16x32_bf16 v[48:51], v[64:67], a[184:187], v[48:51]
  v_mfma_f32_16x16x32_bf16 v[52:55], v[68:71], a[184:187], v[52:55]
  s_waitcnt lgkmcnt(2)
  v_mfma_f32_16x16x32_bf16 v[24:27], v[72:75], a[20:23], v[24:27]
  ds_read_b128 v[64:67], v20 offset:7168
  v_mfma_f32_16x16x32_bf16 v[28:31], v[76:79], a[20:23], v[28:31]
  ds_read_b128 v[68:71], v20 offset:21504
  v_mfma_f32_16x16x32_bf16 v[32:35], v[72:75], a[76:79], v[32:35]
  v_mfma_f32_16x16x32_bf16 v[36:39], v[76:79], a[76:79], v[36:39]
  buffer_load_dwordx4 v[100:103], v3, s[32:35], s66 offen offset:1024
  v_mfma_f32_16x16x32_bf16 v[40:43], v[72:75], a[132:135], v[40:43]
  v_mfma_f32_16x16x32_bf16 v[44:47], v[76:79], a[132:135], v[44:47]
  v_mfma_f32_16x16x32_bf16 v[48:51], v[72:75], a[188:191], v[48:51]
  v_mfma_f32_16x16x32_bf16 v[52:55], v[76:79], a[188:191], v[52:55]
  s_waitcnt lgkmcnt(2)
  v_mfma_f32_16x16x32_bf16 v[24:27], v[56:59], a[24:27], v[24:27]
  ds_read_b128 v[72:75], v20 offset:8192
  v_mfma_f32_16x16x32_bf16 v[28:31], v[60:63], a[24:27], v[28:31]
  ds_read_b128 v[76:79], v20 offset:22528
  v_mfma_f32_16x16x32_bf16 v[32:35], v[56:59], a[80:83], v[32:35]
  v_mfma_f32_16x16x32_bf16 v[36:39], v[60:63], a[80:83], v[36:39]
  buffer_load_dwordx4 v[104:107], v3, s[32:35], s66 offen offset:2048
  v_mfma_f32_16x16x32_bf16 v[40:43], v[56:59], a[136:139], v[40:43]
  v_mfma_f32_16x16x32_bf16 v[44:47], v[60:63], a[136:139], v[44:47]
  v_mfma_f32_16x16x32_bf16 v[48:51], v[56:59], a[192:195], v[48:51]
  v_mfma_f32_16x16x32_bf16 v[52:55], v[60:63], a[192:195], v[52:55]
  s_waitcnt lgkmcnt(2)
  v_mfma_f32_16x16x32_bf16 v[24:27], v[64:67], a[28:31], v[24:27]
  ds_read_b128 v[56:59], v20 offset:9216
  v_mfma_f32_16x16x32_bf16 v[28:31], v[68:71], a[28:31], v[28:31]
  ds_read_b128 v[60:63], v20 offset:23552
  v_mfma_f32_16x16x32_bf16 v[32:35], v[64:67], a[84:87], v[32:35]
  v_mfma_f32_16x16x32_bf16 v[36:39], v[68:71], a[84:87], v[36:39]
  s_waitcnt vmcnt(7)
  buffer_store_dword v7, v6, s[32:35], s68 offen sc1
  v_mfma_f32_16x16x32_bf16 v[40:43], v[64:67], a[140:143], v[40:43]
  v_mfma_f32_16x16x32_bf16 v[44:47], v[68:71], a[140:143], v[44:47]
  v_mfma_f32_16x16x32_bf16 v[48:51], v[64:67], a[196:199], v[48:51]
  v_mfma_f32_16x16x32_bf16 v[52:55], v[68:71], a[196:199], v[52:55]
  s_waitcnt lgkmcnt(2)
  v_mfma_f32_16x16x32_bf16 v[24:27], v[72:75], a[32:35], v[24:27]
  ds_read_b128 v[64:67], v20 offset:10240
  v_mfma_f32_16x16x32_bf16 v[28:31], v[76:79], a[32:35], v[28:31]
  ds_read_b128 v[68:71], v20 offset:24576
  v_mfma_f32_16x16x32_bf16 v[32:35], v[72:75], a[88:91], v[32:35]
  v_mfma_f32_16x16x32_bf16 v[36:39], v[76:79], a[88:91], v[36:39]
  v_mfma_f32_16x16x32_bf16 v[40:43], v[72:75], a[144:147], v[40:43]
  v_mfma_f32_16x16x32_bf16 v[44:47], v[76:79], a[144:147], v[44:47]
  v_mfma_f32_16x16x32_bf16 v[48:51], v[72:75], a[200:203], v[48:51]
  v_mfma_f32_16x16x32_bf16 v[52:55], v[76:79], a[200:203], v[52:55]
  s_waitcnt lgkmcnt(2)
  v_mfma_f32_16x16x32_bf16 v[24:27], v[56:59], a[36:39], v[24:27]
  ds_read_b128 v[72:75], v20 offset:11264
  v_mfma_f32_16x16x32_bf16 v[28:31], v[60:63], a[36:39], v[28:31]
  ds_read_b128 v[76:79], v20 offset:25600
  v_mfma_f32_16x16x32_bf16 v[32:35], v[56:59], a[92:95], v[32:35]
  v_mfma_f32_16x16x32_bf16 v[36:39], v[60:63], a[92:95], v[36:39]
  v_mfma_f32_16x16x32_bf16 v[40:43], v[56:59], a[148:151], v[40:43]
  v_mfma_f32_16x16x32_bf16 v[44:47], v[60:63], a[148:151], v[44:47]
  v_mfma_f32_16x16x32_bf16 v[48:51], v[56:59], a[204:207], v[48:51]
  v_mfma_f32_16x16x32_bf16 v[52:55], v[60:63], a[204:207], v[52:55]
  s_waitcnt lgkmcnt(2)
  v_mfma_f32_16x16x32_bf16 v[24:27], v[64:67], a[40:43], v[24:27]
  ds_read_b128 v[56:59], v20 offset:12288
  v_mfma_f32_16x16x32_bf16 v[28:31], v[68:71], a[40:43], v[28:31]
  ds_read_b128 v[60:63], v20 offset:26624
  v_mfma_f32_16x16x32_bf16 v[32:35], v[64:67], a[96:99], v[32:35]
  v_mfma_f32_16x16x32_bf16 v[36:39], v[68:71], a[96:99], v[36:39]
  v_mfma_f32_16x16x32_bf16 v[40:43], v[64:67], a[152:155], v[40:43]
  v_mfma_f32_16x16x32_bf16 v[44:47], v[68:71], a[152:155], v[44:47]
  v_mfma_f32_16x16x32_bf16 v[48:51], v[64:67], a[208:211], v[48:51]
  v_mfma_f32_16x16x32_bf16 v[52:55], v[68:71], a[208:211], v[52:55]
  s_waitcnt lgkmcnt(2)
  v_mfma_f32_16x16x32_bf16 v[24:27], v[72:75], a[44:47], v[24:27]
  ds_read_b128 v[64:67], v20 offset:13312
  v_mfma_f32_16x16x32_bf16 v[28:31], v[76:79], a[44:47], v[28:31]
  ds_read_b128 v[68:71], v20 offset:27648
  v_mfma_f32_16x16x32_bf16 v[32:35], v[72:75], a[100:103], v[32:35]
  v_mfma_f32_16x16x32_bf16 v[36:39], v[76:79], a[100:103], v[36:39]
  v_mfma_f32_16x16x32_bf16 v[40:43], v[72:75], a[156:159], v[40:43]
  v_mfma_f32_16x16x32_bf16 v[44:47], v[76:79], a[156:159], v[44:47]
  v_mfma_f32_16x16x32_bf16 v[48:51], v[72:75], a[212:215], v[48:51]
  v_mfma_f32_16x16x32_bf16 v[52:55], v[76:79], a[212:215], v[52:55]
  s_waitcnt lgkmcnt(2)
  v_mfma_f32_16x16x32_bf16 v[24:27], v[56:59], a[48:51], v[24:27]
  v_mfma_f32_16x16x32_bf16 v[28:31], v[60:63], a[48:51], v[28:31]
  v_mfma_f32_16x16x32_bf16 v[32:35], v[56:59], a[104:107], v[32:35]
  v_mfma_f32_16x16x32_bf16 v[36:39], v[60:63], a[104:107], v[36:39]
  v_mfma_f32_16x16x32_bf16 v[40:43], v[56:59], a[160:163], v[40:43]
  v_mfma_f32_16x16x32_bf16 v[44:47], v[60:63], a[160:163], v[44:47]
  v_mfma_f32_16x16x32_bf16 v[48:51], v[56:59], a[216:219], v[48:51]
  v_mfma_f32_16x16x32_bf16 v[52:55], v[60:63], a[216:219], v[52:55]
  s_waitcnt lgkmcnt(0)
  v_mfma_f32_16x16x32_bf16 v[24:27], v[64:67], a[52:55], v[24:27]
  v_mfma_f32_16x16x32_bf16 v[28:31], v[68:71], a[52:55], v[28:31]
  v_mfma_f32_16x16x32_bf16 v[32:35], v[64:67], a[108:111], v[32:35]
  v_mfma_f32_16x16x32_bf16 v[36:39], v[68:71], a[108:111], v[36:39]
  v_mfma_f32_16x16x32_bf16 v[40:43], v[64:67], a[164:167], v[40:43]
  v_mfma_f32_16x16x32_bf16 v[44:47], v[68:71], a[164:167], v[44:47]
  v_mfma_f32_16x16x32_bf16 v[48:51], v[64:67], a[220:223], v[48:51]
  v_mfma_f32_16x16x32_bf16 v[52:55], v[68:71], a[220:223], v[52:55]
  s_nop 0
  v_cvt_pk_bf16_f32 v24, v24, v25
  v_cvt_pk_bf16_f32 v25, v26, v27
  v_cvt_pk_bf16_f32 v26, v28, v29
  v_cvt_pk_bf16_f32 v27, v30, v31
  buffer_store_dwordx4 v[24:27], v5, s[32:35], s62 offen offset:0 sc1
  v_cvt_pk_bf16_f32 v32, v32, v33
  v_cvt_pk_bf16_f32 v33, v34, v35
  v_cvt_pk_bf16_f32 v34, v36, v37
  v_cvt_pk_bf16_f32 v35, v38, v39
  buffer_store_dwordx4 v[32:35], v5, s[32:35], s62 offen offset:1024 sc1
  v_cvt_pk_bf16_f32 v40, v40, v41
  v_cvt_pk_bf16_f32 v41, v42, v43
  v_cvt_pk_bf16_f32 v42, v44, v45
  v_cvt_pk_bf16_f32 v43, v46, v47
  buffer_store_dwordx4 v[40:43], v5, s[32:35], s62 offen offset:2048 sc1
  v_cvt_pk_bf16_f32 v48, v48, v49
  v_cvt_pk_bf16_f32 v49, v50, v51
  v_cvt_pk_bf16_f32 v50, v52, v53
  v_cvt_pk_bf16_f32 v51, v54, v55
  buffer_store_dwordx4 v[48:51], v5, s[32:35], s62 offen offset:3072 sc1
  v_xor_b32 v4, 0x8000, v4
  v_xor_b32 v20, 0x8000, v20
  s_mov_b32 s68, s63
  s_add_u32 s62, s62, 458752
  s_add_u32 s63, s63, 3584
  s_add_u32 s61, s61, 1
  s_cmp_lt_u32 s61, 64
  s_cbranch_scc1 u0_177
  s_waitcnt vmcnt(0)
  buffer_store_dword v7, v6, s[32:35], s68 offen sc1
  s_endpgm
r_U1:
  v_lshlrev_b32 v12, 7, v10
  v_lshl_add_u32 v12, v9, 3, v12
  v_add_u32 v13, 1536, v12
  v_mov_b32 v11, 1073741824
  v_cmp_gt_u32 vcc, 2, v10
  s_nop 1
  v_cndmask_b32 v13, v11, v13, vcc
  v_mov_b32 v11, 1.0
  v_mov_b32 v14, 0
  v_cndmask_b32 v14, v14, v11, vcc
  s_lshl_b32 s44, s48, 8
  s_add_u32 s45, s44, 65536
  v_lshlrev_b32 v15, 2, v9
  v_add_u32 v15, s45, v15
  v_lshlrev_b32 v16, 4, v10
  v_add_u32 v16, s45, v16
  s_lshl_b32 s44, s50, 10
  v_add_u32 v17, s44, v2
  v_mov_b32 v23, v17
  s_cmp_ge_u32 s50, 14
  s_cselect_b64 s[72:73], -1, 0
  s_mov_b32 s59, 0
  s_mov_b32 s57, 124787712
  v_mov_b32 v172, 0
  s_mul_i32 s44, s48, 7168
  v_lshlrev_b32 v173, 10, v1
  v_add_u32 v173, s44, v173
  v_mov_b32 v174, 1073741824
  v_cmp_gt_u32 vcc, 7, v1
  s_nop 1
  v_cndmask_b32 v173, v174, v173, vcc
  v_subrev_u32 v175, 32, v1
  v_cmp_lt_u32 vcc, 13, v175
  v_mov_b32 v176, 2
  s_nop 0
  v_cndmask_b32 v176, 0, v176, vcc
  v_add_u32 v176, v175, v176
  v_lshlrev_b32 v176, 7, v176
  v_add_u32 v176, 36864, v176
  v_cmp_gt_u32 vcc, 28, v175
  s_nop 1
  v_cndmask_b32 v173, v173, v176, vcc
  s_cmp_eq_u32 s48, 3
  s_cselect_b64 vcc, 1, 0
  v_mov_b32 v11, 1073741824
  v_mov_b32 v19, 0
  v_cndmask_b32 v19, v11, v19, vcc
  s_cmp_eq_u32 s48, 3
  s_cselect_b64 vcc, -1, 0
  v_cndmask_b32 v18, v11, v17, vcc
  v_mov_b32 v144, 0x3f803f80
  v_mov_b32 v145, 0x3f803f80
  v_mov_b32 v146, 0x3f803f80
  v_mov_b32 v147, 0x3f803f80
  s_waitcnt vmcnt(0)
  s_nop 0
  v_mfma_f32_16x16x32_bf16 v[24:27], v[144:147], a[0:3], 0
  v_mfma_f32_16x16x32_bf16 v[28:31], v[144:147], a[56:59], 0
  v_mfma_f32_16x16x32_bf16 v[32:35], v[144:147], a[112:115], 0
  v_mfma_f32_16x16x32_bf16 v[36:39], v[144:147], a[168:171], 0
  v_mfma_f32_16x16x32_bf16 v[24:27], v[144:147], a[4:7], v[24:27]
  v_mfma_f32_16x16x32_bf16 v[28:31], v[144:147], a[60:63], v[28:31]
  v_mfma_f32_16x16x32_bf16 v[32:35], v[144:147], a[116:119], v[32:35]
  v_mfma_f32_16x16x32_bf16 v[36:39], v[144:147], a[172:175], v[36:39]
  v_mfma_f32_16x16x32_bf16 v[24:27], v[144:147], a[8:11], v[24:27]
  v_mfma_f32_16x16x32_bf16 v[28:31], v[144:147], a[64:67], v[28:31]
  v_mfma_f32_16x16x32_bf16 v[32:35], v[144:147], a[120:123], v[32:35]
  v_mfma_f32_16x16x32_bf16 v[36:39], v[144:147], a[176:179], v[36:39]
  v_mfma_f32_16x16x32_bf16 v[24:27], v[144:147], a[12:15], v[24:27]
  v_mfma_f32_16x16x32_bf16 v[28:31], v[144:147], a[68:71], v[28:31]
  v_mfma_f32_16x16x32_bf16 v[32:35], v[144:147], a[124:127], v[32:35]
  v_mfma_f32_16x16x32_bf16 v[36:39], v[144:147], a[180:183], v[36:39]
  v_mfma_f32_16x16x32_bf16 v[24:27], v[144:147], a[16:19], v[24:27]
  v_mfma_f32_16x16x32_bf16 v[28:31], v[144:147], a[72:75], v[28:31]
  v_mfma_f32_16x16x32_bf16 v[32:35], v[144:147], a[128:131], v[32:35]
  v_mfma_f32_16x16x32_bf16 v[36:39], v[144:147], a[184:187], v[36:39]
  v_mfma_f32_16x16x32_bf16 v[24:27], v[144:147], a[20:23], v[24:27]
  v_mfma_f32_16x16x32_bf16 v[28:31], v[144:147], a[76:79], v[28:31]
  v_mfma_f32_16x16x32_bf16 v[32:35], v[144:147], a[132:135], v[32:35]
  v_mfma_f32_16x16x32_bf16 v[36:39], v[144:147], a[188:191], v[36:39]
  v_mfma_f32_16x16x32_bf16 v[24:27], v[144:147], a[24:27], v[24:27]
  v_mfma_f32_16x16x32_bf16 v[28:31], v[144:147], a[80:83], v[28:31]
  v_mfma_f32_16x16x32_bf16 v[32:35], v[144:147], a[136:139], v[32:35]
  v_mfma_f32_16x16x32_bf16 v[36:39], v[144:147], a[192:195], v[36:39]
  v_mfma_f32_16x16x32_bf16 v[24:27], v[144:147], a[28:31], v[24:27]
  v_mfma_f32_16x16x32_bf16 v[28:31], v[144:147], a[84:87], v[28:31]
  v_mfma_f32_16x16x32_bf16 v[32:35], v[144:147], a[140:143], v[32:35]
  v_mfma_f32_16x16x32_bf16 v[36:39], v[144:147], a[196:199], v[36:39]
  v_mfma_f32_16x16x32_bf16 v[24:27], v[144:147], a[32:35], v[24:27]
  v_mfma_f32_16x16x32_bf16 v[28:31], v[144:147], a[88:91], v[28:31]
  v_mfma_f32_16x16x32_bf16 v[32:35], v[144:147], a[144:147], v[32:35]
  v_mfma_f32_16x16x32_bf16 v[36:39], v[144:147], a[200:203], v[36:39]
  v_mfma_f32_16x16x32_bf16 v[24:27], v[144:147], a[36:39], v[24:27]
  v_mfma_f32_16x16x32_bf16 v[28:31], v[144:147], a[92:95], v[28:31]
  v_mfma_f32_16x16x32_bf16 v[32:35], v[144:147], a[148:151], v[32:35]
  v_mfma_f32_16x16x32_bf16 v[36:39], v[144:147], a[204:207], v[36:39]
  v_mfma_f32_16x16x32_bf16 v[24:27], v[144:147], a[40:43], v[24:27]
  v_mfma_f32_16x16x32_bf16 v[28:31], v[144:147], a[96:99], v[28:31]
  v_mfma_f32_16x16x32_bf16 v[32:35], v[144:147], a[152:155], v[32:35]
  v_mfma_f32_16x16x32_bf16 v[36:39], v[144:147], a[208:211], v[36:39]
  v_mfma_f32_16x16x32_bf16 v[24:27], v[144:147], a[44:47], v[24:27]
  v_mfma_f32_16x16x32_bf16 v[28:31], v[144:147], a[100:103], v[28:31]
  v_mfma_f32_16x16x32_bf16 v[32:35], v[144:147], a[156:159], v[32:35]
  v_mfma_f32_16x16x32_bf16 v[36:39], v[144:147], a[212:215], v[36:39]
  v_mfma_f32_16x16x32_bf16 v[24:27], v[144:147], a[48:51], v[24:27]
  v_mfma_f32_16x16x32_bf16 v[28:31], v[144:147], a[104:107], v[28:31]
  v_mfma_f32_16x16x32_bf16 v[32:35], v[144:147], a[160:163], v[32:35]
  v_mfma_f32_16x16x32_bf16 v[36:39], v[144:147], a[216:219], v[36:39]
  v_mfma_f32_16x16x32_bf16 v[24:27], v[144:147], a[52:55], v[24:27]
  v_mfma_f32_16x16x32_bf16 v[28:31], v[144:147], a[108:111], v[28:31]
  v_mfma_f32_16x16x32_bf16 v[32:35], v[144:147], a[164:167], v[32:35]
  v_mfma_f32_16x16x32_bf16 v[36:39], v[144:147], a[220:223], v[36:39]
  s_nop 4
  v_mov_b32 v124, v24
  v_mov_b32 v125, v28
  v_mov_b32 v126, v32
  v_mov_b32 v127, v36
  s_mov_b32 s65, 80191488
  s_mov_b32 s66, 80195584
  s_mov_b32 s67, 80228352
  s_mov_b32 s64, 19496960
  s_lshl_b32 s44, s50, 7
  s_add_u32 s70, s44, 124551168
  s_mov_b32 s69, 1073741824
  s_mul_i32 s71, s48, 7168
  v_mov_b32 v108, -1
u1_178:
  s_mov_b32 s51, s61
  s_waitcnt vmcnt(5)
  v_max3_u32 v21, v108, v109, v110
  v_max3_u32 v21, v21, v111, v112
  v_max3_u32 v21, v21, v113, v114
  v_max3_u32 v21, v21, v115, v116
  v_max3_u32 v21, v21, v117, v118
  v_max3_u32 v21, v21, v119, v120
  v_max3_u32 v21, v21, v121, v122
  v_max_u32 v21, v21, v123
  v_cmp_eq_u32 vcc, -1, v21
  s_cbranch_vccz sok_179
  s_waitcnt vmcnt(0)
  buffer_store_dword v7, v6, s[32:35], s68 offen sc1
  buffer_store_dword v7, v19, s[32:35], s69 offen sc1
  s_mov_b32 s68, 1073741824
  s_mov_b32 s69, 1073741824
  s_and_b32 s44, s61, 7
  s_cmp_ge_u32 s44, 1
  s_cbranch_scc1 rdy_180
  s_lshr_b32 s44, s61, 3
  s_lshl_b32 s44, s44, 7
  s_add_u32 s44, s44, 124786816
  v_mov_b32 v21, 0
  s_mov_b32 s52, 60000
poll_181:
  buffer_load_dword v22, v21, s[32:35], s44 offen sc1
  s_waitcnt vmcnt(0)
  v_cmp_ne_u32 vcc, 96, v22
  s_cbranch_vccz pok_182
  s_sleep 8
  s_sub_u32 s52, s52, 1
  s_cbranch_scc0 poll_181
  s_mov_b32 s54, 44
  s_branch k1_fail
pok_182:
rdy_180:
  buffer_load_dwordx2 v[108:109], v12, s[32:35], s67 offen offset:0 sc1
  buffer_load_dwordx2 v[110:111], v12, s[32:35], s67 offen offset:512 sc1
  buffer_load_dwordx2 v[112:113], v12, s[32:35], s67 offen offset:1024 sc1
  buffer_load_dwordx2 v[114:115], v13, s[32:35], s67 offen offset:0 sc1
  buffer_load_dwordx2 v[116:117], v12, s[32:35], s67 offen offset:2048 sc1
  buffer_load_dwordx2 v[118:119], v12, s[32:35], s67 offen offset:2560 sc1
  buffer_load_dwordx2 v[120:121], v12, s[32:35], s67 offen offset:3072 sc1
  buffer_load_dwordx2 v[122:123], v13, s[32:35], s67 offen offset:2048 sc1
  s_add_u32 m0, s71, 0
  s_nop 0
  buffer_load_dwordx4 v3, s[32:35], s65 offen offset:0 sc1 lds
  s_add_u32 m0, s71, 0
  s_nop 0
  buffer_load_dwordx4 v3, s[32:35], s65 offen offset:1024 sc1 lds
  s_add_u32 m0, s71, 0
  s_nop 0
  buffer_load_dwordx4 v3, s[32:35], s65 offen offset:2048 sc1 lds
  s_add_u32 m0, s71, 0
  s_nop 0
  buffer_load_dwordx4 v3, s[32:35], s65 offen offset:3072 sc1 lds
  s_add_u32 m0, s71, 4096
  s_nop 0
  buffer_load_dwordx4 v3, s[32:35], s66 offen offset:0 sc1 lds
  s_add_u32 m0, s71, 4096
  s_nop 0
  buffer_load_dwordx4 v3, s[32:35], s66 offen offset:1024 sc1 lds
  s_add_u32 m0, s71, 4096
  s_nop 0
  buffer_load_dwordx4 v3, s[32:35], s66 offen offset:2048 sc1 lds
  s_waitcnt vmcnt(0)
  v_max3_u32 v21, v108, v109, v110
  v_max3_u32 v21, v21, v111, v112
  v_max3_u32 v21, v21, v113, v114
  v_max3_u32 v21, v21, v115, v116
  v_max3_u32 v21, v21, v117, v118
  v_max3_u32 v21, v21, v119, v120
  v_max3_u32 v21, v21, v121, v122
  v_max_u32 v21, v21, v123
  v_cmp_eq_u32 vcc, -1, v21
  s_cbranch_vccz sok_179
  s_mov_b32 s52, 60000
poll_183:
  buffer_load_dword v21, v173, s[32:35], s65 offen sc1
  s_waitcnt vmcnt(0)
  v_cmp_eq_u32 vcc, -1, v21
  s_cbranch_vccz pok_184
  s_sleep 2
  s_sub_u32 s52, s52, 1
  s_cbranch_scc0 poll_183
  s_mov_b32 s54, 42
  s_branch k1_fail
pok_184:
  s_mov_b32 s52, 60000
poll_185:
  buffer_load_dwordx2 v[108:109], v12, s[32:35], s67 offen offset:0 sc1
  buffer_load_dwordx2 v[110:111], v12, s[32:35], s67 offen offset:512 sc1
  buffer_load_dwordx2 v[112:113], v12, s[32:35], s67 offen offset:1024 sc1
  buffer_load_dwordx2 v[114:115], v13, s[32:35], s67 offen offset:0 sc1
  buffer_load_dwordx2 v[116:117], v12, s[32:35], s67 offen offset:2048 sc1
  buffer_load_dwordx2 v[118:119], v12, s[32:35], s67 offen offset:2560 sc1
  buffer_load_dwordx2 v[120:121], v12, s[32:35], s67 offen offset:3072 sc1
  buffer_load_dwordx2 v[122:123], v13, s[32:35], s67 offen offset:2048 sc1
  s_add_u32 m0, s71, 0
  s_nop 0
  buffer_load_dwordx4 v3, s[32:35], s65 offen offset:0 sc1 lds
  s_add_u32 m0, s71, 0
  s_nop 0
  buffer_load_dwordx4 v3, s[32:35], s65 offen offset:1024 sc1 lds
  s_add_u32 m0, s71, 0
  s_nop 0
  buffer_load_dwordx4 v3, s[32:35], s65 offen offset:2048 sc1 lds
  s_add_u32 m0, s71, 0
  s_nop 0
  buffer_load_dwordx4 v3, s[32:35], s65 offen offset:3072 sc1 lds
  s_add_u32 m0, s71, 4096
  s_nop 0
  buffer_load_dwordx4 v3, s[32:35], s66 offen offset:0 sc1 lds
  s_add_u32 m0, s71, 4096
  s_nop 0
  buffer_load_dwordx4 v3, s[32:35], s66 offen offset:1024 sc1 lds
  s_add_u32 m0, s71, 4096
  s_nop 0
  buffer_load_dwordx4 v3, s[32:35], s66 offen offset:2048 sc1 lds
  s_waitcnt vmcnt(0)
  v_max3_u32 v21, v108, v109, v110
  v_max3_u32 v21, v21, v111, v112
  v_max3_u32 v21, v21, v113, v114
  v_max3_u32 v21, v21, v115, v116
  v_max3_u32 v21, v21, v117, v118
  v_max3_u32 v21, v21, v119, v120
  v_max3_u32 v21, v21, v121, v122
  v_max_u32 v21, v21, v123
  v_cmp_eq_u32 vcc, -1, v21
  s_cbranch_vccz pok_186
  s_sleep 2
  s_sub_u32 s52, s52, 1
  s_cbranch_scc0 poll_185
  s_mov_b32 s54, 40
  s_branch k1_fail
pok_186:
sok_179:
  v_mov_b32 v156, v108
  v_mov_b32 v157, v109
  v_mov_b32 v158, v110
  v_mov_b32 v159, v111
  v_mov_b32 v160, v112
  v_mov_b32 v161, v113
  v_mov_b32 v162, v114
  v_mov_b32 v163, v115
  v_mov_b32 v164, v116
  v_mov_b32 v165, v117
  v_mov_b32 v166, v118
  v_mov_b32 v167, v119
  v_mov_b32 v168, v120
  v_mov_b32 v169, v121
  v_mov_b32 v170, v122
  v_mov_b32 v171, v123
  s_barrier
  s_mov_b32 s74, s65
  s_mov_b32 s75, 0
  s_xor_b32 s71, s71, 0x8000
  s_add_u32 s65, s65, 638976
  s_add_u32 s66, s66, 638976
  s_add_u32 s67, s67, 638976
  ds_read_b128 v[56:59], v20 offset:0
  ds_read_b128 v[60:63], v20 offset:14336
  ds_read_b128 v[64:67], v20 offset:1024
  ds_read_b128 v[68:71], v20 offset:15360
  s_waitcnt lgkmcnt(2)
  v_mfma_f32_16x16x32_bf16 v[24:27], v[56:59], a[0:3], 0
  ds_read_b128 v[72:75], v20 offset:2048
  v_mfma_f32_16x16x32_bf16 v[28:31], v[60:63], a[0:3], 0
  ds_read_b128 v[76:79], v20 offset:16384
  v_mfma_f32_16x16x32_bf16 v[32:35], v[56:59], a[56:59], 0
  v_mfma_f32_16x16x32_bf16 v[36:39], v[60:63], a[56:59], 0
  v_mfma_f32_16x16x32_bf16 v[40:43], v[56:59], a[112:115], 0
  v_mfma_f32_16x16x32_bf16 v[44:47], v[60:63], a[112:115], 0
  s_waitcnt vmcnt(0)
  buffer_store_dword v7, v6, s[32:35], s68 offen sc1
  buffer_store_dword v7, v19, s[32:35], s69 offen sc1
  s_mov_b32 s68, 1073741824
  s_mov_b32 s69, 1073741824
  v_mfma_f32_16x16x32_bf16 v[48:51], v[56:59], a[168:171], 0
  v_add_f32 v148, v156, v158
  v_mfma_f32_16x16x32_bf16 v[52:55], v[60:63], a[168:171], 0
  v_add_f32 v149, v160, v162
  s_waitcnt lgkmcnt(2)
  v_mfma_f32_16x16x32_bf16 v[24:27], v[64:67], a[4:7], v[24:27]
  ds_read_b128 v[56:59], v20 offset:3072
  v_add_f32 v148, v148, v149
  v_mfma_f32_16x16x32_bf16 v[28:31], v[68:71], a[4:7], v[28:31]
  ds_read_b128 v[60:63], v20 offset:17408
  v_mov_b32 v150, v148
  v_mfma_f32_16x16x32_bf16 v[32:35], v[64:67], a[60:63], v[32:35]
  s_nop 0
  v_permlane16_swap_b32 v148, v150
  v_mfma_f32_16x16x32_bf16 v[36:39], v[68:71], a[60:63], v[36:39]
  v_add_f32 v148, v148, v150
  v_mfma_f32_16x16x32_bf16 v[40:43], v[64:67], a[116:119], v[40:43]
  v_mov_b32 v150, v148
  v_mfma_f32_16x16x32_bf16 v[44:47], v[68:71], a[116:119], v[44:47]
  s_nop 0
  v_permlane32_swap_b32 v148, v150
  v_mfma_f32_16x16x32_bf16 v[48:51], v[64:67], a[172:175], v[48:51]
  v_add_f32 v148, v148, v150
  v_mfma_f32_16x16x32_bf16 v[52:55], v[68:71], a[172:175], v[52:55]
  v_mul_f32 v148, 0x3d924925, v148
  s_waitcnt lgkmcnt(2)
  v_mfma_f32_16x16x32_bf16 v[24:27], v[72:75], a[8:11], v[24:27]
  ds_read_b128 v[64:67], v20 offset:4096
  v_add_f32 v149, v157, v159
  v_mfma_f32_16x16x32_bf16 v[28:31], v[76:79], a[8:11], v[28:31]
  ds_read_b128 v[68:71], v20 offset:18432
  v_add_f32 v150, v161, v163
  v_mfma_f32_16x16x32_bf16 v[32:35], v[72:75], a[64:67], v[32:35]
  v_add_f32 v149, v149, v150
  v_mfma_f32_16x16x32_bf16 v[36:39], v[76:79], a[64:67], v[36:39]
  v_sub_f32 v156, v156, v148
  v_mfma_f32_16x16x32_bf16 v[40:43], v[72:75], a[120:123], v[40:43]
  v_sub_f32 v158, v158, v148
  v_mfma_f32_16x16x32_bf16 v[44:47], v[76:79], a[120:123], v[44:47]
  v_sub_f32 v160, v160, v148
  v_mfma_f32_16x16x32_bf16 v[48:51], v[72:75], a[176:179], v[48:51]
  v_sub_f32 v162, v162, v148
  v_mfma_f32_16x16x32_bf16 v[52:55], v[76:79], a[176:179], v[52:55]
  v_mul_f32 v162, v162, v14
  s_waitcnt lgkmcnt(2)
  v_mfma_f32_16x16x32_bf16 v[24:27], v[56:59], a[12:15], v[24:27]
  ds_read_b128 v[72:75], v20 offset:5120
  v_mul_f32 v150, v156, v156
  v_mfma_f32_16x16x32_bf16 v[28:31], v[60:63], a[12:15], v[28:31]
  ds_read_b128 v[76:79], v20 offset:19456
  v_fmac_f32 v150, v158, v158
  v_mfma_f32_16x16x32_bf16 v[32:35], v[56:59], a[68:71], v[32:35]
  v_fmac_f32 v150, v160, v160
  v_mfma_f32_16x16x32_bf16 v[36:39], v[60:63], a[68:71], v[36:39]
  v_fmac_f32 v150, v162, v162
  v_mfma_f32_16x16x32_bf16 v[40:43], v[56:59], a[124:127], v[40:43]
  v_fmac_f32 v149, 0x42000000, v150
  v_mfma_f32_16x16x32_bf16 v[44:47], v[60:63], a[124:127], v[44:47]
  v_mov_b32 v150, v149
  v_mfma_f32_16x16x32_bf16 v[48:51], v[56:59], a[180:183], v[48:51]
  s_nop 0
  v_permlane16_swap_b32 v149, v150
  v_mfma_f32_16x16x32_bf16 v[52:55], v[60:63], a[180:183], v[52:55]
  v_add_f32 v149, v149, v150
  s_waitcnt lgkmcnt(2)
  v_mfma_f32_16x16x32_bf16 v[24:27], v[64:67], a[16:19], v[24:27]
  ds_read_b128 v[56:59], v20 offset:6144
  v_mov_b32 v150, v149
  v_mfma_f32_16x16x32_bf16 v[28:31], v[68:71], a[16:19], v[28:31]
  ds_read_b128 v[60:63], v20 offset:20480
  v_permlane32_swap_b32 v149, v150
  v_mfma_f32_16x16x32_bf16 v[32:35], v[64:67], a[72:75], v[32:35]
  v_add_f32 v149, v149, v150
  v_mfma_f32_16x16x32_bf16 v[36:39], v[68:71], a[72:75], v[36:39]
  v_mov_b32 v150, 0x3727c5ac
  v_mfma_f32_16x16x32_bf16 v[40:43], v[64:67], a[128:131], v[40:43]
  v_fmac_f32 v150, 0x3b124925, v149
  v_mfma_f32_16x16x32_bf16 v[44:47], v[68:71], a[128:131], v[44:47]
  v_rsq_f32 v150, v150
  v_mfma_f32_16x16x32_bf16 v[48:51], v[64:67], a[184:187], v[48:51]
  v_mul_f32 v149, v148, v150
  v_mfma_f32_16x16x32_bf16 v[52:55], v[68:71], a[184:187], v[52:55]
  v_sub_f32 v149, 0, v149
  s_waitcnt lgkmcnt(2)
  v_mfma_f32_16x16x32_bf16 v[24:27], v[72:75], a[20:23], v[24:27]
  ds_read_b128 v[64:67], v20 offset:7168
  v_mov_b32 v148, v150
  v_mfma_f32_16x16x32_bf16 v[28:31], v[76:79], a[20:23], v[28:31]
  ds_read_b128 v[68:71], v20 offset:21504
  v_add_f32 v152, v164, v166
  v_mfma_f32_16x16x32_bf16 v[32:35], v[72:75], a[76:79], v[32:35]
  v_add_f32 v153, v168, v170
  v_mfma_f32_16x16x32_bf16 v[36:39], v[76:79], a[76:79], v[36:39]
  v_add_f32 v152, v152, v153
  v_mfma_f32_16x16x32_bf16 v[40:43], v[72:75], a[132:135], v[40:43]
  v_mov_b32 v154, v152
  v_mfma_f32_16x16x32_bf16 v[44:47], v[76:79], a[132:135], v[44:47]
  s_nop 0
  v_permlane16_swap_b32 v152, v154
  v_mfma_f32_16x16x32_bf16 v[48:51], v[72:75], a[188:191], v[48:51]
  v_add_f32 v152, v152, v154
  v_mfma_f32_16x16x32_bf16 v[52:55], v[76:79], a[188:191], v[52:55]
  v_mov_b32 v154, v152
  s_waitcnt lgkmcnt(2)
  v_mfma_f32_16x16x32_bf16 v[24:27], v[56:59], a[24:27], v[24:27]
  ds_read_b128 v[72:75], v20 offset:8192
  v_permlane32_swap_b32 v152, v154
  v_mfma_f32_16x16x32_bf16 v[28:31], v[60:63], a[24:27], v[28:31]
  ds_read_b128 v[76:79], v20 offset:22528
  v_add_f32 v152, v152, v154
  v_mfma_f32_16x16x32_bf16 v[32:35], v[56:59], a[80:83], v[32:35]
  v_mul_f32 v152, 0x3d924925, v152
  v_mfma_f32_16x16x32_bf16 v[36:39], v[60:63], a[80:83], v[36:39]
  v_add_f32 v153, v165, v167
  v_mfma_f32_16x16x32_bf16 v[40:43], v[56:59], a[136:139], v[40:43]
  v_add_f32 v154, v169, v171
  v_mfma_f32_16x16x32_bf16 v[44:47], v[60:63], a[136:139], v[44:47]
  v_add_f32 v153, v153, v154
  v_mfma_f32_16x16x32_bf16 v[48:51], v[56:59], a[192:195], v[48:51]
  v_sub_f32 v164, v164, v152
  v_mfma_f32_16x16x32_bf16 v[52:55], v[60:63], a[192:195], v[52:55]
  v_sub_f32 v166, v166, v152
  s_waitcnt lgkmcnt(2)
  v_mfma_f32_16x16x32_bf16 v[24:27], v[64:67], a[28:31], v[24:27]
  ds_read_b128 v[56:59], v20 offset:9216
  v_sub_f32 v168, v168, v152
  v_mfma_f32_16x16x32_bf16 v[28:31], v[68:71], a[28:31], v[28:31]
  ds_read_b128 v[60:63], v20 offset:23552
  v_sub_f32 v170, v170, v152
  v_mfma_f32_16x16x32_bf16 v[32:35], v[64:67], a[84:87], v[32:35]
  v_mul_f32 v170, v170, v14
  v_mfma_f32_16x16x32_bf16 v[36:39], v[68:71], a[84:87], v[36:39]
  v_mul_f32 v154, v164, v164
  v_mfma_f32_16x16x32_bf16 v[40:43], v[64:67], a[140:143], v[40:43]
  v_fmac_f32 v154, v166, v166
  v_mfma_f32_16x16x32_bf16 v[44:47], v[68:71], a[140:143], v[44:47]
  v_fmac_f32 v154, v168, v168
  v_mfma_f32_16x16x32_bf16 v[48:51], v[64:67], a[196:199], v[48:51]
  v_fmac_f32 v154, v170, v170
  v_mfma_f32_16x16x32_bf16 v[52:55], v[68:71], a[196:199], v[52:55]
  v_fmac_f32 v153, 0x42000000, v154
  s_waitcnt lgkmcnt(2)
  v_mfma_f32_16x16x32_bf16 v[24:27], v[72:75], a[32:35], v[24:27]
  ds_read_b128 v[64:67], v20 offset:10240
  v_mov_b32 v154, v153
  v_mfma_f32_16x16x32_bf16 v[28:31], v[76:79], a[32:35], v[28:31]
  ds_read_b128 v[68:71], v20 offset:24576
  v_permlane16_swap_b32 v153, v154
  v_mfma_f32_16x16x32_bf16 v[32:35], v[72:75], a[88:91], v[32:35]
  v_add_f32 v153, v153, v154
  v_mfma_f32_16x16x32_bf16 v[36:39], v[76:79], a[88:91], v[36:39]
  v_mov_b32 v154, v153
  v_mfma_f32_16x16x32_bf16 v[40:43], v[72:75], a[144:147], v[40:43]
  s_nop 0
  v_permlane32_swap_b32 v153, v154
  v_mfma_f32_16x16x32_bf16 v[44:47], v[76:79], a[144:147], v[44:47]
  v_add_f32 v153, v153, v154
  v_mfma_f32_16x16x32_bf16 v[48:51], v[72:75], a[200:203], v[48:51]
  v_mov_b32 v154, 0x3727c5ac
  v_mfma_f32_16x16x32_bf16 v[52:55], v[76:79], a[200:203], v[52:55]
  v_fmac_f32 v154, 0x3b124925, v153
  s_waitcnt lgkmcnt(2)
  v_mfma_f32_16x16x32_bf16 v[24:27], v[56:59], a[36:39], v[24:27]
  ds_read_b128 v[72:75], v20 offset:11264
  v_rsq_f32 v154, v154
  v_mfma_f32_16x16x32_bf16 v[28:31], v[60:63], a[36:39], v[28:31]
  ds_read_b128 v[76:79], v20 offset:25600
  v_mul_f32 v153, v152, v154
  v_mfma_f32_16x16x32_bf16 v[32:35], v[56:59], a[92:95], v[32:35]
  v_sub_f32 v153, 0, v153
  v_mfma_f32_16x16x32_bf16 v[36:39], v[60:63], a[92:95], v[36:39]
  v_mov_b32 v152, v154
  v_mfma_f32_16x16x32_bf16 v[40:43], v[56:59], a[148:151], v[40:43]
  v_mfma_f32_16x16x32_bf16 v[44:47], v[60:63], a[148:151], v[44:47]
  v_mfma_f32_16x16x32_bf16 v[48:51], v[56:59], a[204:207], v[48:51]
  v_mfma_f32_16x16x32_bf16 v[52:55], v[60:63], a[204:207], v[52:55]
  s_waitcnt lgkmcnt(2)
  v_mfma_f32_16x16x32_bf16 v[24:27], v[64:67], a[40:43], v[24:27]
  ds_read_b128 v[56:59], v20 offset:12288
  v_mfma_f32_16x16x32_bf16 v[28:31], v[68:71], a[40:43], v[28:31]
  ds_read_b128 v[60:63], v20 offset:26624
  buffer_load_dwordx2 v[108:109], v12, s[32:35], s67 offen offset:0 sc1
  v_mfma_f32_16x16x32_bf16 v[32:35], v[64:67], a[96:99], v[32:35]
  v_mfma_f32_16x16x32_bf16 v[36:39], v[68:71], a[96:99], v[36:39]
  buffer_load_dwordx2 v[110:111], v12, s[32:35], s67 offen offset:512 sc1
  v_mfma_f32_16x16x32_bf16 v[40:43], v[64:67], a[152:155], v[40:43]
  v_mfma_f32_16x16x32_bf16 v[44:47], v[68:71], a[152:155], v[44:47]
  buffer_load_dwordx2 v[112:113], v12, s[32:35], s67 offen offset:1024 sc1
  v_mfma_f32_16x16x32_bf16 v[48:51], v[64:67], a[208:211], v[48:51]
  v_mfma_f32_16x16x32_bf16 v[52:55], v[68:71], a[208:211], v[52:55]
  buffer_load_dwordx2 v[114:115], v13, s[32:35], s67 offen offset:0 sc1
  s_waitcnt lgkmcnt(2)
  v_mfma_f32_16x16x32_bf16 v[24:27], v[72:75], a[44:47], v[24:27]
  ds_read_b128 v[64:67], v20 offset:13312
  v_mfma_f32_16x16x32_bf16 v[28:31], v[76:79], a[44:47], v[28:31]
  ds_read_b128 v[68:71], v20 offset:27648
  buffer_load_dwordx2 v[116:117], v12, s[32:35], s67 offen offset:2048 sc1
  v_mfma_f32_16x16x32_bf16 v[32:35], v[72:75], a[100:103], v[32:35]
  v_mfma_f32_16x16x32_bf16 v[36:39], v[76:79], a[100:103], v[36:39]
  buffer_load_dwordx2 v[118:119], v12, s[32:35], s67 offen offset:2560 sc1
  v_mfma_f32_16x16x32_bf16 v[40:43], v[72:75], a[156:159], v[40:43]
  v_mfma_f32_16x16x32_bf16 v[44:47], v[76:79], a[156:159], v[44:47]
  buffer_load_dwordx2 v[120:121], v12, s[32:35], s67 offen offset:3072 sc1
  v_mfma_f32_16x16x32_bf16 v[48:51], v[72:75], a[212:215], v[48:51]
  v_mfma_f32_16x16x32_bf16 v[52:55], v[76:79], a[212:215], v[52:55]
  buffer_load_dwordx2 v[122:123], v13, s[32:35], s67 offen offset:2048 sc1
  s_waitcnt lgkmcnt(2)
  v_mfma_f32_16x16x32_bf16 v[24:27], v[56:59], a[48:51], v[24:27]
  v_mfma_f32_16x16x32_bf16 v[28:31], v[60:63], a[48:51], v[28:31]
  s_add_u32 m0, s71, 0
  s_nop 0
  buffer_load_dwordx4 v3, s[32:35], s65 offen offset:0 sc1 lds
  v_mfma_f32_16x16x32_bf16 v[32:35], v[56:59], a[104:107], v[32:35]
  v_mfma_f32_16x16x32_bf16 v[36:39], v[60:63], a[104:107], v[36:39]
  s_add_u32 m0, s71, 0
  s_nop 0
  buffer_load_dwordx4 v3, s[32:35], s65 offen offset:1024 sc1 lds
  v_mfma_f32_16x16x32_bf16 v[40:43], v[56:59], a[160:163], v[40:43]
  v_mfma_f32_16x16x32_bf16 v[44:47], v[60:63], a[160:163], v[44:47]
  s_add_u32 m0, s71, 0
  s_nop 0
  buffer_load_dwordx4 v3, s[32:35], s65 offen offset:2048 sc1 lds
  v_mfma_f32_16x16x32_bf16 v[48:51], v[56:59], a[216:219], v[48:51]
  v_mfma_f32_16x16x32_bf16 v[52:55], v[60:63], a[216:219], v[52:55]
  s_add_u32 m0, s71, 0
  s_nop 0
  buffer_load_dwordx4 v3, s[32:35], s65 offen offset:3072 sc1 lds
  s_waitcnt lgkmcnt(0)
  v_mfma_f32_16x16x32_bf16 v[24:27], v[64:67], a[52:55], v[24:27]
  v_mfma_f32_16x16x32_bf16 v[28:31], v[68:71], a[52:55], v[28:31]
  s_add_u32 m0, s71, 4096
  s_nop 0
  buffer_load_dwordx4 v3, s[32:35], s66 offen offset:0 sc1 lds
  v_mfma_f32_16x16x32_bf16 v[32:35], v[64:67], a[108:111], v[32:35]
  v_mfma_f32_16x16x32_bf16 v[36:39], v[68:71], a[108:111], v[36:39]
  s_add_u32 m0, s71, 4096
  s_nop 0
  buffer_load_dwordx4 v3, s[32:35], s66 offen offset:1024 sc1 lds
  v_mfma_f32_16x16x32_bf16 v[40:43], v[64:67], a[164:167], v[40:43]
  v_mfma_f32_16x16x32_bf16 v[44:47], v[68:71], a[164:167], v[44:47]
  s_add_u32 m0, s71, 4096
  s_nop 0
  buffer_load_dwordx4 v3, s[32:35], s66 offen offset:2048 sc1 lds
  v_mfma_f32_16x16x32_bf16 v[48:51], v[64:67], a[220:223], v[48:51]
  v_mfma_f32_16x16x32_bf16 v[52:55], v[68:71], a[220:223], v[52:55]
  ds_write_b32 v15, v148 offset:0
  ds_write_b32 v15, v149 offset:128
  ds_write_b32 v15, v152 offset:64
  ds_write_b32 v15, v153 offset:192
  ds_read_b128 v[128:131], v16 offset:0
  ds_read_b128 v[132:135], v16 offset:128
  ds_read_b128 v[136:139], v16 offset:64
  ds_read_b128 v[140:143], v16 offset:192
  v_add_f32 v21, v24, v25
  v_add_f32 v22, v26, v27
  v_add_f32 v21, v21, v28
  v_add_f32 v22, v22, v29
  v_add_f32 v21, v21, v30
  v_add_f32 v22, v22, v31
  v_cmp_u_f32 vcc, v21, v22
  s_cbranch_vccnz redo_187
cont_189:
  s_cmp_lg_u32 s48, 3
  s_cbranch_scc1 nn_190
  ds_read_b128 v[156:159], v23
  v_cndmask_b32 v148, v148, v152, s[72:73]
  v_cndmask_b32 v149, v149, v153, s[72:73]
  s_waitcnt lgkmcnt(0)
  v_lshlrev_b32 v160, 16, v156
  v_and_b32 v161, 0xffff0000, v156
  v_lshlrev_b32 v162, 16, v157
  v_and_b32 v163, 0xffff0000, v157
  v_lshlrev_b32 v164, 16, v158
  v_and_b32 v165, 0xffff0000, v158
  v_lshlrev_b32 v166, 16, v159
  v_and_b32 v167, 0xffff0000, v159
  v_fma_f32 v160, v160, v148, v149
  v_fma_f32 v161, v161, v148, v149
  v_fma_f32 v162, v162, v148, v149
  v_fma_f32 v163, v163, v148, v149
  v_fma_f32 v164, v164, v148, v149
  v_fma_f32 v165, v165, v148, v149
  v_fma_f32 v166, v166, v148, v149
  v_fma_f32 v167, v167, v148, v149
  v_cvt_pk_bf16_f32 v144, v160, v161
  v_cvt_pk_bf16_f32 v145, v162, v163
  v_cvt_pk_bf16_f32 v146, v164, v165
  v_cvt_pk_bf16_f32 v147, v166, v167
nn_190:
  s_add_u32 s44, s61, 1
  s_and_b32 s44, s44, 7
  s_cmp_eq_u32 s44, 0
  s_cbranch_scc0 ng_191
  v_readfirstlane_b32 s44, v172
  s_nop 0
  s_cmp_eq_u32 s44, 96
  s_cbranch_scc1 ng_191
  buffer_load_dword v172, off, s[32:35], s57 sc1
  s_waitcnt vmcnt(0)
  v_mov_b32 v108, -1
ng_191:
  buffer_store_dwordx4 v[144:147], v18, s[32:35], s64 offen sc1
  s_waitcnt lgkmcnt(0)
  v_pk_mul_f32 v[24:25], v[24:25], v[128:129]
  v_pk_mul_f32 v[26:27], v[26:27], v[130:131]
  v_pk_fma_f32 v[24:25], v[132:133], v[124:125], v[24:25] op_sel_hi:[1,0,1]
  v_pk_fma_f32 v[26:27], v[134:135], v[124:125], v[26:27] op_sel_hi:[1,0,1]
  v_pk_mul_f32 v[28:29], v[28:29], v[136:137]
  v_pk_mul_f32 v[30:31], v[30:31], v[138:139]
  v_pk_fma_f32 v[28:29], v[140:141], v[124:125], v[28:29] op_sel_hi:[1,0,1]
  v_pk_fma_f32 v[30:31], v[142:143], v[124:125], v[30:31] op_sel_hi:[1,0,1]
  v_cvt_pk_bf16_f32 v24, v24, v25
  v_cvt_pk_bf16_f32 v25, v26, v27
  v_cvt_pk_bf16_f32 v26, v28, v29
  v_cvt_pk_bf16_f32 v27, v30, v31
  buffer_store_dwordx4 v[24:27], v5, s[32:35], s62 offen offset:0 sc1
  v_pk_mul_f32 v[32:33], v[32:33], v[128:129]
  v_pk_mul_f32 v[34:35], v[34:35], v[130:131]
  v_pk_fma_f32 v[32:33], v[132:133], v[124:125], v[32:33] op_sel:[0,1,0] op_sel_hi:[1,1,1]
  v_pk_fma_f32 v[34:35], v[134:135], v[124:125], v[34:35] op_sel:[0,1,0] op_sel_hi:[1,1,1]
  v_pk_mul_f32 v[36:37], v[36:37], v[136:137]
  v_pk_mul_f32 v[38:39], v[38:39], v[138:139]
  v_pk_fma_f32 v[36:37], v[140:141], v[124:125], v[36:37] op_sel:[0,1,0] op_sel_hi:[1,1,1]
  v_pk_fma_f32 v[38:39], v[142:143], v[124:125], v[38:39] op_sel:[0,1,0] op_sel_hi:[1,1,1]
  v_cvt_pk_bf16_f32 v32, v32, v33
  v_cvt_pk_bf16_f32 v33, v34, v35
  v_cvt_pk_bf16_f32 v34, v36, v37
  v_cvt_pk_bf16_f32 v35, v38, v39
  buffer_store_dwordx4 v[32:35], v5, s[32:35], s62 offen offset:1024 sc1
  v_pk_mul_f32 v[40:41], v[40:41], v[128:129]
  v_pk_mul_f32 v[42:43], v[42:43], v[130:131]
  v_pk_fma_f32 v[40:41], v[132:133], v[126:127], v[40:41] op_sel_hi:[1,0,1]
  v_pk_fma_f32 v[42:43], v[134:135], v[126:127], v[42:43] op_sel_hi:[1,0,1]
  v_pk_mul_f32 v[44:45], v[44:45], v[136:137]
  v_pk_mul_f32 v[46:47], v[46:47], v[138:139]
  v_pk_fma_f32 v[44:45], v[140:141], v[126:127], v[44:45] op_sel_hi:[1,0,1]
  v_pk_fma_f32 v[46:47], v[142:143], v[126:127], v[46:47] op_sel_hi:[1,0,1]
  v_cvt_pk_bf16_f32 v40, v40, v41
  v_cvt_pk_bf16_f32 v41, v42, v43
  v_cvt_pk_bf16_f32 v42, v44, v45
  v_cvt_pk_bf16_f32 v43, v46, v47
  buffer_store_dwordx4 v[40:43], v5, s[32:35], s62 offen offset:2048 sc1
  v_pk_mul_f32 v[48:49], v[48:49], v[128:129]
  v_pk_mul_f32 v[50:51], v[50:51], v[130:131]
  v_pk_fma_f32 v[48:49], v[132:133], v[126:127], v[48:49] op_sel:[0,1,0] op_sel_hi:[1,1,1]
  v_pk_fma_f32 v[50:51], v[134:135], v[126:127], v[50:51] op_sel:[0,1,0] op_sel_hi:[1,1,1]
  v_pk_mul_f32 v[52:53], v[52:53], v[136:137]
  v_pk_mul_f32 v[54:55], v[54:55], v[138:139]
  v_pk_fma_f32 v[52:53], v[140:141], v[126:127], v[52:53] op_sel:[0,1,0] op_sel_hi:[1,1,1]
  v_pk_fma_f32 v[54:55], v[142:143], v[126:127], v[54:55] op_sel:[0,1,0] op_sel_hi:[1,1,1]
  v_cvt_pk_bf16_f32 v48, v48, v49
  v_cvt_pk_bf16_f32 v49, v50, v51
  v_cvt_pk_bf16_f32 v50, v52, v53
  v_cvt_pk_bf16_f32 v51, v54, v55
  buffer_store_dwordx4 v[48:51], v5, s[32:35], s62 offen offset:3072 sc1
  v_xor_b32 v4, 0x8000, v4
  v_xor_b32 v20, 0x8000, v20
  v_xor_b32 v23, 0x8000, v23
  s_mov_b32 s68, s63
  s_mov_b32 s69, s70
  s_add_u32 s62, s62, 458752
  s_add_u32 s63, s63, 3584
  s_add_u32 s70, s70, 3584
  s_add_u32 s64, s64, 28672
  s_add_u32 s61, s61, 1
  s_cmp_lt_u32 s61, 64
  s_cbranch_scc1 u1_178
  s_waitcnt vmcnt(0)
  buffer_store_dword v7, v6, s[32:35], s68 offen sc1
  buffer_store_dword v7, v19, s[32:35], s69 offen sc1
  s_mov_b32 s68, 1073741824
  s_mov_b32 s69, 1073741824
  s_endpgm
redo_187:
  s_waitcnt vmcnt(0) lgkmcnt(0)
  s_barrier
  s_add_u32 s47, s74, 4096
  s_mov_b32 s52, 60000
poll_192:
  buffer_load_dwordx4 v[80:83], v3, s[32:35], s74 offen offset:0 sc1
  buffer_load_dwordx4 v[84:87], v3, s[32:35], s74 offen offset:1024 sc1
  buffer_load_dwordx4 v[88:91], v3, s[32:35], s74 offen offset:2048 sc1
  buffer_load_dwordx4 v[92:95], v3, s[32:35], s74 offen offset:3072 sc1
  buffer_load_dwordx4 v[96:99], v3, s[32:35], s47 offen offset:0 sc1
  buffer_load_dwordx4 v[100:103], v3, s[32:35], s47 offen offset:1024 sc1
  buffer_load_dwordx4 v[104:107], v3, s[32:35], s47 offen offset:2048 sc1
  s_waitcnt vmcnt(0)
  v_max3_u32 v21, v80, v81, v82
  v_max3_u32 v21, v21, v83, v84
  v_max3_u32 v21, v21, v85, v86
  v_max3_u32 v21, v21, v87, v88
  v_max3_u32 v21, v21, v89, v90
  v_max3_u32 v21, v21, v91, v92
  v_max3_u32 v21, v21, v93, v94
  v_max3_u32 v21, v21, v95, v96
  v_max3_u32 v21, v21, v97, v98
  v_max3_u32 v21, v21, v99, v100
  v_max3_u32 v21, v21, v101, v102
  v_max3_u32 v21, v21, v103, v104
  v_max3_u32 v21, v21, v105, v106
  v_max_u32 v21, v21, v107
  v_cmp_eq_u32 vcc, -1, v21
  s_cbranch_vccz pok_193
  s_sleep 2
  s_sub_u32 s52, s52, 1
  s_cbranch_scc0 poll_192
  s_mov_b32 s54, 43
  s_branch k1_fail
pok_193:
  ds_write_b128 v4, v[80:83] offset:0
  ds_write_b128 v4, v[84:87] offset:1024
  ds_write_b128 v4, v[88:91] offset:2048
  ds_write_b128 v4, v[92:95] offset:3072
  ds_write_b128 v4, v[96:99] offset:4096
  ds_write_b128 v4, v[100:103] offset:5120
  ds_write_b128 v4, v[104:107] offset:6144
  s_waitcnt lgkmcnt(0)
  s_barrier
  s_mov_b32 s75, 1
  s_branch again_188
again_188:
  ds_read_b128 v[56:59], v20 offset:0
  ds_read_b128 v[60:63], v20 offset:14336
  ds_read_b128 v[64:67], v20 offset:1024
  ds_read_b128 v[68:71], v20 offset:15360
  s_waitcnt lgkmcnt(2)
  v_mfma_f32_16x16x32_bf16 v[24:27], v[56:59], a[0:3], 0
  ds_read_b128 v[72:75], v20 offset:2048
  v_mfma_f32_16x16x32_bf16 v[28:31], v[60:63], a[0:3], 0
  ds_read_b128 v[76:79], v20 offset:16384
  v_mfma_f32_16x16x32_bf16 v[32:35], v[56:59], a[56:59], 0
  v_mfma_f32_16x16x32_bf16 v[36:39], v[60:63], a[56:59], 0
  v_mfma_f32_16x16x32_bf16 v[40:43], v[56:59], a[112:115], 0
  v_mfma_f32_16x16x32_bf16 v[44:47], v[60:63], a[112:115], 0
  v_mfma_f32_16x16x32_bf16 v[48:51], v[56:59], a[168:171], 0
  v_mfma_f32_16x16x32_bf16 v[52:55], v[60:63], a[168:171], 0
  s_waitcnt lgkmcnt(2)
  v_mfma_f32_16x16x32_bf16 v[24:27], v[64:67], a[4:7], v[24:27]
  ds_read_b128 v[56:59], v20 offset:3072
  v_mfma_f32_16x16x32_bf16 v[28:31], v[68:71], a[4:7], v[28:31]
  ds_read_b128 v[60:63], v20 offset:17408
  v_mfma_f32_16x16x32_bf16 v[32:35], v[64:67], a[60:63], v[32:35]
  v_mfma_f32_16x16x32_bf16 v[36:39], v[68:71], a[60:63], v[36:39]
  v_mfma_f32_16x16x32_bf16 v[40:43], v[64:67], a[116:119], v[40:43]
  v_mfma_f32_16x16x32_bf16 v[44:47], v[68:71], a[116:119], v[44:47]
  v_mfma_f32_16x16x32_bf16 v[48:51], v[64:67], a[172:175], v[48:51]
  v_mfma_f32_16x16x32_bf16 v[52:55], v[68:71], a[172:175], v[52:55]
  s_waitcnt lgkmcnt(2)
  v_mfma_f32_16x16x32_bf16 v[24:27], v[72:75], a[8:11], v[24:27]
  ds_read_b128 v[64:67], v20 offset:4096
  v_mfma_f32_16x16x32_bf16 v[28:31], v[76:79], a[8:11], v[28:31]
  ds_read_b128 v[68:71], v20 offset:18432
  v_mfma_f32_16x16x32_bf16 v[32:35], v[72:75], a[64:67], v[32:35]
  v_mfma_f32_16x16x32_bf16 v[36:39], v[76:79], a[64:67], v[36:39]
  v_mfma_f32_16x16x32_bf16 v[40:43], v[72:75], a[120:123], v[40:43]
  v_mfma_f32_16x16x32_bf16 v[44:47], v[76:79], a[120:123], v[44:47]
  v_mfma_f32_16x16x32_bf16 v[48:51], v[72:75], a[176:179], v[48:51]
  v_mfma_f32_16x16x32_bf16 v[52:55], v[76:79], a[176:179], v[52:55]
  s_waitcnt lgkmcnt(2)
  v_mfma_f32_16x16x32_bf16 v[24:27], v[56:59], a[12:15], v[24:27]
  ds_read_b128 v[72:75], v20 offset:5120
  v_mfma_f32_16x16x32_bf16 v[28:31], v[60:63], a[12:15], v[28:31]
  ds_read_b128 v[76:79], v20 offset:19456
  v_mfma_f32_16x16x32_bf16 v[32:35], v[56:59], a[68:71], v[32:35]
  v_mfma_f32_16x16x32_bf16 v[36:39], v[60:63], a[68:71], v[36:39]
  v_mfma_f32_16x16x32_bf16 v[40:43], v[56:59], a[124:127], v[40:43]
  v_mfma_f32_16x16x32_bf16 v[44:47], v[60:63], a[124:127], v[44:47]
  v_mfma_f32_16x16x32_bf16 v[48:51], v[56:59], a[180:183], v[48:51]
  v_mfma_f32_16x16x32_bf16 v[52:55], v[60:63], a[180:183], v[52:55]
  s_waitcnt lgkmcnt(2)
  v_mfma_f32_16x16x32_bf16 v[24:27], v[64:67], a[16:19], v[24:27]
  ds_read_b128 v[56:59], v20 offset:6144
  v_mfma_f32_16x16x32_bf16 v[28:31], v[68:71], a[16:19], v[28:31]
  ds_read_b128 v[60:63], v20 offset:20480
  v_mfma_f32_16x16x32_bf16 v[32:35], v[64:67], a[72:75], v[32:35]
  v_mfma_f32_16x16x32_bf16 v[36:39], v[68:71], a[72:75], v[36:39]
  v_mfma_f32_16x16x32_bf16 v[40:43], v[64:67], a[128:131], v[40:43]
  v_mfma_f32_16x16x32_bf16 v[44:47], v[68:71], a[128:131], v[44:47]
  v_mfma_f32_16x16x32_bf16 v[48:51], v[64:67], a[184:187], v[48:51]
  v_mfma_f32_16x16x32_bf16 v[52:55], v[68:71], a[184:187], v[52:55]
  s_waitcnt lgkmcnt(2)
  v_mfma_f32_16x16x32_bf16 v[24:27], v[72:75], a[20:23], v[24:27]
  ds_read_b128 v[64:67], v20 offset:7168
  v_mfma_f32_16x16x32_bf16 v[28:31], v[76:79], a[20:23], v[28:31]
  ds_read_b128 v[68:71], v20 offset:21504
  v_mfma_f32_16x16x32_bf16 v[32:35], v[72:75], a[76:79], v[32:35]
  v_mfma_f32_16x16x32_bf16 v[36:39], v[76:79], a[76:79], v[36:39]
  v_mfma_f32_16x16x32_bf16 v[40:43], v[72:75], a[132:135], v[40:43]
  v_mfma_f32_16x16x32_bf16 v[44:47], v[76:79], a[132:135], v[44:47]
  v_mfma_f32_16x16x32_bf16 v[48:51], v[72:75], a[188:191], v[48:51]
  v_mfma_f32_16x16x32_bf16 v[52:55], v[76:79], a[188:191], v[52:55]
  s_waitcnt lgkmcnt(2)
  v_mfma_f32_16x16x32_bf16 v[24:27], v[56:59], a[24:27], v[24:27]
  ds_read_b128 v[72:75], v20 offset:8192
  v_mfma_f32_16x16x32_bf16 v[28:31], v[60:63], a[24:27], v[28:31]
  ds_read_b128 v[76:79], v20 offset:22528
  v_mfma_f32_16x16x32_bf16 v[32:35], v[56:59], a[80:83], v[32:35]
  v_mfma_f32_16x16x32_bf16 v[36:39], v[60:63], a[80:83], v[36:39]
  v_mfma_f32_16x16x32_bf16 v[40:43], v[56:59], a[136:139], v[40:43]
  v_mfma_f32_16x16x32_bf16 v[44:47], v[60:63], a[136:139], v[44:47]
  v_mfma_f32_16x16x32_bf16 v[48:51], v[56:59], a[192:195], v[48:51]
  v_mfma_f32_16x16x32_bf16 v[52:55], v[60:63], a[192:195], v[52:55]
  s_waitcnt lgkmcnt(2)
  v_mfma_f32_16x16x32_bf16 v[24:27], v[64:67], a[28:31], v[24:27]
  ds_read_b128 v[56:59], v20 offset:9216
  v_mfma_f32_16x16x32_bf16 v[28:31], v[68:71], a[28:31], v[28:31]
  ds_read_b128 v[60:63], v20 offset:23552
  v_mfma_f32_16x16x32_bf16 v[32:35], v[64:67], a[84:87], v[32:35]
  v_mfma_f32_16x16x32_bf16 v[36:39], v[68:71], a[84:87], v[36:39]
  v_mfma_f32_16x16x32_bf16 v[40:43], v[64:67], a[140:143], v[40:43]
  v_mfma_f32_16x16x32_bf16 v[44:47], v[68:71], a[140:143], v[44:47]
  v_mfma_f32_16x16x32_bf16 v[48:51], v[64:67], a[196:199], v[48:51]
  v_mfma_f32_16x16x32_bf16 v[52:55], v[68:71], a[196:199], v[52:55]
  s_waitcnt lgkmcnt(2)
  v_mfma_f32_16x16x32_bf16 v[24:27], v[72:75], a[32:35], v[24:27]
  ds_read_b128 v[64:67], v20 offset:10240
  v_mfma_f32_16x16x32_bf16 v[28:31], v[76:79], a[32:35], v[28:31]
  ds_read_b128 v[68:71], v20 offset:24576
  v_mfma_f32_16x16x32_bf16 v[32:35], v[72:75], a[88:91], v[32:35]
  v_mfma_f32_16x16x32_bf16 v[36:39], v[76:79], a[88:91], v[36:39]
  v_mfma_f32_16x16x32_bf16 v[40:43], v[72:75], a[144:147], v[40:43]
  v_mfma_f32_16x16x32_bf16 v[44:47], v[76:79], a[144:147], v[44:47]
  v_mfma_f32_16x16x32_bf16 v[48:51], v[72:75], a[200:203], v[48:51]
  v_mfma_f32_16x16x32_bf16 v[52:55], v[76:79], a[200:203], v[52:55]
  s_waitcnt lgkmcnt(2)
  v_mfma_f32_16x16x32_bf16 v[24:27], v[56:59], a[36:39], v[24:27]
  ds_read_b128 v[72:75], v20 offset:11264
  v_mfma_f32_16x16x32_bf16 v[28:31], v[60:63], a[36:39], v[28:31]
  ds_read_b128 v[76:79], v20 offset:25600
  v_mfma_f32_16x16x32_bf16 v[32:35], v[56:59], a[92:95], v[32:35]
  v_mfma_f32_16x16x32_bf16 v[36:39], v[60:63], a[92:95], v[36:39]
  v_mfma_f32_16x16x32_bf16 v[40:43], v[56:59], a[148:151], v[40:43]
  v_mfma_f32_16x16x32_bf16 v[44:47], v[60:63], a[148:151], v[44:47]
  v_mfma_f32_16x16x32_bf16 v[48:51], v[56:59], a[204:207], v[48:51]
  v_mfma_f32_16x16x32_bf16 v[52:55], v[60:63], a[204:207], v[52:55]
  s_waitcnt lgkmcnt(2)
  v_mfma_f32_16x16x32_bf16 v[24:27], v[64:67], a[40:43], v[24:27]
  ds_read_b128 v[56:59], v20 offset:12288
  v_mfma_f32_16x16x32_bf16 v[28:31], v[68:71], a[40:43], v[28:31]
  ds_read_b128 v[60:63], v20 offset:26624
  v_mfma_f32_16x16x32_bf16 v[32:35], v[64:67], a[96:99], v[32:35]
  v_mfma_f32_16x16x32_bf16 v[36:39], v[68:71], a[96:99], v[36:39]
  v_mfma_f32_16x16x32_bf16 v[40:43], v[64:67], a[152:155], v[40:43]
  v_mfma_f32_16x16x32_bf16 v[44:47], v[68:71], a[152:155], v[44:47]
  v_mfma_f32_16x16x32_bf16 v[48:51], v[64:67], a[208:211], v[48:51]
  v_mfma_f32_16x16x32_bf16 v[52:55], v[68:71], a[208:211], v[52:55]
  s_waitcnt lgkmcnt(2)
  v_mfma_f32_16x16x32_bf16 v[24:27], v[72:75], a[44:47], v[24:27]
  ds_read_b128 v[64:67], v20 offset:13312
  v_mfma_f32_16x16x32_bf16 v[28:31], v[76:79], a[44:47], v[28:31]
  ds_read_b128 v[68:71], v20 offset:27648
  v_mfma_f32_16x16x32_bf16 v[32:35], v[72:75], a[100:103], v[32:35]
  v_mfma_f32_16x16x32_bf16 v[36:39], v[76:79], a[100:103], v[36:39]
  v_mfma_f32_16x16x32_bf16 v[40:43], v[72:75], a[156:159], v[40:43]
  v_mfma_f32_16x16x32_bf16 v[44:47], v[76:79], a[156:159], v[44:47]
  v_mfma_f32_16x16x32_bf16 v[48:51], v[72:75], a[212:215], v[48:51]
  v_mfma_f32_16x16x32_bf16 v[52:55], v[76:79], a[212:215], v[52:55]
  s_waitcnt lgkmcnt(2)
  v_mfma_f32_16x16x32_bf16 v[24:27], v[56:59], a[48:51], v[24:27]
  v_mfma_f32_16x16x32_bf16 v[28:31], v[60:63], a[48:51], v[28:31]
  v_mfma_f32_16x16x32_bf16 v[32:35], v[56:59], a[104:107], v[32:35]
  v_mfma_f32_16x16x32_bf16 v[36:39], v[60:63], a[104:107], v[36:39]
  v_mfma_f32_16x16x32_bf16 v[40:43], v[56:59], a[160:163], v[40:43]
  v_mfma_f32_16x16x32_bf16 v[44:47], v[60:63], a[160:163], v[44:47]
  v_mfma_f32_16x16x32_bf16 v[48:51], v[56:59], a[216:219], v[48:51]
  v_mfma_f32_16x16x32_bf16 v[52:55], v[60:63], a[216:219], v[52:55]
  s_waitcnt lgkmcnt(0)
  v_mfma_f32_16x16x32_bf16 v[24:27], v[64:67], a[52:55], v[24:27]
  v_mfma_f32_16x16x32_bf16 v[28:31], v[68:71], a[52:55], v[28:31]
  v_mfma_f32_16x16x32_bf16 v[32:35], v[64:67], a[108:111], v[32:35]
  v_mfma_f32_16x16x32_bf16 v[36:39], v[68:71], a[108:111], v[36:39]
  v_mfma_f32_16x16x32_bf16 v[40:43], v[64:67], a[164:167], v[40:43]
  v_mfma_f32_16x16x32_bf16 v[44:47], v[68:71], a[164:167], v[44:47]
  v_mfma_f32_16x16x32_bf16 v[48:51], v[64:67], a[220:223], v[48:51]
  v_mfma_f32_16x16x32_bf16 v[52:55], v[68:71], a[220:223], v[52:55]
  s_branch cont_189
r_F:
  s_cmp_ge_u32 s50, 21
  s_cbranch_scc1 r_O
  s_cmp_ge_u32 s50, 14
  s_cbranch_scc1 r_F2
  s_mov_b32 s40, s20
  s_and_b32 s41, s21, 0xffff
  s_mov_b32 s42, 1605632
  s_mov_b32 s43, 0x20000
  s_lshl_b32 s44, s50, 2
  s_add_u32 s44, s44, s48
  s_lshl_b32 s44, s44, 6
  v_lshrrev_b32 v8, 2, v1
  v_mul_u32_u24 v8, 3584, v8
  v_and_b32 v9, 3, v1
  v_lshl_add_u32 v8, v9, 4, v8
  s_mul_i32 s46, s48, 28672
  s_add_u32 m0, s46, 0
  s_nop 0
  buffer_load_dwordx4 v8, s[40:43], s44 offen lds
  s_add_u32 s44, s44, 57344
  s_add_u32 m0, s46, 1024
  s_nop 0
  buffer_load_dwordx4 v8, s[40:43], s44 offen lds
  s_add_u32 s44, s44, 57344
  s_add_u32 m0, s46, 2048
  s_nop 0
  buffer_load_dwordx4 v8, s[40:43], s44 offen lds
  s_add_u32 s44, s44, 57344
  s_add_u32 m0, s46, 3072
  s_nop 0
  buffer_load_dwordx4 v8, s[40:43], s44 offen lds
  s_add_u32 s44, s44, 57344
  s_add_u32 m0, s46, 4096
  s_nop 0
  buffer_load_dwordx4 v8, s[40:43], s44 offen lds
  s_add_u32 s44, s44, 57344
  s_add_u32 m0, s46, 5120
  s_nop 0
  buffer_load_dwordx4 v8, s[40:43], s44 offen lds
  s_add_u32 s44, s44, 57344
  s_add_u32 m0, s46, 6144
  s_nop 0
  buffer_load_dwordx4 v8, s[40:43], s44 offen lds
  s_add_u32 s44, s44, 57344
  s_add_u32 m0, s46, 7168
  s_nop 0
  buffer_load_dwordx4 v8, s[40:43], s44 offen lds
  s_add_u32 s44, s44, 57344
  s_add_u32 m0, s46, 8192
  s_nop 0
  buffer_load_dwordx4 v8, s[40:43], s44 offen lds
  s_add_u32 s44, s44, 57344
  s_add_u32 m0, s46, 9216
  s_nop 0
  buffer_load_dwordx4 v8, s[40:43], s44 offen lds
  s_add_u32 s44, s44, 57344
  s_add_u32 m0, s46, 10240
  s_nop 0
  buffer_load_dwordx4 v8, s[40:43], s44 offen lds
  s_add_u32 s44, s44, 57344
  s_add_u32 m0, s46, 11264
  s_nop 0
  buffer_load_dwordx4 v8, s[40:43], s44 offen lds
  s_add_u32 s44, s44, 57344
  s_add_u32 m0, s46, 12288
  s_nop 0
  buffer_load_dwordx4 v8, s[40:43], s44 offen lds
  s_add_u32 s44, s44, 57344
  s_add_u32 m0, s46, 13312
  s_nop 0
  buffer_load_dwordx4 v8, s[40:43], s44 offen lds
  s_add_u32 s44, s44, 57344
  s_add_u32 m0, s46, 14336
  s_nop 0
  buffer_load_dwordx4 v8, s[40:43], s44 offen lds
  s_add_u32 s44, s44, 57344
  s_add_u32 m0, s46, 15360
  s_nop 0
  buffer_load_dwordx4 v8, s[40:43], s44 offen lds
  s_add_u32 s44, s44, 57344
  s_add_u32 m0, s46, 16384
  s_nop 0
  buffer_load_dwordx4 v8, s[40:43], s44 offen lds
  s_add_u32 s44, s44, 57344
  s_add_u32 m0, s46, 17408
  s_nop 0
  buffer_load_dwordx4 v8, s[40:43], s44 offen lds
  s_add_u32 s44, s44, 57344
  s_add_u32 m0, s46, 18432
  s_nop 0
  buffer_load_dwordx4 v8, s[40:43], s44 offen lds
  s_add_u32 s44, s44, 57344
  s_add_u32 m0, s46, 19456
  s_nop 0
  buffer_load_dwordx4 v8, s[40:43], s44 offen lds
  s_add_u32 s44, s44, 57344
  s_add_u32 m0, s46, 20480
  s_nop 0
  buffer_load_dwordx4 v8, s[40:43], s44 offen lds
  s_add_u32 s44, s44, 57344
  s_add_u32 m0, s46, 21504
  s_nop 0
  buffer_load_dwordx4 v8, s[40:43], s44 offen lds
  s_add_u32 s44, s44, 57344
  s_add_u32 m0, s46, 22528
  s_nop 0
  buffer_load_dwordx4 v8, s[40:43], s44 offen lds
  s_add_u32 s44, s44, 57344
  s_add_u32 m0, s46, 23552
  s_nop 0
  buffer_load_dwordx4 v8, s[40:43], s44 offen lds
  s_add_u32 s44, s44, 57344
  s_add_u32 m0, s46, 24576
  s_nop 0
  buffer_load_dwordx4 v8, s[40:43], s44 offen lds
  s_add_u32 s44, s44, 57344
  s_add_u32 m0, s46, 25600
  s_nop 0
  buffer_load_dwordx4 v8, s[40:43], s44 offen lds
  s_add_u32 s44, s44, 57344
  s_add_u32 m0, s46, 26624
  s_nop 0
  buffer_load_dwordx4 v8, s[40:43], s44 offen lds
  s_add_u32 s44, s44, 57344
  s_add_u32 m0, s46, 27648
  s_nop 0
  buffer_load_dwordx4 v8, s[40:43], s44 offen lds
  s_add_u32 s44, s44, 57344
  v_lshrrev_b32 v8, 4, v1
  v_lshlrev_b32 v8, 3, v8
  v_bfe_u32 v10, v1, 2, 2
  v_add_u32 v8, v8, v10
  v_lshlrev_b32 v8, 6, v8
  v_lshl_add_u32 v8, v9, 4, v8
  v_add_u32 v8, s46, v8
  s_waitcnt vmcnt(0)
  ds_read_b64_tr_b16 a[0:1], v8 offset:0
  ds_read_b64_tr_b16 a[2:3], v8 offset:256
  ds_read_b64_tr_b16 a[56:57], v8 offset:8
  ds_read_b64_tr_b16 a[58:59], v8 offset:264
  ds_read_b64_tr_b16 a[4:5], v8 offset:2048
  ds_read_b64_tr_b16 a[6:7], v8 offset:2304
  ds_read_b64_tr_b16 a[60:61], v8 offset:2056
  ds_read_b64_tr_b16 a[62:63], v8 offset:2312
  ds_read_b64_tr_b16 a[8:9], v8 offset:4096
  ds_read_b64_tr_b16 a[10:11], v8 offset:4352
  ds_read_b64_tr_b16 a[64:65], v8 offset:4104
  ds_read_b64_tr_b16 a[66:67], v8 offset:4360
  s_waitcnt lgkmcnt(0)
  ds_read_b64_tr_b16 a[12:13], v8 offset:6144
  ds_read_b64_tr_b16 a[14:15], v8 offset:6400
  ds_read_b64_tr_b16 a[68:69], v8 offset:6152
  ds_read_b64_tr_b16 a[70:71], v8 offset:6408
  ds_read_b64_tr_b16 a[16:17], v8 offset:8192
  ds_read_b64_tr_b16 a[18:19], v8 offset:8448
  ds_read_b64_tr_b16 a[72:73], v8 offset:8200
  ds_read_b64_tr_b16 a[74:75], v8 offset:8456
  ds_read_b64_tr_b16 a[20:21], v8 offset:10240
  ds_read_b64_tr_b16 a[22:23], v8 offset:10496
  ds_read_b64_tr_b16 a[76:77], v8 offset:10248
  ds_read_b64_tr_b16 a[78:79], v8 offset:10504
  s_waitcnt lgkmcnt(0)
  ds_read_b64_tr_b16 a[24:25], v8 offset:12288
  ds_read_b64_tr_b16 a[26:27], v8 offset:12544
  ds_read_b64_tr_b16 a[80:81], v8 offset:12296
  ds_read_b64_tr_b16 a[82:83], v8 offset:12552
  ds_read_b64_tr_b16 a[28:29], v8 offset:14336
  ds_read_b64_tr_b16 a[30:31], v8 offset:14592
  ds_read_b64_tr_b16 a[84:85], v8 offset:14344
  ds_read_b64_tr_b16 a[86:87], v8 offset:14600
  ds_read_b64_tr_b16 a[32:33], v8 offset:16384
  ds_read_b64_tr_b16 a[34:35], v8 offset:16640
  ds_read_b64_tr_b16 a[88:89], v8 offset:16392
  ds_read_b64_tr_b16 a[90:91], v8 offset:16648
  s_waitcnt lgkmcnt(0)
  ds_read_b64_tr_b16 a[36:37], v8 offset:18432
  ds_read_b64_tr_b16 a[38:39], v8 offset:18688
  ds_read_b64_tr_b16 a[92:93], v8 offset:18440
  ds_read_b64_tr_b16 a[94:95], v8 offset:18696
  ds_read_b64_tr_b16 a[40:41], v8 offset:20480
  ds_read_b64_tr_b16 a[42:43], v8 offset:20736
  ds_read_b64_tr_b16 a[96:97], v8 offset:20488
  ds_read_b64_tr_b16 a[98:99], v8 offset:20744
  ds_read_b64_tr_b16 a[44:45], v8 offset:22528
  ds_read_b64_tr_b16 a[46:47], v8 offset:22784
  ds_read_b64_tr_b16 a[100:101], v8 offset:22536
  ds_read_b64_tr_b16 a[102:103], v8 offset:22792
  s_waitcnt lgkmcnt(0)
  ds_read_b64_tr_b16 a[48:49], v8 offset:24576
  ds_read_b64_tr_b16 a[50:51], v8 offset:24832
  ds_read_b64_tr_b16 a[104:105], v8 offset:24584
  ds_read_b64_tr_b16 a[106:107], v8 offset:24840
  ds_read_b64_tr_b16 a[52:53], v8 offset:26624
  ds_read_b64_tr_b16 a[54:55], v8 offset:26880
  ds_read_b64_tr_b16 a[108:109], v8 offset:26632
  ds_read_b64_tr_b16 a[110:111], v8 offset:26888
  s_waitcnt lgkmcnt(0)
  s_mov_b32 s40, s22
  s_and_b32 s41, s23, 0xffff
  s_mov_b32 s42, 1605632
  s_mov_b32 s43, 0x20000
  s_lshl_b32 s44, s50, 2
  s_add_u32 s44, s44, s48
  s_lshl_b32 s44, s44, 6
  v_lshrrev_b32 v8, 2, v1
  v_mul_u32_u24 v8, 3584, v8
  v_and_b32 v9, 3, v1
  v_lshl_add_u32 v8, v9, 4, v8
  s_mul_i32 s46, s48, 28672
  s_add_u32 m0, s46, 0
  s_nop 0
  buffer_load_dwordx4 v8, s[40:43], s44 offen lds
  s_add_u32 s44, s44, 57344
  s_add_u32 m0, s46, 1024
  s_nop 0
  buffer_load_dwordx4 v8, s[40:43], s44 offen lds
  s_add_u32 s44, s44, 57344
  s_add_u32 m0, s46, 2048
  s_nop 0
  buffer_load_dwordx4 v8, s[40:43], s44 offen lds
  s_add_u32 s44, s44, 57344
  s_add_u32 m0, s46, 3072
  s_nop 0
  buffer_load_dwordx4 v8, s[40:43], s44 offen lds
  s_add_u32 s44, s44, 57344
  s_add_u32 m0, s46, 4096
  s_nop 0
  buffer_load_dwordx4 v8, s[40:43], s44 offen lds
  s_add_u32 s44, s44, 57344
  s_add_u32 m0, s46, 5120
  s_nop 0
  buffer_load_dwordx4 v8, s[40:43], s44 offen lds
  s_add_u32 s44, s44, 57344
  s_add_u32 m0, s46, 6144
  s_nop 0
  buffer_load_dwordx4 v8, s[40:43], s44 offen lds
  s_add_u32 s44, s44, 57344
  s_add_u32 m0, s46, 7168
  s_nop 0
  buffer_load_dwordx4 v8, s[40:43], s44 offen lds
  s_add_u32 s44, s44, 57344
  s_add_u32 m0, s46, 8192
  s_nop 0
  buffer_load_dwordx4 v8, s[40:43], s44 offen lds
  s_add_u32 s44, s44, 57344
  s_add_u32 m0, s46, 9216
  s_nop 0
  buffer_load_dwordx4 v8, s[40:43], s44 offen lds
  s_add_u32 s44, s44, 57344
  s_add_u32 m0, s46, 10240
  s_nop 0
  buffer_load_dwordx4 v8, s[40:43], s44 offen lds
  s_add_u32 s44, s44, 57344
  s_add_u32 m0, s46, 11264
  s_nop 0
  buffer_load_dwordx4 v8, s[40:43], s44 offen lds
  s_add_u32 s44, s44, 57344
  s_add_u32 m0, s46, 12288
  s_nop 0
  buffer_load_dwordx4 v8, s[40:43], s44 offen lds
  s_add_u32 s44, s44, 57344
  s_add_u32 m0, s46, 13312
  s_nop 0
  buffer_load_dwordx4 v8, s[40:43], s44 offen lds
  s_add_u32 s44, s44, 57344
  s_add_u32 m0, s46, 14336
  s_nop 0
  buffer_load_dwordx4 v8, s[40:43], s44 offen lds
  s_add_u32 s44, s44, 57344
  s_add_u32 m0, s46, 15360
  s_nop 0
  buffer_load_dwordx4 v8, s[40:43], s44 offen lds
  s_add_u32 s44, s44, 57344
  s_add_u32 m0, s46, 16384
  s_nop 0
  buffer_load_dwordx4 v8, s[40:43], s44 offen lds
  s_add_u32 s44, s44, 57344
  s_add_u32 m0, s46, 17408
  s_nop 0
  buffer_load_dwordx4 v8, s[40:43], s44 offen lds
  s_add_u32 s44, s44, 57344
  s_add_u32 m0, s46, 18432
  s_nop 0
  buffer_load_dwordx4 v8, s[40:43], s44 offen lds
  s_add_u32 s44, s44, 57344
  s_add_u32 m0, s46, 19456
  s_nop 0
  buffer_load_dwordx4 v8, s[40:43], s44 offen lds
  s_add_u32 s44, s44, 57344
  s_add_u32 m0, s46, 20480
  s_nop 0
  buffer_load_dwordx4 v8, s[40:43], s44 offen lds
  s_add_u32 s44, s44, 57344
  s_add_u32 m0, s46, 21504
  s_nop 0
  buffer_load_dwordx4 v8, s[40:43], s44 offen lds
  s_add_u32 s44, s44, 57344
  s_add_u32 m0, s46, 22528
  s_nop 0
  buffer_load_dwordx4 v8, s[40:43], s44 offen lds
  s_add_u32 s44, s44, 57344
  s_add_u32 m0, s46, 23552
  s_nop 0
  buffer_load_dwordx4 v8, s[40:43], s44 offen lds
  s_add_u32 s44, s44, 57344
  s_add_u32 m0, s46, 24576
  s_nop 0
  buffer_load_dwordx4 v8, s[40:43], s44 offen lds
  s_add_u32 s44, s44, 57344
  s_add_u32 m0, s46, 25600
  s_nop 0
  buffer_load_dwordx4 v8, s[40:43], s44 offen lds
  s_add_u32 s44, s44, 57344
  s_add_u32 m0, s46, 26624
  s_nop 0
  buffer_load_dwordx4 v8, s[40:43], s44 offen lds
  s_add_u32 s44, s44, 57344
  s_add_u32 m0, s46, 27648
  s_nop 0
  buffer_load_dwordx4 v8, s[40:43], s44 offen lds
  s_add_u32 s44, s44, 57344
  v_lshrrev_b32 v8, 4, v1
  v_lshlrev_b32 v8, 3, v8
  v_bfe_u32 v10, v1, 2, 2
  v_add_u32 v8, v8, v10
  v_lshlrev_b32 v8, 6, v8
  v_lshl_add_u32 v8, v9, 4, v8
  v_add_u32 v8, s46, v8
  s_waitcnt vmcnt(0)
  ds_read_b64_tr_b16 a[112:113], v8 offset:0
  ds_read_b64_tr_b16 a[114:115], v8 offset:256
  ds_read_b64_tr_b16 a[168:169], v8 offset:8
  ds_read_b64_tr_b16 a[170:171], v8 offset:264
  ds_read_b64_tr_b16 a[116:117], v8 offset:2048
  ds_read_b64_tr_b16 a[118:119], v8 offset:2304
  ds_read_b64_tr_b16 a[172:173], v8 offset:2056
  ds_read_b64_tr_b16 a[174:175], v8 offset:2312
  ds_read_b64_tr_b16 a[120:121], v8 offset:4096
  ds_read_b64_tr_b16 a[122:123], v8 offset:4352
  ds_read_b64_tr_b16 a[176:177], v8 offset:4104
  ds_read_b64_tr_b16 a[178:179], v8 offset:4360
  s_waitcnt lgkmcnt(0)
  ds_read_b64_tr_b16 a[124:125], v8 offset:6144
  ds_read_b64_tr_b16 a[126:127], v8 offset:6400
  ds_read_b64_tr_b16 a[180:181], v8 offset:6152
  ds_read_b64_tr_b16 a[182:183], v8 offset:6408
  ds_read_b64_tr_b16 a[128:129], v8 offset:8192
  ds_read_b64_tr_b16 a[130:131], v8 offset:8448
  ds_read_b64_tr_b16 a[184:185], v8 offset:8200
  ds_read_b64_tr_b16 a[186:187], v8 offset:8456
  ds_read_b64_tr_b16 a[132:133], v8 offset:10240
  ds_read_b64_tr_b16 a[134:135], v8 offset:10496
  ds_read_b64_tr_b16 a[188:189], v8 offset:10248
  ds_read_b64_tr_b16 a[190:191], v8 offset:10504
  s_waitcnt lgkmcnt(0)
  ds_read_b64_tr_b16 a[136:137], v8 offset:12288
  ds_read_b64_tr_b16 a[138:139], v8 offset:12544
  ds_read_b64_tr_b16 a[192:193], v8 offset:12296
  ds_read_b64_tr_b16 a[194:195], v8 offset:12552
  ds_read_b64_tr_b16 a[140:141], v8 offset:14336
  ds_read_b64_tr_b16 a[142:143], v8 offset:14592
  ds_read_b64_tr_b16 a[196:197], v8 offset:14344
  ds_read_b64_tr_b16 a[198:199], v8 offset:14600
  ds_read_b64_tr_b16 a[144:145], v8 offset:16384
  ds_read_b64_tr_b16 a[146:147], v8 offset:16640
  ds_read_b64_tr_b16 a[200:201], v8 offset:16392
  ds_read_b64_tr_b16 a[202:203], v8 offset:16648
  s_waitcnt lgkmcnt(0)
  ds_read_b64_tr_b16 a[148:149], v8 offset:18432
  ds_read_b64_tr_b16 a[150:151], v8 offset:18688
  ds_read_b64_tr_b16 a[204:205], v8 offset:18440
  ds_read_b64_tr_b16 a[206:207], v8 offset:18696
  ds_read_b64_tr_b16 a[152:153], v8 offset:20480
  ds_read_b64_tr_b16 a[154:155], v8 offset:20736
  ds_read_b64_tr_b16 a[208:209], v8 offset:20488
  ds_read_b64_tr_b16 a[210:211], v8 offset:20744
  ds_read_b64_tr_b16 a[156:157], v8 offset:22528
  ds_read_b64_tr_b16 a[158:159], v8 offset:22784
  ds_read_b64_tr_b16 a[212:213], v8 offset:22536
  ds_read_b64_tr_b16 a[214:215], v8 offset:22792
  s_waitcnt lgkmcnt(0)
  ds_read_b64_tr_b16 a[160:161], v8 offset:24576
  ds_read_b64_tr_b16 a[162:163], v8 offset:24832
  ds_read_b64_tr_b16 a[216:217], v8 offset:24584
  ds_read_b64_tr_b16 a[218:219], v8 offset:24840
  ds_read_b64_tr_b16 a[164:165], v8 offset:26624
  ds_read_b64_tr_b16 a[166:167], v8 offset:26880
  ds_read_b64_tr_b16 a[220:221], v8 offset:26632
  ds_read_b64_tr_b16 a[222:223], v8 offset:26888
  s_waitcnt lgkmcnt(0)
  s_barrier
  v_and_b32 v9, 15, v1
  v_lshrrev_b32 v10, 4, v1
  s_mul_i32 s45, s48, 7168
  v_add_u32 v3, s45, v2
  v_mov_b32 v5, v3
  v_mov_b32 v20, v2
  s_lshl_b32 s44, s50, 2
  s_add_u32 s44, s44, s48
  s_lshl_b32 s44, s44, 11
  v_add_u32 v4, s44, v2
  v_mov_b32 v15, v5
  s_lshr_b32 s60, s49, 5
  v_and_b32 v6, 15, v1
  v_lshlrev_b32 v6, 7, v6
  s_mov_b32 s56, 124784640
  s_mov_b32 s52, 60000
poll_194:
  buffer_load_dword v5, v6, s[32:35], s56 offen sc1
  s_waitcnt vmcnt(0)
  v_mov_b32 v7, v5
  s_nop 1
  v_add_u32_dpp v7, v7, v7 quad_perm:[1,0,3,2] row_mask:0xf bank_mask:0xf
  s_nop 1
  v_add_u32_dpp v7, v7, v7 quad_perm:[2,3,0,1] row_mask:0xf bank_mask:0xf
  s_nop 1
  v_add_u32_dpp v7, v7, v7 row_half_mirror row_mask:0xf bank_mask:0xf
  s_nop 1
  v_add_u32_dpp v7, v7, v7 row_mirror row_mask:0xf bank_mask:0xf
  v_cmp_ne_u32 vcc, 0x100, v7
  v_readlane_b32 s59, v5, s60
  s_nop 0
  s_cmp_ge_u32 s59, 32
  s_cselect_b32 s53, 1, 0
  s_cselect_b64 vcc, 0, vcc
  s_cbranch_vccz pok_195
  s_sleep 4
  s_sub_u32 s52, s52, 1
  s_cbranch_scc0 poll_194
  s_mov_b32 s54, 53
  s_branch k1_fail
pok_195:
  v_mov_b32 v5, v15
  s_lshr_b32 s44, s48, 1
  s_lshl_b32 s44, s44, 11
  v_lshlrev_b32 v12, 7, v10
  v_lshl_add_u32 v12, v9, 3, v12
  v_add_u32 v12, s44, v12
  v_add_u32 v13, 1536, v12
  v_mov_b32 v11, 1073741824
  v_cmp_gt_u32 vcc, 2, v10
  s_nop 1
  v_cndmask_b32 v13, v11, v13, vcc
  v_mov_b32 v11, 1.0
  v_mov_b32 v14, 0
  v_cndmask_b32 v14, v14, v11, vcc
  s_mov_b32 s59, 0
  s_mov_b32 s57, 124787712
  v_mov_b32 v176, 0
  s_mul_i32 s45, s58, -24576
  s_add_u32 s45, s45, 86016
  s_mul_i32 s44, s48, 7168
  v_lshlrev_b32 v177, 10, v1
  v_add_u32 v177, s44, v177
  v_mov_b32 v178, 1073741824
  v_cmp_gt_u32 vcc, 7, v1
  s_nop 1
  v_cndmask_b32 v177, v178, v177, vcc
  v_subrev_u32 v179, 32, v1
  v_cmp_lt_u32 vcc, 13, v179
  v_mov_b32 v180, 2
  s_nop 0
  v_cndmask_b32 v180, 0, v180, vcc
  v_add_u32 v180, v179, v180
  v_lshlrev_b32 v180, 7, v180
  v_add_u32 v180, s45, v180
  v_cmp_gt_u32 vcc, 28, v179
  s_nop 1
  v_cndmask_b32 v177, v177, v180, vcc
  s_cmp_ge_u32 s48, 2
  s_cselect_b64 s[72:73], -1, 0
  s_cselect_b32 s44, 128, 0
  v_lshlrev_b32 v16, 3, v9
  v_add_u32 v16, 65536, v16
  v_add_u32 v15, s44, v16
  v_mov_b32 v148, 0x3f803f80
  v_mov_b32 v149, 0x3f803f80
  v_mov_b32 v150, 0x3f803f80
  v_mov_b32 v151, 0x3f803f80
  s_waitcnt vmcnt(0)
  s_nop 0
  v_mfma_f32_16x16x32_bf16 v[124:127], a[0:3], v[148:151], 0
  v_mfma_f32_16x16x32_bf16 v[128:131], a[56:59], v[148:151], 0
  v_mfma_f32_16x16x32_bf16 v[132:135], a[112:115], v[148:151], 0
  v_mfma_f32_16x16x32_bf16 v[136:139], a[168:171], v[148:151], 0
  v_mfma_f32_16x16x32_bf16 v[124:127], a[4:7], v[148:151], v[124:127]
  v_mfma_f32_16x16x32_bf16 v[128:131], a[60:63], v[148:151], v[128:131]
  v_mfma_f32_16x16x32_bf16 v[132:135], a[116:119], v[148:151], v[132:135]
  v_mfma_f32_16x16x32_bf16 v[136:139], a[172:175], v[148:151], v[136:139]
  v_mfma_f32_16x16x32_bf16 v[124:127], a[8:11], v[148:151], v[124:127]
  v_mfma_f32_16x16x32_bf16 v[128:131], a[64:67], v[148:151], v[128:131]
  v_mfma_f32_16x16x32_bf16 v[132:135], a[120:123], v[148:151], v[132:135]
  v_mfma_f32_16x16x32_bf16 v[136:139], a[176:179], v[148:151], v[136:139]
  v_mfma_f32_16x16x32_bf16 v[124:127], a[12:15], v[148:151], v[124:127]
  v_mfma_f32_16x16x32_bf16 v[128:131], a[68:71], v[148:151], v[128:131]
  v_mfma_f32_16x16x32_bf16 v[132:135], a[124:127], v[148:151], v[132:135]
  v_mfma_f32_16x16x32_bf16 v[136:139], a[180:183], v[148:151], v[136:139]
  v_mfma_f32_16x16x32_bf16 v[124:127], a[16:19], v[148:151], v[124:127]
  v_mfma_f32_16x16x32_bf16 v[128:131], a[72:75], v[148:151], v[128:131]
  v_mfma_f32_16x16x32_bf16 v[132:135], a[128:131], v[148:151], v[132:135]
  v_mfma_f32_16x16x32_bf16 v[136:139], a[184:187], v[148:151], v[136:139]
  v_mfma_f32_16x16x32_bf16 v[124:127], a[20:23], v[148:151], v[124:127]
  v_mfma_f32_16x16x32_bf16 v[128:131], a[76:79], v[148:151], v[128:131]
  v_mfma_f32_16x16x32_bf16 v[132:135], a[132:135], v[148:151], v[132:135]
  v_mfma_f32_16x16x32_bf16 v[136:139], a[188:191], v[148:151], v[136:139]
  v_mfma_f32_16x16x32_bf16 v[124:127], a[24:27], v[148:151], v[124:127]
  v_mfma_f32_16x16x32_bf16 v[128:131], a[80:83], v[148:151], v[128:131]
  v_mfma_f32_16x16x32_bf16 v[132:135], a[136:139], v[148:151], v[132:135]
  v_mfma_f32_16x16x32_bf16 v[136:139], a[192:195], v[148:151], v[136:139]
  v_mfma_f32_16x16x32_bf16 v[124:127], a[28:31], v[148:151], v[124:127]
  v_mfma_f32_16x16x32_bf16 v[128:131], a[84:87], v[148:151], v[128:131]
  v_mfma_f32_16x16x32_bf16 v[132:135], a[140:143], v[148:151], v[132:135]
  v_mfma_f32_16x16x32_bf16 v[136:139], a[196:199], v[148:151], v[136:139]
  v_mfma_f32_16x16x32_bf16 v[124:127], a[32:35], v[148:151], v[124:127]
  v_mfma_f32_16x16x32_bf16 v[128:131], a[88:91], v[148:151], v[128:131]
  v_mfma_f32_16x16x32_bf16 v[132:135], a[144:147], v[148:151], v[132:135]
  v_mfma_f32_16x16x32_bf16 v[136:139], a[200:203], v[148:151], v[136:139]
  v_mfma_f32_16x16x32_bf16 v[124:127], a[36:39], v[148:151], v[124:127]
  v_mfma_f32_16x16x32_bf16 v[128:131], a[92:95], v[148:151], v[128:131]
  v_mfma_f32_16x16x32_bf16 v[132:135], a[148:151], v[148:151], v[132:135]
  v_mfma_f32_16x16x32_bf16 v[136:139], a[204:207], v[148:151], v[136:139]
  v_mfma_f32_16x16x32_bf16 v[124:127], a[40:43], v[148:151], v[124:127]
  v_mfma_f32_16x16x32_bf16 v[128:131], a[96:99], v[148:151], v[128:131]
  v_mfma_f32_16x16x32_bf16 v[132:135], a[152:155], v[148:151], v[132:135]
  v_mfma_f32_16x16x32_bf16 v[136:139], a[208:211], v[148:151], v[136:139]
  v_mfma_f32_16x16x32_bf16 v[124:127], a[44:47], v[148:151], v[124:127]
  v_mfma_f32_16x16x32_bf16 v[128:131], a[100:103], v[148:151], v[128:131]
  v_mfma_f32_16x16x32_bf16 v[132:135], a[156:159], v[148:151], v[132:135]
  v_mfma_f32_16x16x32_bf16 v[136:139], a[212:215], v[148:151], v[136:139]
  v_mfma_f32_16x16x32_bf16 v[124:127], a[48:51], v[148:151], v[124:127]
  v_mfma_f32_16x16x32_bf16 v[128:131], a[104:107], v[148:151], v[128:131]
  v_mfma_f32_16x16x32_bf16 v[132:135], a[160:163], v[148:151], v[132:135]
  v_mfma_f32_16x16x32_bf16 v[136:139], a[216:219], v[148:151], v[136:139]
  v_mfma_f32_16x16x32_bf16 v[124:127], a[52:55], v[148:151], v[124:127]
  v_mfma_f32_16x16x32_bf16 v[128:131], a[108:111], v[148:151], v[128:131]
  v_mfma_f32_16x16x32_bf16 v[132:135], a[164:167], v[148:151], v[132:135]
  v_mfma_f32_16x16x32_bf16 v[136:139], a[220:223], v[148:151], v[136:139]
  s_mov_b32 s61, 0
  s_mul_i32 s65, s61, 638976
  s_cmp_eq_u32 s58, 0
  s_cselect_b32 s47, 0, 28672
  s_add_u32 s65, s65, s47
  s_add_u32 s65, s65, 80134144
  s_add_u32 s66, s65, 4096
  s_mul_i32 s67, s61, 638976
  s_cmp_eq_u32 s58, 0
  s_cselect_b32 s47, 0, 4096
  s_add_u32 s67, s67, s47
  s_add_u32 s67, s67, 80220160
  s_mul_i32 s62, s61, 638976
  s_cmp_eq_u32 s58, 0
  s_cselect_b32 s47, 0, 114688
  s_add_u32 s62, s62, s47
  s_add_u32 s62, s62, 80232448
  s_mul_i32 s71, s48, 7168
  v_mov_b32 v108, -1
  s_cmp_eq_u32 s58, 0
  s_cbranch_scc1 nofill_196
  s_mov_b32 s44, 124
  s_cmp_ge_u32 s49, 224
  s_cselect_b32 s44, 192, s44
  s_cmp_lt_u32 s49, 128
  s_cselect_b32 s44, 96, s44
  s_sub_u32 s44, s49, s44
  s_lshl_b32 s44, s44, 12
  s_add_u32 s55, s44, 85164032
  s_mov_b32 s45, 90275840
  s_mov_b32 s56, 124786944
  s_lshl_b32 s47, s48, 10
  v_add_u32 v180, s47, v2
  v_mov_b32 v182, -1
  v_mov_b32 v183, -1
  v_mov_b32 v184, -1
  v_mov_b32 v185, -1
  s_cmp_eq_u32 s49, 191
  s_cselect_b32 s47, 29, 1
  v_mov_b32 v181, s47
fgrp_197:
  s_mov_b32 s44, s55
fill_198:
  buffer_store_dwordx4 v[182:185], v180, s[32:35], s44 offen sc1
  s_add_u32 s44, s44, 278528
  s_cmp_lt_u32 s44, s45
  s_cbranch_scc1 fill_198
  s_waitcnt vmcnt(0)
  s_barrier
  s_cmp_lg_u32 s48, 0
  s_cbranch_scc1 fd_199
  s_mov_b64 exec, 1
  buffer_atomic_add v181, off, s[32:35], s56 sc1
  s_mov_b64 exec, -1
fd_199:
  s_add_u32 s55, s55, 5111808
  s_add_u32 s45, s45, 5111808
  s_add_u32 s56, s56, 128
  s_cmp_le_u32 s45, 120946688
  s_cbranch_scc1 fgrp_197
nofill_196:
f1_200:
  s_mov_b32 s51, s61
  s_waitcnt vmcnt(2)
  v_max3_u32 v21, v108, v109, v110
  v_max3_u32 v21, v21, v111, v112
  v_max3_u32 v21, v21, v113, v114
  v_max_u32 v21, v21, v115
  v_cmp_eq_u32 vcc, -1, v21
  s_cbranch_vccz sok_201
  s_and_b32 s44, s61, 7
  s_cmp_ge_u32 s44, 1
  s_cbranch_scc1 rdy_202
  s_lshr_b32 s44, s61, 3
  s_lshl_b32 s44, s44, 7
  s_add_u32 s44, s44, 124786816
  v_mov_b32 v21, 0
  s_mov_b32 s52, 60000
poll_203:
  buffer_load_dword v22, v21, s[32:35], s44 offen sc1
  s_waitcnt vmcnt(0)
  v_cmp_ne_u32 vcc, 96, v22
  s_cbranch_vccz pok_204
  s_sleep 8
  s_sub_u32 s52, s52, 1
  s_cbranch_scc0 poll_203
  s_mov_b32 s54, 51
  s_branch k1_fail
pok_204:
rdy_202:
  buffer_load_dwordx2 v[108:109], v12, s[32:35], s67 offen offset:0 sc1
  buffer_load_dwordx2 v[110:111], v12, s[32:35], s67 offen offset:512 sc1
  buffer_load_dwordx2 v[112:113], v12, s[32:35], s67 offen offset:1024 sc1
  buffer_load_dwordx2 v[114:115], v13, s[32:35], s67 offen sc1
  s_add_u32 m0, s71, 0
  s_nop 0
  buffer_load_dwordx4 v3, s[32:35], s65 offen offset:0 sc1 lds
  s_add_u32 m0, s71, 0
  s_nop 0
  buffer_load_dwordx4 v3, s[32:35], s65 offen offset:1024 sc1 lds
  s_add_u32 m0, s71, 0
  s_nop 0
  buffer_load_dwordx4 v3, s[32:35], s65 offen offset:2048 sc1 lds
  s_add_u32 m0, s71, 0
  s_nop 0
  buffer_load_dwordx4 v3, s[32:35], s65 offen offset:3072 sc1 lds
  s_add_u32 m0, s71, 4096
  s_nop 0
  buffer_load_dwordx4 v3, s[32:35], s66 offen offset:0 sc1 lds
  s_add_u32 m0, s71, 4096
  s_nop 0
  buffer_load_dwordx4 v3, s[32:35], s66 offen offset:1024 sc1 lds
  s_add_u32 m0, s71, 4096
  s_nop 0
  buffer_load_dwordx4 v3, s[32:35], s66 offen offset:2048 sc1 lds
  s_waitcnt vmcnt(0)
  v_max3_u32 v21, v108, v109, v110
  v_max3_u32 v21, v21, v111, v112
  v_max3_u32 v21, v21, v113, v114
  v_max_u32 v21, v21, v115
  v_cmp_eq_u32 vcc, -1, v21
  s_cbranch_vccz sok_201
  s_mov_b32 s52, 60000
poll_205:
  buffer_load_dword v21, v177, s[32:35], s65 offen sc1
  s_waitcnt vmcnt(0)
  v_cmp_eq_u32 vcc, -1, v21
  s_cbranch_vccz pok_206
  s_sleep 2
  s_sub_u32 s52, s52, 1
  s_cbranch_scc0 poll_205
  s_mov_b32 s54, 52
  s_branch k1_fail
pok_206:
  s_mov_b32 s52, 60000
poll_207:
  buffer_load_dwordx2 v[108:109], v12, s[32:35], s67 offen offset:0 sc1
  buffer_load_dwordx2 v[110:111], v12, s[32:35], s67 offen offset:512 sc1
  buffer_load_dwordx2 v[112:113], v12, s[32:35], s67 offen offset:1024 sc1
  buffer_load_dwordx2 v[114:115], v13, s[32:35], s67 offen sc1
  s_add_u32 m0, s71, 0
  s_nop 0
  buffer_load_dwordx4 v3, s[32:35], s65 offen offset:0 sc1 lds
  s_add_u32 m0, s71, 0
  s_nop 0
  buffer_load_dwordx4 v3, s[32:35], s65 offen offset:1024 sc1 lds
  s_add_u32 m0, s71, 0
  s_nop 0
  buffer_load_dwordx4 v3, s[32:35], s65 offen offset:2048 sc1 lds
  s_add_u32 m0, s71, 0
  s_nop 0
  buffer_load_dwordx4 v3, s[32:35], s65 offen offset:3072 sc1 lds
  s_add_u32 m0, s71, 4096
  s_nop 0
  buffer_load_dwordx4 v3, s[32:35], s66 offen offset:0 sc1 lds
  s_add_u32 m0, s71, 4096
  s_nop 0
  buffer_load_dwordx4 v3, s[32:35], s66 offen offset:1024 sc1 lds
  s_add_u32 m0, s71, 4096
  s_nop 0
  buffer_load_dwordx4 v3, s[32:35], s66 offen offset:2048 sc1 lds
  s_waitcnt vmcnt(0)
  v_max3_u32 v21, v108, v109, v110
  v_max3_u32 v21, v21, v111, v112
  v_max3_u32 v21, v21, v113, v114
  v_max_u32 v21, v21, v115
  v_cmp_eq_u32 vcc, -1, v21
  s_cbranch_vccz pok_208
  s_sleep 2
  s_sub_u32 s52, s52, 1
  s_cbranch_scc0 poll_207
  s_mov_b32 s54, 50
  s_branch k1_fail
pok_208:
sok_201:
  v_mov_b32 v160, v108
  v_mov_b32 v161, v109
  v_mov_b32 v162, v110
  v_mov_b32 v163, v111
  v_mov_b32 v164, v112
  v_mov_b32 v165, v113
  v_mov_b32 v166, v114
  v_mov_b32 v167, v115
  s_barrier
  s_mov_b32 s76, s65
  s_xor_b32 s71, s71, 0x8000
  s_add_u32 s65, s65, 638976
  s_add_u32 s66, s66, 638976
  s_add_u32 s67, s67, 638976
  ds_read_b128 v[56:59], v20 offset:0
  ds_read_b128 v[60:63], v20 offset:1024
  ds_read_b128 v[64:67], v20 offset:2048
  ds_read_b128 v[68:71], v20 offset:3072
  s_waitcnt lgkmcnt(3)
  v_mfma_f32_16x16x32_bf16 v[24:27], a[0:3], v[56:59], 0
  ds_read_b128 v[72:75], v20 offset:4096
  v_mfma_f32_16x16x32_bf16 v[32:35], a[56:59], v[56:59], 0
  v_add_f32 v168, v160, v162
  v_mfma_f32_16x16x32_bf16 v[40:43], a[112:115], v[56:59], 0
  v_add_f32 v169, v164, v166
  v_mfma_f32_16x16x32_bf16 v[48:51], a[168:171], v[56:59], 0
  v_add_f32 v168, v168, v169
  s_waitcnt lgkmcnt(3)
  v_mfma_f32_16x16x32_bf16 v[24:27], a[4:7], v[60:63], v[24:27]
  ds_read_b128 v[56:59], v20 offset:5120
  v_mov_b32 v170, v168
  v_mfma_f32_16x16x32_bf16 v[32:35], a[60:63], v[60:63], v[32:35]
  s_nop 0
  v_permlane16_swap_b32 v168, v170
  v_mfma_f32_16x16x32_bf16 v[40:43], a[116:119], v[60:63], v[40:43]
  v_add_f32 v168, v168, v170
  v_mfma_f32_16x16x32_bf16 v[48:51], a[172:175], v[60:63], v[48:51]
  v_mov_b32 v170, v168
  s_waitcnt lgkmcnt(3)
  v_mfma_f32_16x16x32_bf16 v[24:27], a[8:11], v[64:67], v[24:27]
  ds_read_b128 v[60:63], v20 offset:6144
  v_permlane32_swap_b32 v168, v170
  v_mfma_f32_16x16x32_bf16 v[32:35], a[64:67], v[64:67], v[32:35]
  v_add_f32 v168, v168, v170
  v_mfma_f32_16x16x32_bf16 v[40:43], a[120:123], v[64:67], v[40:43]
  v_mul_f32 v168, 0x3d924925, v168
  v_mfma_f32_16x16x32_bf16 v[48:51], a[176:179], v[64:67], v[48:51]
  v_add_f32 v169, v161, v163
  s_waitcnt lgkmcnt(3)
  v_mfma_f32_16x16x32_bf16 v[24:27], a[12:15], v[68:71], v[24:27]
  ds_read_b128 v[64:67], v20 offset:7168
  v_add_f32 v170, v165, v167
  v_mfma_f32_16x16x32_bf16 v[32:35], a[68:71], v[68:71], v[32:35]
  v_add_f32 v169, v169, v170
  v_mfma_f32_16x16x32_bf16 v[40:43], a[124:127], v[68:71], v[40:43]
  v_sub_f32 v160, v160, v168
  v_mfma_f32_16x16x32_bf16 v[48:51], a[180:183], v[68:71], v[48:51]
  v_sub_f32 v162, v162, v168
  s_waitcnt lgkmcnt(3)
  v_mfma_f32_16x16x32_bf16 v[24:27], a[16:19], v[72:75], v[24:27]
  ds_read_b128 v[68:71], v20 offset:8192
  v_sub_f32 v164, v164, v168
  v_mfma_f32_16x16x32_bf16 v[32:35], a[72:75], v[72:75], v[32:35]
  v_sub_f32 v166, v166, v168
  v_mfma_f32_16x16x32_bf16 v[40:43], a[128:131], v[72:75], v[40:43]
  v_mul_f32 v166, v166, v14
  v_mfma_f32_16x16x32_bf16 v[48:51], a[184:187], v[72:75], v[48:51]
  v_mul_f32 v170, v160, v160
  s_waitcnt lgkmcnt(3)
  v_mfma_f32_16x16x32_bf16 v[24:27], a[20:23], v[56:59], v[24:27]
  ds_read_b128 v[72:75], v20 offset:9216
  v_fmac_f32 v170, v162, v162
  v_mfma_f32_16x16x32_bf16 v[32:35], a[76:79], v[56:59], v[32:35]
  v_fmac_f32 v170, v164, v164
  v_mfma_f32_16x16x32_bf16 v[40:43], a[132:135], v[56:59], v[40:43]
  v_fmac_f32 v170, v166, v166
  v_mfma_f32_16x16x32_bf16 v[48:51], a[188:191], v[56:59], v[48:51]
  v_fmac_f32 v169, 0x42000000, v170
  s_waitcnt lgkmcnt(3)
  v_mfma_f32_16x16x32_bf16 v[24:27], a[24:27], v[60:63], v[24:27]
  ds_read_b128 v[56:59], v20 offset:10240
  v_mov_b32 v170, v169
  v_mfma_f32_16x16x32_bf16 v[32:35], a[80:83], v[60:63], v[32:35]
  s_nop 0
  v_permlane16_swap_b32 v169, v170
  v_mfma_f32_16x16x32_bf16 v[40:43], a[136:139], v[60:63], v[40:43]
  v_add_f32 v169, v169, v170
  v_mfma_f32_16x16x32_bf16 v[48:51], a[192:195], v[60:63], v[48:51]
  v_mov_b32 v170, v169
  s_waitcnt lgkmcnt(3)
  v_mfma_f32_16x16x32_bf16 v[24:27], a[28:31], v[64:67], v[24:27]
  ds_read_b128 v[60:63], v20 offset:11264
  v_permlane32_swap_b32 v169, v170
  v_mfma_f32_16x16x32_bf16 v[32:35], a[84:87], v[64:67], v[32:35]
  v_add_f32 v169, v169, v170
  v_mfma_f32_16x16x32_bf16 v[40:43], a[140:143], v[64:67], v[40:43]
  v_mov_b32 v170, 0x3727c5ac
  v_mfma_f32_16x16x32_bf16 v[48:51], a[196:199], v[64:67], v[48:51]
  v_fmac_f32 v170, 0x3b124925, v169
  s_waitcnt lgkmcnt(3)
  v_mfma_f32_16x16x32_bf16 v[24:27], a[32:35], v[68:71], v[24:27]
  ds_read_b128 v[64:67], v20 offset:12288
  v_rsq_f32 v170, v170
  v_mfma_f32_16x16x32_bf16 v[32:35], a[88:91], v[68:71], v[32:35]
  v_mul_f32 v169, v168, v170
  v_mfma_f32_16x16x32_bf16 v[40:43], a[144:147], v[68:71], v[40:43]
  v_sub_f32 v169, 0, v169
  v_mfma_f32_16x16x32_bf16 v[48:51], a[200:203], v[68:71], v[48:51]
  v_mov_b32 v168, v170
  s_waitcnt lgkmcnt(3)
  v_mfma_f32_16x16x32_bf16 v[24:27], a[36:39], v[72:75], v[24:27]
  ds_read_b128 v[68:71], v20 offset:13312
  v_mfma_f32_16x16x32_bf16 v[32:35], a[92:95], v[72:75], v[32:35]
  v_mfma_f32_16x16x32_bf16 v[40:43], a[148:151], v[72:75], v[40:43]
  v_mfma_f32_16x16x32_bf16 v[48:51], a[204:207], v[72:75], v[48:51]
  s_waitcnt lgkmcnt(3)
  v_mfma_f32_16x16x32_bf16 v[24:27], a[40:43], v[56:59], v[24:27]
  v_mfma_f32_16x16x32_bf16 v[32:35], a[96:99], v[56:59], v[32:35]
  v_mfma_f32_16x16x32_bf16 v[40:43], a[152:155], v[56:59], v[40:43]
  v_mfma_f32_16x16x32_bf16 v[48:51], a[208:211], v[56:59], v[48:51]
  s_waitcnt lgkmcnt(2)
  v_mfma_f32_16x16x32_bf16 v[24:27], a[44:47], v[60:63], v[24:27]
  v_mfma_f32_16x16x32_bf16 v[32:35], a[100:103], v[60:63], v[32:35]
  v_mfma_f32_16x16x32_bf16 v[40:43], a[156:159], v[60:63], v[40:43]
  v_mfma_f32_16x16x32_bf16 v[48:51], a[212:215], v[60:63], v[48:51]
  s_waitcnt lgkmcnt(1)
  v_mfma_f32_16x16x32_bf16 v[24:27], a[48:51], v[64:67], v[24:27]
  v_mfma_f32_16x16x32_bf16 v[32:35], a[104:107], v[64:67], v[32:35]
  v_mfma_f32_16x16x32_bf16 v[40:43], a[160:163], v[64:67], v[40:43]
  v_mfma_f32_16x16x32_bf16 v[48:51], a[216:219], v[64:67], v[48:51]
  s_waitcnt lgkmcnt(0)
  v_mfma_f32_16x16x32_bf16 v[24:27], a[52:55], v[68:71], v[24:27]
  v_mfma_f32_16x16x32_bf16 v[32:35], a[108:111], v[68:71], v[32:35]
  v_mfma_f32_16x16x32_bf16 v[40:43], a[164:167], v[68:71], v[40:43]
  v_mfma_f32_16x16x32_bf16 v[48:51], a[220:223], v[68:71], v[48:51]
  ds_write_b64 v15, v[168:169]
  s_waitcnt lgkmcnt(0)
  s_barrier
  ds_read_b64 v[140:141], v16 offset:0
  ds_read_b64 v[144:145], v16 offset:128
  ds_read_b128 v[56:59], v20 offset:14336
  ds_read_b128 v[60:63], v20 offset:15360
  ds_read_b128 v[64:67], v20 offset:16384
  ds_read_b128 v[68:71], v20 offset:17408
  s_waitcnt lgkmcnt(3)
  v_mfma_f32_16x16x32_bf16 v[28:31], a[0:3], v[56:59], 0
  ds_read_b128 v[72:75], v20 offset:18432
  v_mfma_f32_16x16x32_bf16 v[36:39], a[56:59], v[56:59], 0
  v_mfma_f32_16x16x32_bf16 v[44:47], a[112:115], v[56:59], 0
  v_cmp_u_f32 s[74:75], v24, v24
  v_mul_f32 v142, 0xbfb8aa3b, v140
  v_mfma_f32_16x16x32_bf16 v[52:55], a[168:171], v[56:59], 0
  v_mul_f32 v143, 0xbfb8aa3b, v141
  v_mul_f32 v24, v24, v142
  s_waitcnt lgkmcnt(3)
  v_mfma_f32_16x16x32_bf16 v[28:31], a[4:7], v[60:63], v[28:31]
  ds_read_b128 v[56:59], v20 offset:19456
  v_mul_f32 v25, v25, v142
  v_mul_f32 v26, v26, v142
  v_mfma_f32_16x16x32_bf16 v[36:39], a[60:63], v[60:63], v[36:39]
  v_mul_f32 v27, v27, v142
  v_fmac_f32 v24, v124, v143
  v_mfma_f32_16x16x32_bf16 v[44:47], a[116:119], v[60:63], v[44:47]
  v_fmac_f32 v25, v125, v143
  v_fmac_f32 v26, v126, v143
  v_mfma_f32_16x16x32_bf16 v[52:55], a[172:175], v[60:63], v[52:55]
  v_fmac_f32 v27, v127, v143
  v_mul_f32 v32, v32, v142
  s_waitcnt lgkmcnt(3)
  v_mfma_f32_16x16x32_bf16 v[28:31], a[8:11], v[64:67], v[28:31]
  ds_read_b128 v[60:63], v20 offset:20480
  v_mul_f32 v33, v33, v142
  v_mul_f32 v34, v34, v142
  v_mfma_f32_16x16x32_bf16 v[36:39], a[64:67], v[64:67], v[36:39]
  v_mul_f32 v35, v35, v142
  v_fmac_f32 v32, v128, v143
  v_mfma_f32_16x16x32_bf16 v[44:47], a[120:123], v[64:67], v[44:47]
  v_fmac_f32 v33, v129, v143
  v_fmac_f32 v34, v130, v143
  v_mfma_f32_16x16x32_bf16 v[52:55], a[176:179], v[64:67], v[52:55]
  v_fmac_f32 v35, v131, v143
  v_mul_f32 v40, v40, v140
  s_waitcnt lgkmcnt(3)
  v_mfma_f32_16x16x32_bf16 v[28:31], a[12:15], v[68:71], v[28:31]
  ds_read_b128 v[64:67], v20 offset:21504
  v_mul_f32 v41, v41, v140
  v_mul_f32 v42, v42, v140
  v_mfma_f32_16x16x32_bf16 v[36:39], a[68:71], v[68:71], v[36:39]
  v_mul_f32 v43, v43, v140
  v_fmac_f32 v40, v132, v141
  v_mfma_f32_16x16x32_bf16 v[44:47], a[124:127], v[68:71], v[44:47]
  v_fmac_f32 v41, v133, v141
  v_fmac_f32 v42, v134, v141
  v_mfma_f32_16x16x32_bf16 v[52:55], a[180:183], v[68:71], v[52:55]
  v_fmac_f32 v43, v135, v141
  v_mul_f32 v48, v48, v140
  s_waitcnt lgkmcnt(3)
  v_mfma_f32_16x16x32_bf16 v[28:31], a[16:19], v[72:75], v[28:31]
  ds_read_b128 v[68:71], v20 offset:22528
  v_mul_f32 v49, v49, v140
  v_mul_f32 v50, v50, v140
  v_mfma_f32_16x16x32_bf16 v[36:39], a[72:75], v[72:75], v[36:39]
  v_mul_f32 v51, v51, v140
  v_fmac_f32 v48, v136, v141
  v_mfma_f32_16x16x32_bf16 v[44:47], a[128:131], v[72:75], v[44:47]
  v_fmac_f32 v49, v137, v141
  v_fmac_f32 v50, v138, v141
  v_mfma_f32_16x16x32_bf16 v[52:55], a[184:187], v[72:75], v[52:55]
  v_fmac_f32 v51, v139, v141
  v_exp_f32 v24, v24
  s_waitcnt lgkmcnt(3)
  v_mfma_f32_16x16x32_bf16 v[28:31], a[20:23], v[56:59], v[28:31]
  ds_read_b128 v[72:75], v20 offset:23552
  v_exp_f32 v25, v25
  v_exp_f32 v26, v26
  v_mfma_f32_16x16x32_bf16 v[36:39], a[76:79], v[56:59], v[36:39]
  v_exp_f32 v27, v27
  v_exp_f32 v32, v32
  v_mfma_f32_16x16x32_bf16 v[44:47], a[132:135], v[56:59], v[44:47]
  v_exp_f32 v33, v33
  v_exp_f32 v34, v34
  v_mfma_f32_16x16x32_bf16 v[52:55], a[188:191], v[56:59], v[52:55]
  v_exp_f32 v35, v35
  v_add_f32 v24, 1.0, v24
  s_waitcnt lgkmcnt(3)
  v_mfma_f32_16x16x32_bf16 v[28:31], a[24:27], v[60:63], v[28:31]
  ds_read_b128 v[56:59], v20 offset:24576
  v_add_f32 v25, 1.0, v25
  v_add_f32 v26, 1.0, v26
  v_mfma_f32_16x16x32_bf16 v[36:39], a[80:83], v[60:63], v[36:39]
  v_add_f32 v27, 1.0, v27
  v_add_f32 v32, 1.0, v32
  v_mfma_f32_16x16x32_bf16 v[44:47], a[136:139], v[60:63], v[44:47]
  v_add_f32 v33, 1.0, v33
  v_add_f32 v34, 1.0, v34
  v_mfma_f32_16x16x32_bf16 v[52:55], a[192:195], v[60:63], v[52:55]
  v_add_f32 v35, 1.0, v35
  s_waitcnt lgkmcnt(3)
  v_mfma_f32_16x16x32_bf16 v[28:31], a[28:31], v[64:67], v[28:31]
  ds_read_b128 v[60:63], v20 offset:25600
  v_rcp_f32 v24, v24
  v_mfma_f32_16x16x32_bf16 v[36:39], a[84:87], v[64:67], v[36:39]
  v_rcp_f32 v25, v25
  v_mfma_f32_16x16x32_bf16 v[44:47], a[140:143], v[64:67], v[44:47]
  v_rcp_f32 v26, v26
  v_mfma_f32_16x16x32_bf16 v[52:55], a[196:199], v[64:67], v[52:55]
  v_rcp_f32 v27, v27
  s_waitcnt lgkmcnt(3)
  v_mfma_f32_16x16x32_bf16 v[28:31], a[32:35], v[68:71], v[28:31]
  ds_read_b128 v[64:67], v20 offset:26624
  v_rcp_f32 v32, v32
  v_mfma_f32_16x16x32_bf16 v[36:39], a[88:91], v[68:71], v[36:39]
  v_rcp_f32 v33, v33
  v_mfma_f32_16x16x32_bf16 v[44:47], a[144:147], v[68:71], v[44:47]
  v_rcp_f32 v34, v34
  buffer_load_dwordx2 v[108:109], v12, s[32:35], s67 offen offset:0 sc1
  v_mfma_f32_16x16x32_bf16 v[52:55], a[200:203], v[68:71], v[52:55]
  v_rcp_f32 v35, v35
  s_waitcnt lgkmcnt(3)
  v_mfma_f32_16x16x32_bf16 v[28:31], a[36:39], v[72:75], v[28:31]
  ds_read_b128 v[68:71], v20 offset:27648
  v_mul_f32 v24, v24, v40
  buffer_load_dwordx2 v[110:111], v12, s[32:35], s67 offen offset:512 sc1
  v_mfma_f32_16x16x32_bf16 v[36:39], a[92:95], v[72:75], v[36:39]
  v_mul_f32 v25, v25, v41
  v_mfma_f32_16x16x32_bf16 v[44:47], a[148:151], v[72:75], v[44:47]
  v_mul_f32 v26, v26, v42
  buffer_load_dwordx2 v[112:113], v12, s[32:35], s67 offen offset:1024 sc1
  v_mfma_f32_16x16x32_bf16 v[52:55], a[204:207], v[72:75], v[52:55]
  v_mul_f32 v27, v27, v43
  s_waitcnt lgkmcnt(3)
  v_mfma_f32_16x16x32_bf16 v[28:31], a[40:43], v[56:59], v[28:31]
  v_mul_f32 v32, v32, v48
  buffer_load_dwordx2 v[114:115], v13, s[32:35], s67 offen sc1
  v_mfma_f32_16x16x32_bf16 v[36:39], a[96:99], v[56:59], v[36:39]
  v_mul_f32 v33, v33, v49
  v_mfma_f32_16x16x32_bf16 v[44:47], a[152:155], v[56:59], v[44:47]
  v_mul_f32 v34, v34, v50
  s_add_u32 m0, s71, 0
  s_nop 0
  buffer_load_dwordx4 v3, s[32:35], s65 offen offset:0 sc1 lds
  v_mfma_f32_16x16x32_bf16 v[52:55], a[208:211], v[56:59], v[52:55]
  v_mul_f32 v35, v35, v51
  s_waitcnt lgkmcnt(2)
  v_mfma_f32_16x16x32_bf16 v[28:31], a[44:47], v[60:63], v[28:31]
  v_cvt_pk_bf16_f32 v152, v24, v25
  s_add_u32 m0, s71, 0
  s_nop 0
  buffer_load_dwordx4 v3, s[32:35], s65 offen offset:1024 sc1 lds
  v_mfma_f32_16x16x32_bf16 v[36:39], a[100:103], v[60:63], v[36:39]
  v_cvt_pk_bf16_f32 v153, v26, v27
  v_mfma_f32_16x16x32_bf16 v[44:47], a[156:159], v[60:63], v[44:47]
  v_cvt_pk_bf16_f32 v154, v32, v33
  s_add_u32 m0, s71, 0
  s_nop 0
  buffer_load_dwordx4 v3, s[32:35], s65 offen offset:2048 sc1 lds
  v_mfma_f32_16x16x32_bf16 v[52:55], a[212:215], v[60:63], v[52:55]
  v_cvt_pk_bf16_f32 v155, v34, v35
  s_waitcnt lgkmcnt(1)
  v_mfma_f32_16x16x32_bf16 v[28:31], a[48:51], v[64:67], v[28:31]
  v_min_u32 v152, -2, v152
  s_add_u32 m0, s71, 0
  s_nop 0
  buffer_load_dwordx4 v3, s[32:35], s65 offen offset:3072 sc1 lds
  v_mfma_f32_16x16x32_bf16 v[36:39], a[104:107], v[64:67], v[36:39]
  v_min_u32 v153, -2, v153
  v_mfma_f32_16x16x32_bf16 v[44:47], a[160:163], v[64:67], v[44:47]
  v_min_u32 v154, -2, v154
  s_add_u32 m0, s71, 4096
  s_nop 0
  buffer_load_dwordx4 v3, s[32:35], s66 offen offset:0 sc1 lds
  v_mfma_f32_16x16x32_bf16 v[52:55], a[216:219], v[64:67], v[52:55]
  v_min_u32 v155, -2, v155
  s_waitcnt lgkmcnt(0)
  v_mfma_f32_16x16x32_bf16 v[28:31], a[52:55], v[68:71], v[28:31]
  s_add_u32 m0, s71, 4096
  s_nop 0
  buffer_load_dwordx4 v3, s[32:35], s66 offen offset:1024 sc1 lds
  v_mfma_f32_16x16x32_bf16 v[36:39], a[108:111], v[68:71], v[36:39]
  v_mfma_f32_16x16x32_bf16 v[44:47], a[164:167], v[68:71], v[44:47]
  s_add_u32 m0, s71, 4096
  s_nop 0
  buffer_load_dwordx4 v3, s[32:35], s66 offen offset:2048 sc1 lds
  v_mfma_f32_16x16x32_bf16 v[52:55], a[220:223], v[68:71], v[52:55]
  s_add_u32 s44, s61, 1
  s_and_b32 s44, s44, 7
  s_cmp_eq_u32 s44, 0
  s_cbranch_scc0 ng_212
  v_readfirstlane_b32 s44, v176
  s_nop 0
  s_cmp_eq_u32 s44, 96
  s_cbranch_scc1 ng_212
  buffer_load_dword v176, off, s[32:35], s57 sc1
  s_waitcnt vmcnt(0)
  v_mov_b32 v108, -1
ng_212:
  v_cmp_u_f32 vcc, v28, v28
  s_nop 0
  s_or_b64 vcc, vcc, s[74:75]
  s_cbranch_vccnz redo_209
cont_211:
  s_cmp_eq_u32 s53, 1
  s_cbranch_scc0 sl_213
  buffer_store_dwordx4 v[152:155], v4, s[32:35], s62 offen offset:0
  s_branch sd_214
sl_213:
  buffer_store_dwordx4 v[152:155], v4, s[32:35], s62 offen offset:0 sc1
sd_214:
  v_mul_f32 v146, 0xbfb8aa3b, v144
  v_mul_f32 v147, 0xbfb8aa3b, v145
  v_pk_mul_f32 v[28:29], v[28:29], v[146:147] op_sel_hi:[1,0]
  v_pk_mul_f32 v[30:31], v[30:31], v[146:147] op_sel_hi:[1,0]
  v_pk_fma_f32 v[28:29], v[124:125], v[146:147], v[28:29] op_sel:[0,1,0] op_sel_hi:[1,1,1]
  v_pk_fma_f32 v[30:31], v[126:127], v[146:147], v[30:31] op_sel:[0,1,0] op_sel_hi:[1,1,1]
  v_pk_mul_f32 v[36:37], v[36:37], v[146:147] op_sel_hi:[1,0]
  v_pk_mul_f32 v[38:39], v[38:39], v[146:147] op_sel_hi:[1,0]
  v_pk_fma_f32 v[36:37], v[128:129], v[146:147], v[36:37] op_sel:[0,1,0] op_sel_hi:[1,1,1]
  v_pk_fma_f32 v[38:39], v[130:131], v[146:147], v[38:39] op_sel:[0,1,0] op_sel_hi:[1,1,1]
  v_pk_mul_f32 v[44:45], v[44:45], v[144:145] op_sel_hi:[1,0]
  v_pk_mul_f32 v[46:47], v[46:47], v[144:145] op_sel_hi:[1,0]
  v_pk_fma_f32 v[44:45], v[132:133], v[144:145], v[44:45] op_sel:[0,1,0] op_sel_hi:[1,1,1]
  v_pk_fma_f32 v[46:47], v[134:135], v[144:145], v[46:47] op_sel:[0,1,0] op_sel_hi:[1,1,1]
  v_pk_mul_f32 v[52:53], v[52:53], v[144:145] op_sel_hi:[1,0]
  v_pk_mul_f32 v[54:55], v[54:55], v[144:145] op_sel_hi:[1,0]
  v_pk_fma_f32 v[52:53], v[136:137], v[144:145], v[52:53] op_sel:[0,1,0] op_sel_hi:[1,1,1]
  v_pk_fma_f32 v[54:55], v[138:139], v[144:145], v[54:55] op_sel:[0,1,0] op_sel_hi:[1,1,1]
  v_exp_f32 v28, v28
  v_exp_f32 v29, v29
  v_exp_f32 v30, v30
  v_exp_f32 v31, v31
  v_exp_f32 v36, v36
  v_exp_f32 v37, v37
  v_exp_f32 v38, v38
  v_exp_f32 v39, v39
  v_add_f32 v28, 1.0, v28
  v_add_f32 v29, 1.0, v29
  v_add_f32 v30, 1.0, v30
  v_add_f32 v31, 1.0, v31
  v_add_f32 v36, 1.0, v36
  v_add_f32 v37, 1.0, v37
  v_add_f32 v38, 1.0, v38
  v_add_f32 v39, 1.0, v39
  v_rcp_f32 v28, v28
  v_rcp_f32 v29, v29
  v_rcp_f32 v30, v30
  v_rcp_f32 v31, v31
  v_rcp_f32 v36, v36
  v_rcp_f32 v37, v37
  v_rcp_f32 v38, v38
  v_rcp_f32 v39, v39
  v_mul_f32 v28, v28, v44
  v_mul_f32 v29, v29, v45
  v_mul_f32 v30, v30, v46
  v_mul_f32 v31, v31, v47
  v_mul_f32 v36, v36, v52
  v_mul_f32 v37, v37, v53
  v_mul_f32 v38, v38, v54
  v_mul_f32 v39, v39, v55
  v_cvt_pk_bf16_f32 v156, v28, v29
  v_cvt_pk_bf16_f32 v157, v30, v31
  v_cvt_pk_bf16_f32 v158, v36, v37
  v_cvt_pk_bf16_f32 v159, v38, v39
  v_min_u32 v156, -2, v156
  v_min_u32 v157, -2, v157
  v_min_u32 v158, -2, v158
  v_min_u32 v159, -2, v159
  s_cmp_eq_u32 s53, 1
  s_cbranch_scc0 sl_215
  buffer_store_dwordx4 v[156:159], v4, s[32:35], s62 offen offset:1024
  s_branch sd_216
sl_215:
  buffer_store_dwordx4 v[156:159], v4, s[32:35], s62 offen offset:1024 sc1
sd_216:
  v_xor_b32 v5, 0x8000, v5
  v_xor_b32 v20, 0x8000, v20
  s_add_u32 s62, s62, 638976
  s_add_u32 s61, s61, 1
  s_cmp_lt_u32 s61, 64
  s_cbranch_scc1 f1_200
  s_endpgm
redo_209:
  s_waitcnt vmcnt(0) lgkmcnt(0)
  s_barrier
  s_add_u32 s47, s76, 4096
  s_mov_b32 s52, 60000
poll_217:
  buffer_load_dwordx4 v[80:83], v3, s[32:35], s76 offen offset:0 sc1
  buffer_load_dwordx4 v[84:87], v3, s[32:35], s76 offen offset:1024 sc1
  buffer_load_dwordx4 v[88:91], v3, s[32:35], s76 offen offset:2048 sc1
  buffer_load_dwordx4 v[92:95], v3, s[32:35], s76 offen offset:3072 sc1
  buffer_load_dwordx4 v[96:99], v3, s[32:35], s47 offen offset:0 sc1
  buffer_load_dwordx4 v[100:103], v3, s[32:35], s47 offen offset:1024 sc1
  buffer_load_dwordx4 v[104:107], v3, s[32:35], s47 offen offset:2048 sc1
  s_waitcnt vmcnt(0)
  v_max3_u32 v21, v80, v81, v82
  v_max3_u32 v21, v21, v83, v84
  v_max3_u32 v21, v21, v85, v86
  v_max3_u32 v21, v21, v87, v88
  v_max3_u32 v21, v21, v89, v90
  v_max3_u32 v21, v21, v91, v92
  v_max3_u32 v21, v21, v93, v94
  v_max3_u32 v21, v21, v95, v96
  v_max3_u32 v21, v21, v97, v98
  v_max3_u32 v21, v21, v99, v100
  v_max3_u32 v21, v21, v101, v102
  v_max3_u32 v21, v21, v103, v104
  v_max3_u32 v21, v21, v105, v106
  v_max_u32 v21, v21, v107
  v_cmp_eq_u32 vcc, -1, v21
  s_cbranch_vccz pok_218
  s_sleep 2
  s_sub_u32 s52, s52, 1
  s_cbranch_scc0 poll_217
  s_mov_b32 s54, 54
  s_branch k1_fail
pok_218:
  ds_write_b128 v5, v[80:83] offset:0
  ds_write_b128 v5, v[84:87] offset:1024
  ds_write_b128 v5, v[88:91] offset:2048
  ds_write_b128 v5, v[92:95] offset:3072
  ds_write_b128 v5, v[96:99] offset:4096
  ds_write_b128 v5, v[100:103] offset:5120
  ds_write_b128 v5, v[104:107] offset:6144
  s_waitcnt lgkmcnt(0)
  s_barrier
  s_mov_b32 s77, 1
  s_branch again_210
again_210:
  ds_read_b128 v[56:59], v20 offset:0
  ds_read_b128 v[60:63], v20 offset:1024
  ds_read_b128 v[64:67], v20 offset:2048
  ds_read_b128 v[68:71], v20 offset:3072
  s_waitcnt lgkmcnt(3)
  v_mfma_f32_16x16x32_bf16 v[24:27], a[0:3], v[56:59], 0
  ds_read_b128 v[72:75], v20 offset:4096
  v_mfma_f32_16x16x32_bf16 v[32:35], a[56:59], v[56:59], 0
  v_mfma_f32_16x16x32_bf16 v[40:43], a[112:115], v[56:59], 0
  v_mfma_f32_16x16x32_bf16 v[48:51], a[168:171], v[56:59], 0
  s_waitcnt lgkmcnt(3)
  v_mfma_f32_16x16x32_bf16 v[24:27], a[4:7], v[60:63], v[24:27]
  ds_read_b128 v[56:59], v20 offset:5120
  v_mfma_f32_16x16x32_bf16 v[32:35], a[60:63], v[60:63], v[32:35]
  v_mfma_f32_16x16x32_bf16 v[40:43], a[116:119], v[60:63], v[40:43]
  v_mfma_f32_16x16x32_bf16 v[48:51], a[172:175], v[60:63], v[48:51]
  s_waitcnt lgkmcnt(3)
  v_mfma_f32_16x16x32_bf16 v[24:27], a[8:11], v[64:67], v[24:27]
  ds_read_b128 v[60:63], v20 offset:6144
  v_mfma_f32_16x16x32_bf16 v[32:35], a[64:67], v[64:67], v[32:35]
  v_mfma_f32_16x16x32_bf16 v[40:43], a[120:123], v[64:67], v[40:43]
  v_mfma_f32_16x16x32_bf16 v[48:51], a[176:179], v[64:67], v[48:51]
  s_waitcnt lgkmcnt(3)
  v_mfma_f32_16x16x32_bf16 v[24:27], a[12:15], v[68:71], v[24:27]
  ds_read_b128 v[64:67], v20 offset:7168
  v_mfma_f32_16x16x32_bf16 v[32:35], a[68:71], v[68:71], v[32:35]
  v_mfma_f32_16x16x32_bf16 v[40:43], a[124:127], v[68:71], v[40:43]
  v_mfma_f32_16x16x32_bf16 v[48:51], a[180:183], v[68:71], v[48:51]
  s_waitcnt lgkmcnt(3)
  v_mfma_f32_16x16x32_bf16 v[24:27], a[16:19], v[72:75], v[24:27]
  ds_read_b128 v[68:71], v20 offset:8192
  v_mfma_f32_16x16x32_bf16 v[32:35], a[72:75], v[72:75], v[32:35]
  v_mfma_f32_16x16x32_bf16 v[40:43], a[128:131], v[72:75], v[40:43]
  v_mfma_f32_16x16x32_bf16 v[48:51], a[184:187], v[72:75], v[48:51]
  s_waitcnt lgkmcnt(3)
  v_mfma_f32_16x16x32_bf16 v[24:27], a[20:23], v[56:59], v[24:27]
  ds_read_b128 v[72:75], v20 offset:9216
  v_mfma_f32_16x16x32_bf16 v[32:35], a[76:79], v[56:59], v[32:35]
  v_mfma_f32_16x16x32_bf16 v[40:43], a[132:135], v[56:59], v[40:43]
  v_mfma_f32_16x16x32_bf16 v[48:51], a[188:191], v[56:59], v[48:51]
  s_waitcnt lgkmcnt(3)
  v_mfma_f32_16x16x32_bf16 v[24:27], a[24:27], v[60:63], v[24:27]
  ds_read_b128 v[56:59], v20 offset:10240
  v_mfma_f32_16x16x32_bf16 v[32:35], a[80:83], v[60:63], v[32:35]
  v_mfma_f32_16x16x32_bf16 v[40:43], a[136:139], v[60:63], v[40:43]
  v_mfma_f32_16x16x32_bf16 v[48:51], a[192:195], v[60:63], v[48:51]
  s_waitcnt lgkmcnt(3)
  v_mfma_f32_16x16x32_bf16 v[24:27], a[28:31], v[64:67], v[24:27]
  ds_read_b128 v[60:63], v20 offset:11264
  v_mfma_f32_16x16x32_bf16 v[32:35], a[84:87], v[64:67], v[32:35]
  v_mfma_f32_16x16x32_bf16 v[40:43], a[140:143], v[64:67], v[40:43]
  v_mfma_f32_16x16x32_bf16 v[48:51], a[196:199], v[64:67], v[48:51]
  s_waitcnt lgkmcnt(3)
  v_mfma_f32_16x16x32_bf16 v[24:27], a[32:35], v[68:71], v[24:27]
  ds_read_b128 v[64:67], v20 offset:12288
  v_mfma_f32_16x16x32_bf16 v[32:35], a[88:91], v[68:71], v[32:35]
  v_mfma_f32_16x16x32_bf16 v[40:43], a[144:147], v[68:71], v[40:43]
  v_mfma_f32_16x16x32_bf16 v[48:51], a[200:203], v[68:71], v[48:51]
  s_waitcnt lgkmcnt(3)
  v_mfma_f32_16x16x32_bf16 v[24:27], a[36:39], v[72:75], v[24:27]
  ds_read_b128 v[68:71], v20 offset:13312
  v_mfma_f32_16x16x32_bf16 v[32:35], a[92:95], v[72:75], v[32:35]
  v_mfma_f32_16x16x32_bf16 v[40:43], a[148:151], v[72:75], v[40:43]
  v_mfma_f32_16x16x32_bf16 v[48:51], a[204:207], v[72:75], v[48:51]
  s_waitcnt lgkmcnt(3)
  v_mfma_f32_16x16x32_bf16 v[24:27], a[40:43], v[56:59], v[24:27]
  v_mfma_f32_16x16x32_bf16 v[32:35], a[96:99], v[56:59], v[32:35]
  v_mfma_f32_16x16x32_bf16 v[40:43], a[152:155], v[56:59], v[40:43]
  v_mfma_f32_16x16x32_bf16 v[48:51], a[208:211], v[56:59], v[48:51]
  s_waitcnt lgkmcnt(2)
  v_mfma_f32_16x16x32_bf16 v[24:27], a[44:47], v[60:63], v[24:27]
  v_mfma_f32_16x16x32_bf16 v[32:35], a[100:103], v[60:63], v[32:35]
  v_mfma_f32_16x16x32_bf16 v[40:43], a[156:159], v[60:63], v[40:43]
  v_mfma_f32_16x16x32_bf16 v[48:51], a[212:215], v[60:63], v[48:51]
  s_waitcnt lgkmcnt(1)
  v_mfma_f32_16x16x32_bf16 v[24:27], a[48:51], v[64:67], v[24:27]
  v_mfma_f32_16x16x32_bf16 v[32:35], a[104:107], v[64:67], v[32:35]
  v_mfma_f32_16x16x32_bf16 v[40:43], a[160:163], v[64:67], v[40:43]
  v_mfma_f32_16x16x32_bf16 v[48:51], a[216:219], v[64:67], v[48:51]
  s_waitcnt lgkmcnt(0)
  v_mfma_f32_16x16x32_bf16 v[24:27], a[52:55], v[68:71], v[24:27]
  v_mfma_f32_16x16x32_bf16 v[32:35], a[108:111], v[68:71], v[32:35]
  v_mfma_f32_16x16x32_bf16 v[40:43], a[164:167], v[68:71], v[40:43]
  v_mfma_f32_16x16x32_bf16 v[48:51], a[220:223], v[68:71], v[48:51]
  ds_read_b128 v[56:59], v20 offset:14336
  ds_read_b128 v[60:63], v20 offset:15360
  ds_read_b128 v[64:67], v20 offset:16384
  ds_read_b128 v[68:71], v20 offset:17408
  s_waitcnt lgkmcnt(3)
  v_mfma_f32_16x16x32_bf16 v[28:31], a[0:3], v[56:59], 0
  ds_read_b128 v[72:75], v20 offset:18432
  v_mfma_f32_16x16x32_bf16 v[36:39], a[56:59], v[56:59], 0
  v_mfma_f32_16x16x32_bf16 v[44:47], a[112:115], v[56:59], 0
  v_mfma_f32_16x16x32_bf16 v[52:55], a[168:171], v[56:59], 0
  s_waitcnt lgkmcnt(3)
  v_mfma_f32_16x16x32_bf16 v[28:31], a[4:7], v[60:63], v[28:31]
  ds_read_b128 v[56:59], v20 offset:19456
  v_mfma_f32_16x16x32_bf16 v[36:39], a[60:63], v[60:63], v[36:39]
  v_mfma_f32_16x16x32_bf16 v[44:47], a[116:119], v[60:63], v[44:47]
  v_mfma_f32_16x16x32_bf16 v[52:55], a[172:175], v[60:63], v[52:55]
  s_waitcnt lgkmcnt(3)
  v_mfma_f32_16x16x32_bf16 v[28:31], a[8:11], v[64:67], v[28:31]
  ds_read_b128 v[60:63], v20 offset:20480
  v_mfma_f32_16x16x32_bf16 v[36:39], a[64:67], v[64:67], v[36:39]
  v_mfma_f32_16x16x32_bf16 v[44:47], a[120:123], v[64:67], v[44:47]
  v_mfma_f32_16x16x32_bf16 v[52:55], a[176:179], v[64:67], v[52:55]
  s_waitcnt lgkmcnt(3)
  v_mfma_f32_16x16x32_bf16 v[28:31], a[12:15], v[68:71], v[28:31]
  ds_read_b128 v[64:67], v20 offset:21504
  v_mfma_f32_16x16x32_bf16 v[36:39], a[68:71], v[68:71], v[36:39]
  v_mfma_f32_16x16x32_bf16 v[44:47], a[124:127], v[68:71], v[44:47]
  v_mfma_f32_16x16x32_bf16 v[52:55], a[180:183], v[68:71], v[52:55]
  s_waitcnt lgkmcnt(3)
  v_mfma_f32_16x16x32_bf16 v[28:31], a[16:19], v[72:75], v[28:31]
  ds_read_b128 v[68:71], v20 offset:22528
  v_mfma_f32_16x16x32_bf16 v[36:39], a[72:75], v[72:75], v[36:39]
  v_mfma_f32_16x16x32_bf16 v[44:47], a[128:131], v[72:75], v[44:47]
  v_mfma_f32_16x16x32_bf16 v[52:55], a[184:187], v[72:75], v[52:55]
  s_waitcnt lgkmcnt(3)
  v_mfma_f32_16x16x32_bf16 v[28:31], a[20:23], v[56:59], v[28:31]
  ds_read_b128 v[72:75], v20 offset:23552
  v_mfma_f32_16x16x32_bf16 v[36:39], a[76:79], v[56:59], v[36:39]
  v_mfma_f32_16x16x32_bf16 v[44:47], a[132:135], v[56:59], v[44:47]
  v_mfma_f32_16x16x32_bf16 v[52:55], a[188:191], v[56:59], v[52:55]
  s_waitcnt lgkmcnt(3)
  v_mfma_f32_16x16x32_bf16 v[28:31], a[24:27], v[60:63], v[28:31]
  ds_read_b128 v[56:59], v20 offset:24576
  v_mfma_f32_16x16x32_bf16 v[36:39], a[80:83], v[60:63], v[36:39]
  v_mfma_f32_16x16x32_bf16 v[44:47], a[136:139], v[60:63], v[44:47]
  v_mfma_f32_16x16x32_bf16 v[52:55], a[192:195], v[60:63], v[52:55]
  s_waitcnt lgkmcnt(3)
  v_mfma_f32_16x16x32_bf16 v[28:31], a[28:31], v[64:67], v[28:31]
  ds_read_b128 v[60:63], v20 offset:25600
  v_mfma_f32_16x16x32_bf16 v[36:39], a[84:87], v[64:67], v[36:39]
  v_mfma_f32_16x16x32_bf16 v[44:47], a[140:143], v[64:67], v[44:47]
  v_mfma_f32_16x16x32_bf16 v[52:55], a[196:199], v[64:67], v[52:55]
  s_waitcnt lgkmcnt(3)
  v_mfma_f32_16x16x32_bf16 v[28:31], a[32:35], v[68:71], v[28:31]
  ds_read_b128 v[64:67], v20 offset:26624
  v_mfma_f32_16x16x32_bf16 v[36:39], a[88:91], v[68:71], v[36:39]
  v_mfma_f32_16x16x32_bf16 v[44:47], a[144:147], v[68:71], v[44:47]
  v_mfma_f32_16x16x32_bf16 v[52:55], a[200:203], v[68:71], v[52:55]
  s_waitcnt lgkmcnt(3)
  v_mfma_f32_16x16x32_bf16 v[28:31], a[36:39], v[72:75], v[28:31]
  ds_read_b128 v[68:71], v20 offset:27648
  v_mfma_f32_16x16x32_bf16 v[36:39], a[92:95], v[72:75], v[36:39]
  v_mfma_f32_16x16x32_bf16 v[44:47], a[148:151], v[72:75], v[44:47]
  v_mfma_f32_16x16x32_bf16 v[52:55], a[204:207], v[72:75], v[52:55]
  s_waitcnt lgkmcnt(3)
  v_mfma_f32_16x16x32_bf16 v[28:31], a[40:43], v[56:59], v[28:31]
  v_mfma_f32_16x16x32_bf16 v[36:39], a[96:99], v[56:59], v[36:39]
  v_mfma_f32_16x16x32_bf16 v[44:47], a[152:155], v[56:59], v[44:47]
  v_mfma_f32_16x16x32_bf16 v[52:55], a[208:211], v[56:59], v[52:55]
  s_waitcnt lgkmcnt(2)
  v_mfma_f32_16x16x32_bf16 v[28:31], a[44:47], v[60:63], v[28:31]
  v_mfma_f32_16x16x32_bf16 v[36:39], a[100:103], v[60:63], v[36:39]
  v_mfma_f32_16x16x32_bf16 v[44:47], a[156:159], v[60:63], v[44:47]
  v_mfma_f32_16x16x32_bf16 v[52:55], a[212:215], v[60:63], v[52:55]
  s_waitcnt lgkmcnt(1)
  v_mfma_f32_16x16x32_bf16 v[28:31], a[48:51], v[64:67], v[28:31]
  v_mfma_f32_16x16x32_bf16 v[36:39], a[104:107], v[64:67], v[36:39]
  v_mfma_f32_16x16x32_bf16 v[44:47], a[160:163], v[64:67], v[44:47]
  v_mfma_f32_16x16x32_bf16 v[52:55], a[216:219], v[64:67], v[52:55]
  s_waitcnt lgkmcnt(0)
  v_mfma_f32_16x16x32_bf16 v[28:31], a[52:55], v[68:71], v[28:31]
  v_mfma_f32_16x16x32_bf16 v[36:39], a[108:111], v[68:71], v[36:39]
  v_mfma_f32_16x16x32_bf16 v[44:47], a[164:167], v[68:71], v[44:47]
  v_mfma_f32_16x16x32_bf16 v[52:55], a[220:223], v[68:71], v[52:55]
  v_mul_f32 v142, 0xbfb8aa3b, v140
  v_mul_f32 v143, 0xbfb8aa3b, v141
  v_mul_f32 v24, v24, v142
  v_mul_f32 v25, v25, v142
  v_mul_f32 v26, v26, v142
  v_mul_f32 v27, v27, v142
  v_fmac_f32 v24, v124, v143
  v_fmac_f32 v25, v125, v143
  v_fmac_f32 v26, v126, v143
  v_fmac_f32 v27, v127, v143
  v_mul_f32 v32, v32, v142
  v_mul_f32 v33, v33, v142
  v_mul_f32 v34, v34, v142
  v_mul_f32 v35, v35, v142
  v_fmac_f32 v32, v128, v143
  v_fmac_f32 v33, v129, v143
  v_fmac_f32 v34, v130, v143
  v_fmac_f32 v35, v131, v143
  v_mul_f32 v40, v40, v140
  v_mul_f32 v41, v41, v140
  v_mul_f32 v42, v42, v140
  v_mul_f32 v43, v43, v140
  v_fmac_f32 v40, v132, v141
  v_fmac_f32 v41, v133, v141
  v_fmac_f32 v42, v134, v141
  v_fmac_f32 v43, v135, v141
  v_mul_f32 v48, v48, v140
  v_mul_f32 v49, v49, v140
  v_mul_f32 v50, v50, v140
  v_mul_f32 v51, v51, v140
  v_fmac_f32 v48, v136, v141
  v_fmac_f32 v49, v137, v141
  v_fmac_f32 v50, v138, v141
  v_fmac_f32 v51, v139, v141
  v_exp_f32 v24, v24
  v_exp_f32 v25, v25
  v_exp_f32 v26, v26
  v_exp_f32 v27, v27
  v_exp_f32 v32, v32
  v_exp_f32 v33, v33
  v_exp_f32 v34, v34
  v_exp_f32 v35, v35
  v_add_f32 v24, 1.0, v24
  v_add_f32 v25, 1.0, v25
  v_add_f32 v26, 1.0, v26
  v_add_f32 v27, 1.0, v27
  v_add_f32 v32, 1.0, v32
  v_add_f32 v33, 1.0, v33
  v_add_f32 v34, 1.0, v34
  v_add_f32 v35, 1.0, v35
  v_rcp_f32 v24, v24
  v_rcp_f32 v25, v25
  v_rcp_f32 v26, v26
  v_rcp_f32 v27, v27
  v_rcp_f32 v32, v32
  v_rcp_f32 v33, v33
  v_rcp_f32 v34, v34
  v_rcp_f32 v35, v35
  v_mul_f32 v24, v24, v40
  v_mul_f32 v25, v25, v41
  v_mul_f32 v26, v26, v42
  v_mul_f32 v27, v27, v43
  v_mul_f32 v32, v32, v48
  v_mul_f32 v33, v33, v49
  v_mul_f32 v34, v34, v50
  v_mul_f32 v35, v35, v51
  v_cvt_pk_bf16_f32 v152, v24, v25
  v_cvt_pk_bf16_f32 v153, v26, v27
  v_cvt_pk_bf16_f32 v154, v32, v33
  v_cvt_pk_bf16_f32 v155, v34, v35
  v_min_u32 v152, -2, v152
  v_min_u32 v153, -2, v153
  v_min_u32 v154, -2, v154
  v_min_u32 v155, -2, v155
  s_branch cont_211
r_F2:
  s_sub_u32 s65, s50, 14
  s_mov_b32 s40, s24
  s_and_b32 s41, s25, 0xffff
  s_mov_b32 s42, 1605632
  s_mov_b32 s43, 0x20000
  s_mul_i32 s44, s48, 401408
  s_lshl_b32 s45, s65, 7
  s_add_u32 s44, s44, s45
  s_add_u32 s44, s44, 0
  v_lshrrev_b32 v8, 2, v1
  v_mul_u32_u24 v8, 896, v8
  v_and_b32 v9, 3, v1
  v_lshl_add_u32 v8, v9, 4, v8
  s_mul_i32 s46, s48, 28672
  s_add_u32 m0, s46, 0
  s_nop 0
  buffer_load_dwordx4 v8, s[40:43], s44 offen lds
  s_add_u32 s44, s44, 14336
  s_add_u32 m0, s46, 1024
  s_nop 0
  buffer_load_dwordx4 v8, s[40:43], s44 offen lds
  s_add_u32 s44, s44, 14336
  s_add_u32 m0, s46, 2048
  s_nop 0
  buffer_load_dwordx4 v8, s[40:43], s44 offen lds
  s_add_u32 s44, s44, 14336
  s_add_u32 m0, s46, 3072
  s_nop 0
  buffer_load_dwordx4 v8, s[40:43], s44 offen lds
  s_add_u32 s44, s44, 14336
  s_add_u32 m0, s46, 4096
  s_nop 0
  buffer_load_dwordx4 v8, s[40:43], s44 offen lds
  s_add_u32 s44, s44, 14336
  s_add_u32 m0, s46, 5120
  s_nop 0
  buffer_load_dwordx4 v8, s[40:43], s44 offen lds
  s_add_u32 s44, s44, 14336
  s_add_u32 m0, s46, 6144
  s_nop 0
  buffer_load_dwordx4 v8, s[40:43], s44 offen lds
  s_add_u32 s44, s44, 14336
  s_add_u32 m0, s46, 7168
  s_nop 0
  buffer_load_dwordx4 v8, s[40:43], s44 offen lds
  s_add_u32 s44, s44, 14336
  s_add_u32 m0, s46, 8192
  s_nop 0
  buffer_load_dwordx4 v8, s[40:43], s44 offen lds
  s_add_u32 s44, s44, 14336
  s_add_u32 m0, s46, 9216
  s_nop 0
  buffer_load_dwordx4 v8, s[40:43], s44 offen lds
  s_add_u32 s44, s44, 14336
  s_add_u32 m0, s46, 10240
  s_nop 0
  buffer_load_dwordx4 v8, s[40:43], s44 offen lds
  s_add_u32 s44, s44, 14336
  s_add_u32 m0, s46, 11264
  s_nop 0
  buffer_load_dwordx4 v8, s[40:43], s44 offen lds
  s_add_u32 s44, s44, 14336
  s_add_u32 m0, s46, 12288
  s_nop 0
  buffer_load_dwordx4 v8, s[40:43], s44 offen lds
  s_add_u32 s44, s44, 14336
  s_add_u32 m0, s46, 13312
  s_nop 0
  buffer_load_dwordx4 v8, s[40:43], s44 offen lds
  s_add_u32 s44, s44, 14336
  s_add_u32 m0, s46, 14336
  s_nop 0
  buffer_load_dwordx4 v8, s[40:43], s44 offen lds
  s_add_u32 s44, s44, 14336
  s_add_u32 m0, s46, 15360
  s_nop 0
  buffer_load_dwordx4 v8, s[40:43], s44 offen lds
  s_add_u32 s44, s44, 14336
  s_add_u32 m0, s46, 16384
  s_nop 0
  buffer_load_dwordx4 v8, s[40:43], s44 offen lds
  s_add_u32 s44, s44, 14336
  s_add_u32 m0, s46, 17408
  s_nop 0
  buffer_load_dwordx4 v8, s[40:43], s44 offen lds
  s_add_u32 s44, s44, 14336
  s_add_u32 m0, s46, 18432
  s_nop 0
  buffer_load_dwordx4 v8, s[40:43], s44 offen lds
  s_add_u32 s44, s44, 14336
  s_add_u32 m0, s46, 19456
  s_nop 0
  buffer_load_dwordx4 v8, s[40:43], s44 offen lds
  s_add_u32 s44, s44, 14336
  s_add_u32 m0, s46, 20480
  s_nop 0
  buffer_load_dwordx4 v8, s[40:43], s44 offen lds
  s_add_u32 s44, s44, 14336
  s_add_u32 m0, s46, 21504
  s_nop 0
  buffer_load_dwordx4 v8, s[40:43], s44 offen lds
  s_add_u32 s44, s44, 14336
  s_add_u32 m0, s46, 22528
  s_nop 0
  buffer_load_dwordx4 v8, s[40:43], s44 offen lds
  s_add_u32 s44, s44, 14336
  s_add_u32 m0, s46, 23552
  s_nop 0
  buffer_load_dwordx4 v8, s[40:43], s44 offen lds
  s_add_u32 s44, s44, 14336
  s_add_u32 m0, s46, 24576
  s_nop 0
  buffer_load_dwordx4 v8, s[40:43], s44 offen lds
  s_add_u32 s44, s44, 14336
  s_add_u32 m0, s46, 25600
  s_nop 0
  buffer_load_dwordx4 v8, s[40:43], s44 offen lds
  s_add_u32 s44, s44, 14336
  s_add_u32 m0, s46, 26624
  s_nop 0
  buffer_load_dwordx4 v8, s[40:43], s44 offen lds
  s_add_u32 s44, s44, 14336
  s_add_u32 m0, s46, 27648
  s_nop 0
  buffer_load_dwordx4 v8, s[40:43], s44 offen lds
  s_add_u32 s44, s44, 14336
  v_lshrrev_b32 v8, 4, v1
  v_lshlrev_b32 v8, 3, v8
  v_bfe_u32 v10, v1, 2, 2
  v_add_u32 v8, v8, v10
  v_lshlrev_b32 v8, 6, v8
  v_lshl_add_u32 v8, v9, 4, v8
  v_add_u32 v8, s46, v8
  s_waitcnt vmcnt(0)
  ds_read_b64_tr_b16 a[0:1], v8 offset:0
  ds_read_b64_tr_b16 a[2:3], v8 offset:256
  ds_read_b64_tr_b16 a[56:57], v8 offset:8
  ds_read_b64_tr_b16 a[58:59], v8 offset:264
  ds_read_b64_tr_b16 a[4:5], v8 offset:2048
  ds_read_b64_tr_b16 a[6:7], v8 offset:2304
  ds_read_b64_tr_b16 a[60:61], v8 offset:2056
  ds_read_b64_tr_b16 a[62:63], v8 offset:2312
  ds_read_b64_tr_b16 a[8:9], v8 offset:4096
  ds_read_b64_tr_b16 a[10:11], v8 offset:4352
  ds_read_b64_tr_b16 a[64:65], v8 offset:4104
  ds_read_b64_tr_b16 a[66:67], v8 offset:4360
  s_waitcnt lgkmcnt(0)
  ds_read_b64_tr_b16 a[12:13], v8 offset:6144
  ds_read_b64_tr_b16 a[14:15], v8 offset:6400
  ds_read_b64_tr_b16 a[68:69], v8 offset:6152
  ds_read_b64_tr_b16 a[70:71], v8 offset:6408
  ds_read_b64_tr_b16 a[16:17], v8 offset:8192
  ds_read_b64_tr_b16 a[18:19], v8 offset:8448
  ds_read_b64_tr_b16 a[72:73], v8 offset:8200
  ds_read_b64_tr_b16 a[74:75], v8 offset:8456
  ds_read_b64_tr_b16 a[20:21], v8 offset:10240
  ds_read_b64_tr_b16 a[22:23], v8 offset:10496
  ds_read_b64_tr_b16 a[76:77], v8 offset:10248
  ds_read_b64_tr_b16 a[78:79], v8 offset:10504
  s_waitcnt lgkmcnt(0)
  ds_read_b64_tr_b16 a[24:25], v8 offset:12288
  ds_read_b64_tr_b16 a[26:27], v8 offset:12544
  ds_read_b64_tr_b16 a[80:81], v8 offset:12296
  ds_read_b64_tr_b16 a[82:83], v8 offset:12552
  ds_read_b64_tr_b16 a[28:29], v8 offset:14336
  ds_read_b64_tr_b16 a[30:31], v8 offset:14592
  ds_read_b64_tr_b16 a[84:85], v8 offset:14344
  ds_read_b64_tr_b16 a[86:87], v8 offset:14600
  ds_read_b64_tr_b16 a[32:33], v8 offset:16384
  ds_read_b64_tr_b16 a[34:35], v8 offset:16640
  ds_read_b64_tr_b16 a[88:89], v8 offset:16392
  ds_read_b64_tr_b16 a[90:91], v8 offset:16648
  s_waitcnt lgkmcnt(0)
  ds_read_b64_tr_b16 a[36:37], v8 offset:18432
  ds_read_b64_tr_b16 a[38:39], v8 offset:18688
  ds_read_b64_tr_b16 a[92:93], v8 offset:18440
  ds_read_b64_tr_b16 a[94:95], v8 offset:18696
  ds_read_b64_tr_b16 a[40:41], v8 offset:20480
  ds_read_b64_tr_b16 a[42:43], v8 offset:20736
  ds_read_b64_tr_b16 a[96:97], v8 offset:20488
  ds_read_b64_tr_b16 a[98:99], v8 offset:20744
  ds_read_b64_tr_b16 a[44:45], v8 offset:22528
  ds_read_b64_tr_b16 a[46:47], v8 offset:22784
  ds_read_b64_tr_b16 a[100:101], v8 offset:22536
  ds_read_b64_tr_b16 a[102:103], v8 offset:22792
  s_waitcnt lgkmcnt(0)
  ds_read_b64_tr_b16 a[48:49], v8 offset:24576
  ds_read_b64_tr_b16 a[50:51], v8 offset:24832
  ds_read_b64_tr_b16 a[104:105], v8 offset:24584
  ds_read_b64_tr_b16 a[106:107], v8 offset:24840
  ds_read_b64_tr_b16 a[52:53], v8 offset:26624
  ds_read_b64_tr_b16 a[54:55], v8 offset:26880
  ds_read_b64_tr_b16 a[108:109], v8 offset:26632
  ds_read_b64_tr_b16 a[110:111], v8 offset:26888
  s_waitcnt lgkmcnt(0)
  s_mul_i32 s44, s48, 401408
  s_lshl_b32 s45, s65, 7
  s_add_u32 s44, s44, s45
  s_add_u32 s44, s44, 64
  v_lshrrev_b32 v8, 2, v1
  v_mul_u32_u24 v8, 896, v8
  v_and_b32 v9, 3, v1
  v_lshl_add_u32 v8, v9, 4, v8
  s_mul_i32 s46, s48, 28672
  s_add_u32 m0, s46, 0
  s_nop 0
  buffer_load_dwordx4 v8, s[40:43], s44 offen lds
  s_add_u32 s44, s44, 14336
  s_add_u32 m0, s46, 1024
  s_nop 0
  buffer_load_dwordx4 v8, s[40:43], s44 offen lds
  s_add_u32 s44, s44, 14336
  s_add_u32 m0, s46, 2048
  s_nop 0
  buffer_load_dwordx4 v8, s[40:43], s44 offen lds
  s_add_u32 s44, s44, 14336
  s_add_u32 m0, s46, 3072
  s_nop 0
  buffer_load_dwordx4 v8, s[40:43], s44 offen lds
  s_add_u32 s44, s44, 14336
  s_add_u32 m0, s46, 4096
  s_nop 0
  buffer_load_dwordx4 v8, s[40:43], s44 offen lds
  s_add_u32 s44, s44, 14336
  s_add_u32 m0, s46, 5120
  s_nop 0
  buffer_load_dwordx4 v8, s[40:43], s44 offen lds
  s_add_u32 s44, s44, 14336
  s_add_u32 m0, s46, 6144
  s_nop 0
  buffer_load_dwordx4 v8, s[40:43], s44 offen lds
  s_add_u32 s44, s44, 14336
  s_add_u32 m0, s46, 7168
  s_nop 0
  buffer_load_dwordx4 v8, s[40:43], s44 offen lds
  s_add_u32 s44, s44, 14336
  s_add_u32 m0, s46, 8192
  s_nop 0
  buffer_load_dwordx4 v8, s[40:43], s44 offen lds
  s_add_u32 s44, s44, 14336
  s_add_u32 m0, s46, 9216
  s_nop 0
  buffer_load_dwordx4 v8, s[40:43], s44 offen lds
  s_add_u32 s44, s44, 14336
  s_add_u32 m0, s46, 10240
  s_nop 0
  buffer_load_dwordx4 v8, s[40:43], s44 offen lds
  s_add_u32 s44, s44, 14336
  s_add_u32 m0, s46, 11264
  s_nop 0
  buffer_load_dwordx4 v8, s[40:43], s44 offen lds
  s_add_u32 s44, s44, 14336
  s_add_u32 m0, s46, 12288
  s_nop 0
  buffer_load_dwordx4 v8, s[40:43], s44 offen lds
  s_add_u32 s44, s44, 14336
  s_add_u32 m0, s46, 13312
  s_nop 0
  buffer_load_dwordx4 v8, s[40:43], s44 offen lds
  s_add_u32 s44, s44, 14336
  s_add_u32 m0, s46, 14336
  s_nop 0
  buffer_load_dwordx4 v8, s[40:43], s44 offen lds
  s_add_u32 s44, s44, 14336
  s_add_u32 m0, s46, 15360
  s_nop 0
  buffer_load_dwordx4 v8, s[40:43], s44 offen lds
  s_add_u32 s44, s44, 14336
  s_add_u32 m0, s46, 16384
  s_nop 0
  buffer_load_dwordx4 v8, s[40:43], s44 offen lds
  s_add_u32 s44, s44, 14336
  s_add_u32 m0, s46, 17408
  s_nop 0
  buffer_load_dwordx4 v8, s[40:43], s44 offen lds
  s_add_u32 s44, s44, 14336
  s_add_u32 m0, s46, 18432
  s_nop 0
  buffer_load_dwordx4 v8, s[40:43], s44 offen lds
  s_add_u32 s44, s44, 14336
  s_add_u32 m0, s46, 19456
  s_nop 0
  buffer_load_dwordx4 v8, s[40:43], s44 offen lds
  s_add_u32 s44, s44, 14336
  s_add_u32 m0, s46, 20480
  s_nop 0
  buffer_load_dwordx4 v8, s[40:43], s44 offen lds
  s_add_u32 s44, s44, 14336
  s_add_u32 m0, s46, 21504
  s_nop 0
  buffer_load_dwordx4 v8, s[40:43], s44 offen lds
  s_add_u32 s44, s44, 14336
  s_add_u32 m0, s46, 22528
  s_nop 0
  buffer_load_dwordx4 v8, s[40:43], s44 offen lds
  s_add_u32 s44, s44, 14336
  s_add_u32 m0, s46, 23552
  s_nop 0
  buffer_load_dwordx4 v8, s[40:43], s44 offen lds
  s_add_u32 s44, s44, 14336
  s_add_u32 m0, s46, 24576
  s_nop 0
  buffer_load_dwordx4 v8, s[40:43], s44 offen lds
  s_add_u32 s44, s44, 14336
  s_add_u32 m0, s46, 25600
  s_nop 0
  buffer_load_dwordx4 v8, s[40:43], s44 offen lds
  s_add_u32 s44, s44, 14336
  s_add_u32 m0, s46, 26624
  s_nop 0
  buffer_load_dwordx4 v8, s[40:43], s44 offen lds
  s_add_u32 s44, s44, 14336
  s_add_u32 m0, s46, 27648
  s_nop 0
  buffer_load_dwordx4 v8, s[40:43], s44 offen lds
  s_add_u32 s44, s44, 14336
  v_lshrrev_b32 v8, 4, v1
  v_lshlrev_b32 v8, 3, v8
  v_bfe_u32 v10, v1, 2, 2
  v_add_u32 v8, v8, v10
  v_lshlrev_b32 v8, 6, v8
  v_lshl_add_u32 v8, v9, 4, v8
  v_add_u32 v8, s46, v8
  s_waitcnt vmcnt(0)
  ds_read_b64_tr_b16 a[112:113], v8 offset:0
  ds_read_b64_tr_b16 a[114:115], v8 offset:256
  ds_read_b64_tr_b16 a[168:169], v8 offset:8
  ds_read_b64_tr_b16 a[170:171], v8 offset:264
  ds_read_b64_tr_b16 a[116:117], v8 offset:2048
  ds_read_b64_tr_b16 a[118:119], v8 offset:2304
  ds_read_b64_tr_b16 a[172:173], v8 offset:2056
  ds_read_b64_tr_b16 a[174:175], v8 offset:2312
  ds_read_b64_tr_b16 a[120:121], v8 offset:4096
  ds_read_b64_tr_b16 a[122:123], v8 offset:4352
  ds_read_b64_tr_b16 a[176:177], v8 offset:4104
  ds_read_b64_tr_b16 a[178:179], v8 offset:4360
  s_waitcnt lgkmcnt(0)
  ds_read_b64_tr_b16 a[124:125], v8 offset:6144
  ds_read_b64_tr_b16 a[126:127], v8 offset:6400
  ds_read_b64_tr_b16 a[180:181], v8 offset:6152
  ds_read_b64_tr_b16 a[182:183], v8 offset:6408
  ds_read_b64_tr_b16 a[128:129], v8 offset:8192
  ds_read_b64_tr_b16 a[130:131], v8 offset:8448
  ds_read_b64_tr_b16 a[184:185], v8 offset:8200
  ds_read_b64_tr_b16 a[186:187], v8 offset:8456
  ds_read_b64_tr_b16 a[132:133], v8 offset:10240
  ds_read_b64_tr_b16 a[134:135], v8 offset:10496
  ds_read_b64_tr_b16 a[188:189], v8 offset:10248
  ds_read_b64_tr_b16 a[190:191], v8 offset:10504
  s_waitcnt lgkmcnt(0)
  ds_read_b64_tr_b16 a[136:137], v8 offset:12288
  ds_read_b64_tr_b16 a[138:139], v8 offset:12544
  ds_read_b64_tr_b16 a[192:193], v8 offset:12296
  ds_read_b64_tr_b16 a[194:195], v8 offset:12552
  ds_read_b64_tr_b16 a[140:141], v8 offset:14336
  ds_read_b64_tr_b16 a[142:143], v8 offset:14592
  ds_read_b64_tr_b16 a[196:197], v8 offset:14344
  ds_read_b64_tr_b16 a[198:199], v8 offset:14600
  ds_read_b64_tr_b16 a[144:145], v8 offset:16384
  ds_read_b64_tr_b16 a[146:147], v8 offset:16640
  ds_read_b64_tr_b16 a[200:201], v8 offset:16392
  ds_read_b64_tr_b16 a[202:203], v8 offset:16648
  s_waitcnt lgkmcnt(0)
  ds_read_b64_tr_b16 a[148:149], v8 offset:18432
  ds_read_b64_tr_b16 a[150:151], v8 offset:18688
  ds_read_b64_tr_b16 a[204:205], v8 offset:18440
  ds_read_b64_tr_b16 a[206:207], v8 offset:18696
  ds_read_b64_tr_b16 a[152:153], v8 offset:20480
  ds_read_b64_tr_b16 a[154:155], v8 offset:20736
  ds_read_b64_tr_b16 a[208:209], v8 offset:20488
  ds_read_b64_tr_b16 a[210:211], v8 offset:20744
  ds_read_b64_tr_b16 a[156:157], v8 offset:22528
  ds_read_b64_tr_b16 a[158:159], v8 offset:22784
  ds_read_b64_tr_b16 a[212:213], v8 offset:22536
  ds_read_b64_tr_b16 a[214:215], v8 offset:22792
  s_waitcnt lgkmcnt(0)
  ds_read_b64_tr_b16 a[160:161], v8 offset:24576
  ds_read_b64_tr_b16 a[162:163], v8 offset:24832
  ds_read_b64_tr_b16 a[216:217], v8 offset:24584
  ds_read_b64_tr_b16 a[218:219], v8 offset:24840
  ds_read_b64_tr_b16 a[164:165], v8 offset:26624
  ds_read_b64_tr_b16 a[166:167], v8 offset:26880
  ds_read_b64_tr_b16 a[220:221], v8 offset:26632
  ds_read_b64_tr_b16 a[222:223], v8 offset:26888
  s_waitcnt lgkmcnt(0)
  s_lshl_b32 s65, s65, 1
  s_lshr_b32 s44, s48, 1
  s_add_u32 s65, s65, s44
  s_barrier
  s_mov_b32 s40, s26
  s_and_b32 s41, s27, 0xffff
  s_mov_b32 s42, 1835008
  s_mov_b32 s43, 0x20000
  v_and_b32 v9, 15, v1
  v_lshrrev_b32 v10, 4, v1
  s_mul_i32 s45, s48, 28672
  v_add_u32 v3, s45, v2
  s_lshl_b32 s45, s48, 12
  s_add_u32 s45, s45, 0
  v_add_u32 v13, s45, v2
  s_and_b32 s46, s48, 1
  s_lshl_b32 s45, s46, 10
  s_add_u32 s45, s45, 0
  v_add_u32 v14, s45, v2
  s_mul_i32 s45, s46, 14
  s_add_u32 s45, s45, s65
  s_lshl_b32 s45, s45, 10
  v_add_u32 v15, s45, v2
  s_lshl_b32 s45, s46, 11
  s_lshl_b32 s44, s65, 7
  s_add_u32 s45, s45, s44
  v_lshlrev_b32 v16, 3, v9
  v_add_u32 v16, s45, v16
  v_mov_b32 v11, 1073741824
  v_cmp_eq_u32 vcc, 0, v10
  s_nop 1
  v_cndmask_b32 v16, v11, v16, vcc
  s_lshl_b32 s45, s46, 4
  v_add_u32 v17, s45, v9
  v_mul_u32_u24 v17, 896, v17
  v_lshl_add_u32 v17, v10, 4, v17
  s_lshl_b32 s45, s65, 6
  v_add_u32 v17, s45, v17
  s_lshl_b32 s45, s48, 13
  v_add_u32 v13, s45, v2
  s_lshr_b32 s45, s48, 1
  s_lshl_b32 s45, s45, 12
  v_add_u32 v14, s45, v14
  s_mov_b32 s61, 0
  s_mul_i32 s66, s61, 638976
  s_cmp_eq_u32 s58, 0
  s_cselect_b32 s47, 0, 114688
  s_add_u32 s66, s66, s47
  s_add_u32 s66, s66, 80232448
  s_add_u32 s67, s66, 4096
  s_add_u32 s81, s67, 638976
  s_add_u32 s68, s66, 8192
  s_add_u32 s82, s68, 638976
  s_add_u32 s69, s66, 12288
  s_add_u32 s83, s69, 638976
  s_add_u32 s70, s66, 16384
  s_add_u32 s84, s70, 638976
  s_add_u32 s71, s66, 20480
  s_add_u32 s85, s71, 638976
  s_add_u32 s72, s66, 24576
  s_add_u32 s86, s72, 638976
  s_add_u32 s80, s66, 638976
  v_mov_b32 v64, -1
  s_mov_b32 s59, 0
  s_mov_b32 s57, 124787712
  v_mov_b32 v212, 0
  s_mul_i32 s44, s48, 28672
  v_lshlrev_b32 v213, 10, v1
  v_add_u32 v213, s44, v213
  v_mov_b32 v214, 1073741824
  v_cmp_gt_u32 vcc, 28, v1
  s_nop 1
  v_cndmask_b32 v213, v214, v213, vcc
  s_cmp_eq_u32 s58, 0
  s_cbranch_scc1 nofill_219
  s_mov_b32 s44, 124
  s_cmp_ge_u32 s49, 224
  s_cselect_b32 s44, 192, s44
  s_cmp_lt_u32 s49, 128
  s_cselect_b32 s44, 96, s44
  s_sub_u32 s44, s49, s44
  s_lshl_b32 s44, s44, 12
  s_add_u32 s55, s44, 85164032
  s_mov_b32 s45, 90275840
  s_mov_b32 s56, 124786944
  s_lshl_b32 s47, s48, 10
  v_add_u32 v216, s47, v2
  v_mov_b32 v218, -1
  v_mov_b32 v219, -1
  v_mov_b32 v220, -1
  v_mov_b32 v221, -1
  s_cmp_eq_u32 s49, 191
  s_cselect_b32 s47, 29, 1
  v_mov_b32 v217, s47
fgrp_220:
  s_mov_b32 s44, s55
fill_221:
  buffer_store_dwordx4 v[218:221], v216, s[32:35], s44 offen sc1
  s_add_u32 s44, s44, 278528
  s_cmp_lt_u32 s44, s45
  s_cbranch_scc1 fill_221
  s_waitcnt vmcnt(0)
  s_barrier
  s_cmp_lg_u32 s48, 0
  s_cbranch_scc1 fd_222
  s_mov_b64 exec, 1
  buffer_atomic_add v217, off, s[32:35], s56 sc1
  s_mov_b64 exec, -1
fd_222:
  s_add_u32 s55, s55, 5111808
  s_add_u32 s45, s45, 5111808
  s_add_u32 s56, s56, 128
  s_cmp_le_u32 s45, 120946688
  s_cbranch_scc1 fgrp_220
nofill_219:
f2_223:
  s_mov_b32 s51, s61
  s_mul_i32 s62, s61, 638976
  s_cmp_eq_u32 s58, 0
  s_cselect_b32 s47, 0, 28672
  s_add_u32 s62, s62, s47
  s_add_u32 s62, s62, 80134144
  s_waitcnt vmcnt(26)
  v_max3_u32 v11, v64, v65, v66
  v_max3_u32 v11, v11, v67, v68
  v_max3_u32 v11, v11, v69, v70
  v_max_u32 v11, v11, v71
  v_cmp_eq_u32 vcc, -1, v11
  s_cbranch_vccz go_224
  s_and_b32 s44, s61, 7
  s_cmp_ge_u32 s44, 1
  s_cbranch_scc1 rdy_225
  s_lshr_b32 s44, s61, 3
  s_lshl_b32 s44, s44, 7
  s_add_u32 s44, s44, 124786816
  v_mov_b32 v11, 0
  s_mov_b32 s52, 60000
poll_226:
  buffer_load_dword v12, v11, s[32:35], s44 offen sc1
  s_waitcnt vmcnt(0)
  v_cmp_ne_u32 vcc, 96, v12
  s_cbranch_vccz pok_227
  s_sleep 8
  s_sub_u32 s52, s52, 1
  s_cbranch_scc0 poll_226
  s_mov_b32 s54, 62
  s_branch k1_fail
pok_227:
rdy_225:
  buffer_load_dwordx4 v[64:67], v3, s[32:35], s66 offen offset:0 sc1
  buffer_load_dwordx4 v[68:71], v3, s[32:35], s66 offen offset:1024 sc1
  buffer_load_dwordx4 v[72:75], v3, s[32:35], s66 offen offset:2048 sc1
  buffer_load_dwordx4 v[76:79], v3, s[32:35], s66 offen offset:3072 sc1
  buffer_load_dwordx4 v[80:83], v3, s[32:35], s67 offen offset:0 sc1
  buffer_load_dwordx4 v[84:87], v3, s[32:35], s67 offen offset:1024 sc1
  buffer_load_dwordx4 v[88:91], v3, s[32:35], s67 offen offset:2048 sc1
  buffer_load_dwordx4 v[92:95], v3, s[32:35], s67 offen offset:3072 sc1
  buffer_load_dwordx4 v[96:99], v3, s[32:35], s68 offen offset:0 sc1
  buffer_load_dwordx4 v[100:103], v3, s[32:35], s68 offen offset:1024 sc1
  buffer_load_dwordx4 v[104:107], v3, s[32:35], s68 offen offset:2048 sc1
  buffer_load_dwordx4 v[108:111], v3, s[32:35], s68 offen offset:3072 sc1
  buffer_load_dwordx4 v[112:115], v3, s[32:35], s69 offen offset:0 sc1
  buffer_load_dwordx4 v[116:119], v3, s[32:35], s69 offen offset:1024 sc1
  buffer_load_dwordx4 v[120:123], v3, s[32:35], s69 offen offset:2048 sc1
  buffer_load_dwordx4 v[124:127], v3, s[32:35], s69 offen offset:3072 sc1
  buffer_load_dwordx4 v[128:131], v3, s[32:35], s70 offen offset:0 sc1
  buffer_load_dwordx4 v[132:135], v3, s[32:35], s70 offen offset:1024 sc1
  buffer_load_dwordx4 v[136:139], v3, s[32:35], s70 offen offset:2048 sc1
  buffer_load_dwordx4 v[140:143], v3, s[32:35], s70 offen offset:3072 sc1
  buffer_load_dwordx4 v[144:147], v3, s[32:35], s71 offen offset:0 sc1
  buffer_load_dwordx4 v[148:151], v3, s[32:35], s71 offen offset:1024 sc1
  buffer_load_dwordx4 v[152:155], v3, s[32:35], s71 offen offset:2048 sc1
  buffer_load_dwordx4 v[156:159], v3, s[32:35], s71 offen offset:3072 sc1
  buffer_load_dwordx4 v[160:163], v3, s[32:35], s72 offen offset:0 sc1
  buffer_load_dwordx4 v[164:167], v3, s[32:35], s72 offen offset:1024 sc1
  buffer_load_dwordx4 v[168:171], v3, s[32:35], s72 offen offset:2048 sc1
  buffer_load_dwordx4 v[172:175], v3, s[32:35], s72 offen offset:3072 sc1
  s_waitcnt vmcnt(26)
  v_max3_u32 v11, v64, v65, v66
  v_max3_u32 v11, v11, v67, v68
  v_max3_u32 v11, v11, v69, v70
  v_max_u32 v11, v11, v71
  v_cmp_eq_u32 vcc, -1, v11
  s_cbranch_vccz go_224
  s_mov_b32 s52, 60000
poll_228:
  buffer_load_dword v11, v213, s[32:35], s66 offen sc1
  s_waitcnt vmcnt(0)
  v_cmp_eq_u32 vcc, -1, v11
  s_cbranch_vccz pok_229
  s_sleep 2
  s_sub_u32 s52, s52, 1
  s_cbranch_scc0 poll_228
  s_mov_b32 s54, 64
  s_branch k1_fail
pok_229:
  s_mov_b32 s52, 60000
poll_230:
  buffer_load_dwordx4 v[64:67], v3, s[32:35], s66 offen offset:0 sc1
  buffer_load_dwordx4 v[68:71], v3, s[32:35], s66 offen offset:1024 sc1
  buffer_load_dwordx4 v[72:75], v3, s[32:35], s66 offen offset:2048 sc1
  buffer_load_dwordx4 v[76:79], v3, s[32:35], s66 offen offset:3072 sc1
  buffer_load_dwordx4 v[80:83], v3, s[32:35], s67 offen offset:0 sc1
  buffer_load_dwordx4 v[84:87], v3, s[32:35], s67 offen offset:1024 sc1
  buffer_load_dwordx4 v[88:91], v3, s[32:35], s67 offen offset:2048 sc1
  buffer_load_dwordx4 v[92:95], v3, s[32:35], s67 offen offset:3072 sc1
  buffer_load_dwordx4 v[96:99], v3, s[32:35], s68 offen offset:0 sc1
  buffer_load_dwordx4 v[100:103], v3, s[32:35], s68 offen offset:1024 sc1
  buffer_load_dwordx4 v[104:107], v3, s[32:35], s68 offen offset:2048 sc1
  buffer_load_dwordx4 v[108:111], v3, s[32:35], s68 offen offset:3072 sc1
  buffer_load_dwordx4 v[112:115], v3, s[32:35], s69 offen offset:0 sc1
  buffer_load_dwordx4 v[116:119], v3, s[32:35], s69 offen offset:1024 sc1
  buffer_load_dwordx4 v[120:123], v3, s[32:35], s69 offen offset:2048 sc1
  buffer_load_dwordx4 v[124:127], v3, s[32:35], s69 offen offset:3072 sc1
  buffer_load_dwordx4 v[128:131], v3, s[32:35], s70 offen offset:0 sc1
  buffer_load_dwordx4 v[132:135], v3, s[32:35], s70 offen offset:1024 sc1
  buffer_load_dwordx4 v[136:139], v3, s[32:35], s70 offen offset:2048 sc1
  buffer_load_dwordx4 v[140:143], v3, s[32:35], s70 offen offset:3072 sc1
  buffer_load_dwordx4 v[144:147], v3, s[32:35], s71 offen offset:0 sc1
  buffer_load_dwordx4 v[148:151], v3, s[32:35], s71 offen offset:1024 sc1
  buffer_load_dwordx4 v[152:155], v3, s[32:35], s71 offen offset:2048 sc1
  buffer_load_dwordx4 v[156:159], v3, s[32:35], s71 offen offset:3072 sc1
  buffer_load_dwordx4 v[160:163], v3, s[32:35], s72 offen offset:0 sc1
  buffer_load_dwordx4 v[164:167], v3, s[32:35], s72 offen offset:1024 sc1
  buffer_load_dwordx4 v[168:171], v3, s[32:35], s72 offen offset:2048 sc1
  buffer_load_dwordx4 v[172:175], v3, s[32:35], s72 offen offset:3072 sc1
  s_waitcnt vmcnt(26)
  v_max3_u32 v11, v64, v65, v66
  v_max3_u32 v11, v11, v67, v68
  v_max3_u32 v11, v11, v69, v70
  v_max_u32 v11, v11, v71
  v_cmp_eq_u32 vcc, -1, v11
  s_cbranch_vccz pok_231
  s_sleep 2
  s_sub_u32 s52, s52, 1
  s_cbranch_scc0 poll_230
  s_mov_b32 s54, 60
  s_branch k1_fail
pok_231:
go_224:
  buffer_load_dwordx4 v[56:59], v15, s[32:35], s62 offen sc1
  v_mfma_f32_16x16x32_bf16 v[24:27], a[0:3], v[64:67], 0
  v_mfma_f32_16x16x32_bf16 v[28:31], a[0:3], v[68:71], 0
  v_mfma_f32_16x16x32_bf16 v[32:35], a[56:59], v[64:67], 0
  s_waitcnt vmcnt(25)
  v_max3_u32 v11, v72, v73, v74
  v_mfma_f32_16x16x32_bf16 v[36:39], a[56:59], v[68:71], 0
  v_max3_u32 v11, v11, v75, v76
  v_mfma_f32_16x16x32_bf16 v[40:43], a[112:115], v[64:67], 0
  v_max3_u32 v11, v11, v77, v78
  v_mfma_f32_16x16x32_bf16 v[44:47], a[112:115], v[68:71], 0
  v_max_u32 v11, v11, v79
  v_mfma_f32_16x16x32_bf16 v[48:51], a[168:171], v[64:67], 0
  v_cmp_eq_u32 vcc, -1, v11
  v_mfma_f32_16x16x32_bf16 v[52:55], a[168:171], v[68:71], 0
  s_cbranch_vccnz rt_232
bk_233:
  v_mfma_f32_16x16x32_bf16 v[24:27], a[4:7], v[72:75], v[24:27]
  buffer_load_dwordx4 v[64:67], v3, s[32:35], s80 offen offset:0 sc1
  v_mfma_f32_16x16x32_bf16 v[28:31], a[4:7], v[76:79], v[28:31]
  buffer_load_dwordx4 v[68:71], v3, s[32:35], s80 offen offset:1024 sc1
  v_mfma_f32_16x16x32_bf16 v[32:35], a[60:63], v[72:75], v[32:35]
  s_waitcnt vmcnt(25)
  v_max3_u32 v11, v80, v81, v82
  v_mfma_f32_16x16x32_bf16 v[36:39], a[60:63], v[76:79], v[36:39]
  v_max3_u32 v11, v11, v83, v84
  v_mfma_f32_16x16x32_bf16 v[40:43], a[116:119], v[72:75], v[40:43]
  v_max3_u32 v11, v11, v85, v86
  v_mfma_f32_16x16x32_bf16 v[44:47], a[116:119], v[76:79], v[44:47]
  v_max_u32 v11, v11, v87
  v_mfma_f32_16x16x32_bf16 v[48:51], a[172:175], v[72:75], v[48:51]
  v_cmp_eq_u32 vcc, -1, v11
  v_mfma_f32_16x16x32_bf16 v[52:55], a[172:175], v[76:79], v[52:55]
  s_cbranch_vccnz rt_234
bk_235:
  v_mfma_f32_16x16x32_bf16 v[24:27], a[8:11], v[80:83], v[24:27]
  buffer_load_dwordx4 v[72:75], v3, s[32:35], s80 offen offset:2048 sc1
  v_mfma_f32_16x16x32_bf16 v[28:31], a[8:11], v[84:87], v[28:31]
  buffer_load_dwordx4 v[76:79], v3, s[32:35], s80 offen offset:3072 sc1
  v_mfma_f32_16x16x32_bf16 v[32:35], a[64:67], v[80:83], v[32:35]
  s_waitcnt vmcnt(25)
  v_max3_u32 v11, v88, v89, v90
  v_mfma_f32_16x16x32_bf16 v[36:39], a[64:67], v[84:87], v[36:39]
  v_max3_u32 v11, v11, v91, v92
  v_mfma_f32_16x16x32_bf16 v[40:43], a[120:123], v[80:83], v[40:43]
  v_max3_u32 v11, v11, v93, v94
  v_mfma_f32_16x16x32_bf16 v[44:47], a[120:123], v[84:87], v[44:47]
  v_max_u32 v11, v11, v95
  v_mfma_f32_16x16x32_bf16 v[48:51], a[176:179], v[80:83], v[48:51]
  v_cmp_eq_u32 vcc, -1, v11
  v_mfma_f32_16x16x32_bf16 v[52:55], a[176:179], v[84:87], v[52:55]
  s_cbranch_vccnz rt_236
bk_237:
  v_mfma_f32_16x16x32_bf16 v[24:27], a[12:15], v[88:91], v[24:27]
  buffer_load_dwordx4 v[80:83], v3, s[32:35], s81 offen offset:0 sc1
  v_mfma_f32_16x16x32_bf16 v[28:31], a[12:15], v[92:95], v[28:31]
  buffer_load_dwordx4 v[84:87], v3, s[32:35], s81 offen offset:1024 sc1
  v_mfma_f32_16x16x32_bf16 v[32:35], a[68:71], v[88:91], v[32:35]
  s_waitcnt vmcnt(25)
  v_max3_u32 v11, v96, v97, v98
  v_mfma_f32_16x16x32_bf16 v[36:39], a[68:71], v[92:95], v[36:39]
  v_max3_u32 v11, v11, v99, v100
  v_mfma_f32_16x16x32_bf16 v[40:43], a[124:127], v[88:91], v[40:43]
  v_max3_u32 v11, v11, v101, v102
  v_mfma_f32_16x16x32_bf16 v[44:47], a[124:127], v[92:95], v[44:47]
  v_max_u32 v11, v11, v103
  v_mfma_f32_16x16x32_bf16 v[48:51], a[180:183], v[88:91], v[48:51]
  v_cmp_eq_u32 vcc, -1, v11
  v_mfma_f32_16x16x32_bf16 v[52:55], a[180:183], v[92:95], v[52:55]
  s_cbranch_vccnz rt_238
bk_239:
  v_mfma_f32_16x16x32_bf16 v[24:27], a[16:19], v[96:99], v[24:27]
  buffer_load_dwordx4 v[88:91], v3, s[32:35], s81 offen offset:2048 sc1
  v_mfma_f32_16x16x32_bf16 v[28:31], a[16:19], v[100:103], v[28:31]
  buffer_load_dwordx4 v[92:95], v3, s[32:35], s81 offen offset:3072 sc1
  v_mfma_f32_16x16x32_bf16 v[32:35], a[72:75], v[96:99], v[32:35]
  s_waitcnt vmcnt(25)
  v_max3_u32 v11, v104, v105, v106
  v_mfma_f32_16x16x32_bf16 v[36:39], a[72:75], v[100:103], v[36:39]
  v_max3_u32 v11, v11, v107, v108
  v_mfma_f32_16x16x32_bf16 v[40:43], a[128:131], v[96:99], v[40:43]
  v_max3_u32 v11, v11, v109, v110
  v_mfma_f32_16x16x32_bf16 v[44:47], a[128:131], v[100:103], v[44:47]
  v_max_u32 v11, v11, v111
  v_mfma_f32_16x16x32_bf16 v[48:51], a[184:187], v[96:99], v[48:51]
  v_cmp_eq_u32 vcc, -1, v11
  v_mfma_f32_16x16x32_bf16 v[52:55], a[184:187], v[100:103], v[52:55]
  s_cbranch_vccnz rt_240
bk_241:
  v_mfma_f32_16x16x32_bf16 v[24:27], a[20:23], v[104:107], v[24:27]
  buffer_load_dwordx4 v[96:99], v3, s[32:35], s82 offen offset:0 sc1
  v_mfma_f32_16x16x32_bf16 v[28:31], a[20:23], v[108:111], v[28:31]
  buffer_load_dwordx4 v[100:103], v3, s[32:35], s82 offen offset:1024 sc1
  v_mfma_f32_16x16x32_bf16 v[32:35], a[76:79], v[104:107], v[32:35]
  s_waitcnt vmcnt(25)
  v_max3_u32 v11, v112, v113, v114
  v_mfma_f32_16x16x32_bf16 v[36:39], a[76:79], v[108:111], v[36:39]
  v_max3_u32 v11, v11, v115, v116
  v_mfma_f32_16x16x32_bf16 v[40:43], a[132:135], v[104:107], v[40:43]
  v_max3_u32 v11, v11, v117, v118
  v_mfma_f32_16x16x32_bf16 v[44:47], a[132:135], v[108:111], v[44:47]
  v_max_u32 v11, v11, v119
  v_mfma_f32_16x16x32_bf16 v[48:51], a[188:191], v[104:107], v[48:51]
  v_cmp_eq_u32 vcc, -1, v11
  v_mfma_f32_16x16x32_bf16 v[52:55], a[188:191], v[108:111], v[52:55]
  s_cbranch_vccnz rt_242
bk_243:
  v_mfma_f32_16x16x32_bf16 v[24:27], a[24:27], v[112:115], v[24:27]
  buffer_load_dwordx4 v[104:107], v3, s[32:35], s82 offen offset:2048 sc1
  v_mfma_f32_16x16x32_bf16 v[28:31], a[24:27], v[116:119], v[28:31]
  buffer_load_dwordx4 v[108:111], v3, s[32:35], s82 offen offset:3072 sc1
  v_mfma_f32_16x16x32_bf16 v[32:35], a[80:83], v[112:115], v[32:35]
  s_waitcnt vmcnt(25)
  v_max3_u32 v11, v120, v121, v122
  v_mfma_f32_16x16x32_bf16 v[36:39], a[80:83], v[116:119], v[36:39]
  v_max3_u32 v11, v11, v123, v124
  v_mfma_f32_16x16x32_bf16 v[40:43], a[136:139], v[112:115], v[40:43]
  v_max3_u32 v11, v11, v125, v126
  v_mfma_f32_16x16x32_bf16 v[44:47], a[136:139], v[116:119], v[44:47]
  v_max_u32 v11, v11, v127
  v_mfma_f32_16x16x32_bf16 v[48:51], a[192:195], v[112:115], v[48:51]
  v_cmp_eq_u32 vcc, -1, v11
  v_mfma_f32_16x16x32_bf16 v[52:55], a[192:195], v[116:119], v[52:55]
  s_cbranch_vccnz rt_244
bk_245:
  v_mfma_f32_16x16x32_bf16 v[24:27], a[28:31], v[120:123], v[24:27]
  buffer_load_dwordx4 v[112:115], v3, s[32:35], s83 offen offset:0 sc1
  v_mfma_f32_16x16x32_bf16 v[28:31], a[28:31], v[124:127], v[28:31]
  buffer_load_dwordx4 v[116:119], v3, s[32:35], s83 offen offset:1024 sc1
  v_mfma_f32_16x16x32_bf16 v[32:35], a[84:87], v[120:123], v[32:35]
  s_waitcnt vmcnt(25)
  v_max3_u32 v11, v128, v129, v130
  v_mfma_f32_16x16x32_bf16 v[36:39], a[84:87], v[124:127], v[36:39]
  v_max3_u32 v11, v11, v131, v132
  v_mfma_f32_16x16x32_bf16 v[40:43], a[140:143], v[120:123], v[40:43]
  v_max3_u32 v11, v11, v133, v134
  v_mfma_f32_16x16x32_bf16 v[44:47], a[140:143], v[124:127], v[44:47]
  v_max_u32 v11, v11, v135
  v_mfma_f32_16x16x32_bf16 v[48:51], a[196:199], v[120:123], v[48:51]
  v_cmp_eq_u32 vcc, -1, v11
  v_mfma_f32_16x16x32_bf16 v[52:55], a[196:199], v[124:127], v[52:55]
  s_cbranch_vccnz rt_246
bk_247:
  v_mfma_f32_16x16x32_bf16 v[24:27], a[32:35], v[128:131], v[24:27]
  buffer_load_dwordx4 v[120:123], v3, s[32:35], s83 offen offset:2048 sc1
  v_mfma_f32_16x16x32_bf16 v[28:31], a[32:35], v[132:135], v[28:31]
  buffer_load_dwordx4 v[124:127], v3, s[32:35], s83 offen offset:3072 sc1
  v_mfma_f32_16x16x32_bf16 v[32:35], a[88:91], v[128:131], v[32:35]
  s_waitcnt vmcnt(25)
  v_max3_u32 v11, v136, v137, v138
  v_mfma_f32_16x16x32_bf16 v[36:39], a[88:91], v[132:135], v[36:39]
  v_max3_u32 v11, v11, v139, v140
  v_mfma_f32_16x16x32_bf16 v[40:43], a[144:147], v[128:131], v[40:43]
  v_max3_u32 v11, v11, v141, v142
  v_mfma_f32_16x16x32_bf16 v[44:47], a[144:147], v[132:135], v[44:47]
  v_max_u32 v11, v11, v143
  v_mfma_f32_16x16x32_bf16 v[48:51], a[200:203], v[128:131], v[48:51]
  v_cmp_eq_u32 vcc, -1, v11
  v_mfma_f32_16x16x32_bf16 v[52:55], a[200:203], v[132:135], v[52:55]
  s_cbranch_vccnz rt_248
bk_249:
  v_mfma_f32_16x16x32_bf16 v[24:27], a[36:39], v[136:139], v[24:27]
  buffer_load_dwordx4 v[128:131], v3, s[32:35], s84 offen offset:0 sc1
  v_mfma_f32_16x16x32_bf16 v[28:31], a[36:39], v[140:143], v[28:31]
  buffer_load_dwordx4 v[132:135], v3, s[32:35], s84 offen offset:1024 sc1
  v_mfma_f32_16x16x32_bf16 v[32:35], a[92:95], v[136:139], v[32:35]
  s_waitcnt vmcnt(25)
  v_max3_u32 v11, v144, v145, v146
  v_mfma_f32_16x16x32_bf16 v[36:39], a[92:95], v[140:143], v[36:39]
  v_max3_u32 v11, v11, v147, v148
  v_mfma_f32_16x16x32_bf16 v[40:43], a[148:151], v[136:139], v[40:43]
  v_max3_u32 v11, v11, v149, v150
  v_mfma_f32_16x16x32_bf16 v[44:47], a[148:151], v[140:143], v[44:47]
  v_max_u32 v11, v11, v151
  v_mfma_f32_16x16x32_bf16 v[48:51], a[204:207], v[136:139], v[48:51]
  v_cmp_eq_u32 vcc, -1, v11
  v_mfma_f32_16x16x32_bf16 v[52:55], a[204:207], v[140:143], v[52:55]
  s_cbranch_vccnz rt_250
bk_251:
  v_mfma_f32_16x16x32_bf16 v[24:27], a[40:43], v[144:147], v[24:27]
  buffer_load_dwordx4 v[136:139], v3, s[32:35], s84 offen offset:2048 sc1
  v_mfma_f32_16x16x32_bf16 v[28:31], a[40:43], v[148:151], v[28:31]
  buffer_load_dwordx4 v[140:143], v3, s[32:35], s84 offen offset:3072 sc1
  v_mfma_f32_16x16x32_bf16 v[32:35], a[96:99], v[144:147], v[32:35]
  s_waitcnt vmcnt(25)
  v_max3_u32 v11, v152, v153, v154
  v_mfma_f32_16x16x32_bf16 v[36:39], a[96:99], v[148:151], v[36:39]
  v_max3_u32 v11, v11, v155, v156
  v_mfma_f32_16x16x32_bf16 v[40:43], a[152:155], v[144:147], v[40:43]
  v_max3_u32 v11, v11, v157, v158
  v_mfma_f32_16x16x32_bf16 v[44:47], a[152:155], v[148:151], v[44:47]
  v_max_u32 v11, v11, v159
  v_mfma_f32_16x16x32_bf16 v[48:51], a[208:211], v[144:147], v[48:51]
  v_cmp_eq_u32 vcc, -1, v11
  v_mfma_f32_16x16x32_bf16 v[52:55], a[208:211], v[148:151], v[52:55]
  s_cbranch_vccnz rt_252
bk_253:
  v_mfma_f32_16x16x32_bf16 v[24:27], a[44:47], v[152:155], v[24:27]
  buffer_load_dwordx4 v[144:147], v3, s[32:35], s85 offen offset:0 sc1
  v_mfma_f32_16x16x32_bf16 v[28:31], a[44:47], v[156:159], v[28:31]
  buffer_load_dwordx4 v[148:151], v3, s[32:35], s85 offen offset:1024 sc1
  v_mfma_f32_16x16x32_bf16 v[32:35], a[100:103], v[152:155], v[32:35]
  s_waitcnt vmcnt(25)
  v_max3_u32 v11, v160, v161, v162
  v_mfma_f32_16x16x32_bf16 v[36:39], a[100:103], v[156:159], v[36:39]
  v_max3_u32 v11, v11, v163, v164
  v_mfma_f32_16x16x32_bf16 v[40:43], a[156:159], v[152:155], v[40:43]
  v_max3_u32 v11, v11, v165, v166
  v_mfma_f32_16x16x32_bf16 v[44:47], a[156:159], v[156:159], v[44:47]
  v_max_u32 v11, v11, v167
  v_mfma_f32_16x16x32_bf16 v[48:51], a[212:215], v[152:155], v[48:51]
  v_cmp_eq_u32 vcc, -1, v11
  v_mfma_f32_16x16x32_bf16 v[52:55], a[212:215], v[156:159], v[52:55]
  s_cbranch_vccnz rt_254
bk_255:
  v_mfma_f32_16x16x32_bf16 v[24:27], a[48:51], v[160:163], v[24:27]
  buffer_load_dwordx4 v[152:155], v3, s[32:35], s85 offen offset:2048 sc1
  v_mfma_f32_16x16x32_bf16 v[28:31], a[48:51], v[164:167], v[28:31]
  buffer_load_dwordx4 v[156:159], v3, s[32:35], s85 offen offset:3072 sc1
  v_mfma_f32_16x16x32_bf16 v[32:35], a[104:107], v[160:163], v[32:35]
  s_waitcnt vmcnt(25)
  v_max3_u32 v11, v168, v169, v170
  v_mfma_f32_16x16x32_bf16 v[36:39], a[104:107], v[164:167], v[36:39]
  v_max3_u32 v11, v11, v171, v172
  v_mfma_f32_16x16x32_bf16 v[40:43], a[160:163], v[160:163], v[40:43]
  v_max3_u32 v11, v11, v173, v174
  v_mfma_f32_16x16x32_bf16 v[44:47], a[160:163], v[164:167], v[44:47]
  v_max_u32 v11, v11, v175
  v_mfma_f32_16x16x32_bf16 v[48:51], a[216:219], v[160:163], v[48:51]
  v_cmp_eq_u32 vcc, -1, v11
  v_mfma_f32_16x16x32_bf16 v[52:55], a[216:219], v[164:167], v[52:55]
  s_cbranch_vccnz rt_256
bk_257:
  v_mfma_f32_16x16x32_bf16 v[24:27], a[52:55], v[168:171], v[24:27]
  buffer_load_dwordx4 v[160:163], v3, s[32:35], s86 offen offset:0 sc1
  v_mfma_f32_16x16x32_bf16 v[28:31], a[52:55], v[172:175], v[28:31]
  buffer_load_dwordx4 v[164:167], v3, s[32:35], s86 offen offset:1024 sc1
  v_mfma_f32_16x16x32_bf16 v[32:35], a[108:111], v[168:171], v[32:35]
  v_mfma_f32_16x16x32_bf16 v[36:39], a[108:111], v[172:175], v[36:39]
  v_mfma_f32_16x16x32_bf16 v[40:43], a[164:167], v[168:171], v[40:43]
  v_mfma_f32_16x16x32_bf16 v[44:47], a[164:167], v[172:175], v[44:47]
  v_mfma_f32_16x16x32_bf16 v[48:51], a[220:223], v[168:171], v[48:51]
  v_mfma_f32_16x16x32_bf16 v[52:55], a[220:223], v[172:175], v[52:55]
  buffer_load_dwordx4 v[168:171], v3, s[32:35], s86 offen offset:2048 sc1
  buffer_load_dwordx4 v[172:175], v3, s[32:35], s86 offen offset:3072 sc1
  s_mov_b32 s66, s80
  s_add_u32 s80, s80, 638976
  s_mov_b32 s67, s81
  s_add_u32 s81, s81, 638976
  s_mov_b32 s68, s82
  s_add_u32 s82, s82, 638976
  s_mov_b32 s69, s83
  s_add_u32 s83, s83, 638976
  s_mov_b32 s70, s84
  s_add_u32 s84, s84, 638976
  s_mov_b32 s71, s85
  s_add_u32 s85, s85, 638976
  s_mov_b32 s72, s86
  s_add_u32 s86, s86, 638976
  s_add_u32 s44, s61, 1
  s_and_b32 s44, s44, 7
  s_cmp_eq_u32 s44, 0
  s_cbranch_scc0 ng_258
  v_readfirstlane_b32 s44, v212
  s_nop 0
  s_cmp_eq_u32 s44, 96
  s_cbranch_scc1 ng_258
  buffer_load_dword v212, off, s[32:35], s57 sc1
  s_waitcnt vmcnt(0)
  v_mov_b32 v64, -1
ng_258:
  ds_write_b128 v13, v[24:27] offset:0
  ds_write_b128 v13, v[28:31] offset:1024
  ds_write_b128 v13, v[32:35] offset:2048
  ds_write_b128 v13, v[36:39] offset:3072
  ds_write_b128 v13, v[40:43] offset:4096
  ds_write_b128 v13, v[44:47] offset:5120
  ds_write_b128 v13, v[48:51] offset:6144
  ds_write_b128 v13, v[52:55] offset:7168
  s_waitcnt vmcnt(28) lgkmcnt(0)
  s_barrier
  ds_read_b128 v[176:179], v14 offset:0
  ds_read_b128 v[180:183], v14 offset:8192
  ds_read_b128 v[184:187], v14 offset:16384
  ds_read_b128 v[188:191], v14 offset:24576
  ds_read_b128 v[192:195], v14 offset:2048
  ds_read_b128 v[196:199], v14 offset:10240
  ds_read_b128 v[200:203], v14 offset:18432
  ds_read_b128 v[204:207], v14 offset:26624
  v_lshlrev_b32 v224, 16, v56
  v_and_b32 v225, 0xffff0000, v56
  v_lshlrev_b32 v226, 16, v57
  v_and_b32 v227, 0xffff0000, v57
  v_lshlrev_b32 v228, 16, v58
  v_and_b32 v229, 0xffff0000, v58
  v_lshlrev_b32 v230, 16, v59
  v_and_b32 v231, 0xffff0000, v59
  s_waitcnt lgkmcnt(4)
  v_pk_add_f32 v[176:177], v[176:177], v[180:181]
  v_pk_add_f32 v[184:185], v[184:185], v[188:189]
  v_pk_add_f32 v[178:179], v[178:179], v[182:183]
  v_pk_add_f32 v[186:187], v[186:187], v[190:191]
  v_pk_add_f32 v[176:177], v[176:177], v[184:185]
  v_pk_add_f32 v[178:179], v[178:179], v[186:187]
  v_pk_add_f32 v[224:225], v[224:225], v[176:177]
  v_pk_add_f32 v[226:227], v[226:227], v[178:179]
  s_waitcnt lgkmcnt(0)
  v_pk_add_f32 v[192:193], v[192:193], v[196:197]
  v_pk_add_f32 v[200:201], v[200:201], v[204:205]
  v_pk_add_f32 v[194:195], v[194:195], v[198:199]
  v_pk_add_f32 v[202:203], v[202:203], v[206:207]
  v_pk_add_f32 v[192:193], v[192:193], v[200:201]
  v_pk_add_f32 v[194:195], v[194:195], v[202:203]
  v_pk_add_f32 v[228:229], v[228:229], v[192:193]
  v_pk_add_f32 v[230:231], v[230:231], v[194:195]
  s_cmp_eq_u32 s58, 0
  s_cbranch_scc0 last_260
  s_mul_i32 s62, s61, 638976
  s_add_u32 s62, s62, 80191488
  s_mul_i32 s63, s61, 638976
  s_add_u32 s63, s63, 80228352
  v_cvt_pk_bf16_f32 v236, v224, v225
  v_cvt_pk_bf16_f32 v237, v226, v227
  v_cvt_pk_bf16_f32 v238, v228, v229
  v_cvt_pk_bf16_f32 v239, v230, v231
  v_min_u32 v236, -2, v236
  v_min_u32 v237, -2, v237
  v_min_u32 v238, -2, v238
  v_min_u32 v239, -2, v239
  buffer_store_dwordx4 v[236:239], v15, s[32:35], s62 offen sc1
  v_add_f32 v232, v224, v225
  v_add_f32 v233, v226, v227
  v_add_f32 v234, v228, v229
  v_add_f32 v235, v230, v231
  v_add_f32 v232, v232, v233
  v_add_f32 v234, v234, v235
  v_add_f32 v232, v232, v234
  v_mov_b32 v234, v232
  s_nop 1
  v_permlane16_swap_b32 v232, v234
  v_add_f32 v232, v232, v234
  v_mov_b32 v234, v232
  s_nop 1
  v_permlane32_swap_b32 v232, v234
  v_add_f32 v232, v232, v234
  v_mul_f32 v232, 0x3d000000, v232
  v_sub_f32 v224, v224, v232
  v_sub_f32 v225, v225, v232
  v_sub_f32 v226, v226, v232
  v_sub_f32 v227, v227, v232
  v_sub_f32 v228, v228, v232
  v_sub_f32 v229, v229, v232
  v_sub_f32 v230, v230, v232
  v_sub_f32 v231, v231, v232
  v_mul_f32 v233, v224, v224
  v_mul_f32 v235, v225, v225
  v_fmac_f32 v233, v226, v226
  v_fmac_f32 v235, v227, v227
  v_fmac_f32 v233, v228, v228
  v_fmac_f32 v235, v229, v229
  v_fmac_f32 v233, v230, v230
  v_fmac_f32 v235, v231, v231
  v_add_f32 v233, v233, v235
  v_mov_b32 v234, v233
  s_nop 1
  v_permlane16_swap_b32 v233, v234
  v_add_f32 v233, v233, v234
  v_mov_b32 v234, v233
  s_nop 1
  v_permlane32_swap_b32 v233, v234
  v_add_f32 v233, v233, v234
  v_min_u32 v232, -2, v232
  v_min_u32 v233, -2, v233
  buffer_store_dwordx2 v[232:233], v16, s[32:35], s63 offen sc1
  s_branch noepi_259
last_260:
  v_cvt_pk_bf16_f32 v232, v224, v225
  v_cvt_pk_bf16_f32 v233, v226, v227
  v_cvt_pk_bf16_f32 v234, v228, v229
  v_cvt_pk_bf16_f32 v235, v230, v231
  s_mul_i32 s44, s61, 28672
  buffer_store_dwordx4 v[232:235], v17, s[40:43], s44 offen
noepi_259:
  v_xor_b32 v13, 0x8000, v13
  v_xor_b32 v14, 0x8000, v14
  s_add_u32 s61, s61, 1
  s_cmp_lt_u32 s61, 64
  s_cbranch_scc1 f2_223
  s_endpgm
rt_232:
  s_mov_b32 s52, 60000
poll_261:
  buffer_load_dword v11, v213, s[32:35], s66 offen sc1
  s_waitcnt vmcnt(0)
  v_cmp_eq_u32 vcc, -1, v11
  s_cbranch_vccz pok_262
  s_sleep 2
  s_sub_u32 s52, s52, 1
  s_cbranch_scc0 poll_261
  s_mov_b32 s54, 65
  s_branch k1_fail
pok_262:
  s_mov_b32 s52, 60000
poll_263:
  buffer_load_dwordx4 v[72:75], v3, s[32:35], s66 offen offset:2048 sc1
  buffer_load_dwordx4 v[76:79], v3, s[32:35], s66 offen offset:3072 sc1
  buffer_load_dwordx4 v[80:83], v3, s[32:35], s67 offen offset:0 sc1
  buffer_load_dwordx4 v[84:87], v3, s[32:35], s67 offen offset:1024 sc1
  buffer_load_dwordx4 v[88:91], v3, s[32:35], s67 offen offset:2048 sc1
  buffer_load_dwordx4 v[92:95], v3, s[32:35], s67 offen offset:3072 sc1
  buffer_load_dwordx4 v[96:99], v3, s[32:35], s68 offen offset:0 sc1
  buffer_load_dwordx4 v[100:103], v3, s[32:35], s68 offen offset:1024 sc1
  buffer_load_dwordx4 v[104:107], v3, s[32:35], s68 offen offset:2048 sc1
  buffer_load_dwordx4 v[108:111], v3, s[32:35], s68 offen offset:3072 sc1
  buffer_load_dwordx4 v[112:115], v3, s[32:35], s69 offen offset:0 sc1
  buffer_load_dwordx4 v[116:119], v3, s[32:35], s69 offen offset:1024 sc1
  buffer_load_dwordx4 v[120:123], v3, s[32:35], s69 offen offset:2048 sc1
  buffer_load_dwordx4 v[124:127], v3, s[32:35], s69 offen offset:3072 sc1
  buffer_load_dwordx4 v[128:131], v3, s[32:35], s70 offen offset:0 sc1
  buffer_load_dwordx4 v[132:135], v3, s[32:35], s70 offen offset:1024 sc1
  buffer_load_dwordx4 v[136:139], v3, s[32:35], s70 offen offset:2048 sc1
  buffer_load_dwordx4 v[140:143], v3, s[32:35], s70 offen offset:3072 sc1
  buffer_load_dwordx4 v[144:147], v3, s[32:35], s71 offen offset:0 sc1
  buffer_load_dwordx4 v[148:151], v3, s[32:35], s71 offen offset:1024 sc1
  buffer_load_dwordx4 v[152:155], v3, s[32:35], s71 offen offset:2048 sc1
  buffer_load_dwordx4 v[156:159], v3, s[32:35], s71 offen offset:3072 sc1
  buffer_load_dwordx4 v[160:163], v3, s[32:35], s72 offen offset:0 sc1
  buffer_load_dwordx4 v[164:167], v3, s[32:35], s72 offen offset:1024 sc1
  buffer_load_dwordx4 v[168:171], v3, s[32:35], s72 offen offset:2048 sc1
  buffer_load_dwordx4 v[172:175], v3, s[32:35], s72 offen offset:3072 sc1
  s_waitcnt vmcnt(0)
  v_max3_u32 v11, v72, v73, v74
  v_max3_u32 v11, v11, v75, v76
  v_max3_u32 v11, v11, v77, v78
  v_max3_u32 v11, v11, v79, v80
  v_max3_u32 v11, v11, v81, v82
  v_max3_u32 v11, v11, v83, v84
  v_max3_u32 v11, v11, v85, v86
  v_max3_u32 v11, v11, v87, v88
  v_max3_u32 v11, v11, v89, v90
  v_max3_u32 v11, v11, v91, v92
  v_max3_u32 v11, v11, v93, v94
  v_max3_u32 v11, v11, v95, v96
  v_max3_u32 v11, v11, v97, v98
  v_max3_u32 v11, v11, v99, v100
  v_max3_u32 v11, v11, v101, v102
  v_max3_u32 v11, v11, v103, v104
  v_max3_u32 v11, v11, v105, v106
  v_max3_u32 v11, v11, v107, v108
  v_max3_u32 v11, v11, v109, v110
  v_max3_u32 v11, v11, v111, v112
  v_max3_u32 v11, v11, v113, v114
  v_max3_u32 v11, v11, v115, v116
  v_max3_u32 v11, v11, v117, v118
  v_max3_u32 v11, v11, v119, v120
  v_max3_u32 v11, v11, v121, v122
  v_max3_u32 v11, v11, v123, v124
  v_max3_u32 v11, v11, v125, v126
  v_max3_u32 v11, v11, v127, v128
  v_max3_u32 v11, v11, v129, v130
  v_max3_u32 v11, v11, v131, v132
  v_max3_u32 v11, v11, v133, v134
  v_max3_u32 v11, v11, v135, v136
  v_max3_u32 v11, v11, v137, v138
  v_max3_u32 v11, v11, v139, v140
  v_max3_u32 v11, v11, v141, v142
  v_max3_u32 v11, v11, v143, v144
  v_max3_u32 v11, v11, v145, v146
  v_max3_u32 v11, v11, v147, v148
  v_max3_u32 v11, v11, v149, v150
  v_max3_u32 v11, v11, v151, v152
  v_max3_u32 v11, v11, v153, v154
  v_max3_u32 v11, v11, v155, v156
  v_max3_u32 v11, v11, v157, v158
  v_max3_u32 v11, v11, v159, v160
  v_max3_u32 v11, v11, v161, v162
  v_max3_u32 v11, v11, v163, v164
  v_max3_u32 v11, v11, v165, v166
  v_max3_u32 v11, v11, v167, v168
  v_max3_u32 v11, v11, v169, v170
  v_max3_u32 v11, v11, v171, v172
  v_max3_u32 v11, v11, v173, v174
  v_max_u32 v11, v11, v175
  v_cmp_eq_u32 vcc, -1, v11
  s_cbranch_vccz pok_264
  s_sleep 2
  s_sub_u32 s52, s52, 1
  s_cbranch_scc0 poll_263
  s_mov_b32 s54, 63
  s_branch k1_fail
pok_264:
  s_branch bk_233
rt_234:
  s_mov_b32 s52, 60000
poll_265:
  buffer_load_dword v11, v213, s[32:35], s66 offen sc1
  s_waitcnt vmcnt(0)
  v_cmp_eq_u32 vcc, -1, v11
  s_cbranch_vccz pok_266
  s_sleep 2
  s_sub_u32 s52, s52, 1
  s_cbranch_scc0 poll_265
  s_mov_b32 s54, 65
  s_branch k1_fail
pok_266:
  s_mov_b32 s52, 60000
poll_267:
  buffer_load_dwordx4 v[80:83], v3, s[32:35], s67 offen offset:0 sc1
  buffer_load_dwordx4 v[84:87], v3, s[32:35], s67 offen offset:1024 sc1
  buffer_load_dwordx4 v[88:91], v3, s[32:35], s67 offen offset:2048 sc1
  buffer_load_dwordx4 v[92:95], v3, s[32:35], s67 offen offset:3072 sc1
  buffer_load_dwordx4 v[96:99], v3, s[32:35], s68 offen offset:0 sc1
  buffer_load_dwordx4 v[100:103], v3, s[32:35], s68 offen offset:1024 sc1
  buffer_load_dwordx4 v[104:107], v3, s[32:35], s68 offen offset:2048 sc1
  buffer_load_dwordx4 v[108:111], v3, s[32:35], s68 offen offset:3072 sc1
  buffer_load_dwordx4 v[112:115], v3, s[32:35], s69 offen offset:0 sc1
  buffer_load_dwordx4 v[116:119], v3, s[32:35], s69 offen offset:1024 sc1
  buffer_load_dwordx4 v[120:123], v3, s[32:35], s69 offen offset:2048 sc1
  buffer_load_dwordx4 v[124:127], v3, s[32:35], s69 offen offset:3072 sc1
  buffer_load_dwordx4 v[128:131], v3, s[32:35], s70 offen offset:0 sc1
  buffer_load_dwordx4 v[132:135], v3, s[32:35], s70 offen offset:1024 sc1
  buffer_load_dwordx4 v[136:139], v3, s[32:35], s70 offen offset:2048 sc1
  buffer_load_dwordx4 v[140:143], v3, s[32:35], s70 offen offset:3072 sc1
  buffer_load_dwordx4 v[144:147], v3, s[32:35], s71 offen offset:0 sc1
  buffer_load_dwordx4 v[148:151], v3, s[32:35], s71 offen offset:1024 sc1
  buffer_load_dwordx4 v[152:155], v3, s[32:35], s71 offen offset:2048 sc1
  buffer_load_dwordx4 v[156:159], v3, s[32:35], s71 offen offset:3072 sc1
  buffer_load_dwordx4 v[160:163], v3, s[32:35], s72 offen offset:0 sc1
  buffer_load_dwordx4 v[164:167], v3, s[32:35], s72 offen offset:1024 sc1
  buffer_load_dwordx4 v[168:171], v3, s[32:35], s72 offen offset:2048 sc1
  buffer_load_dwordx4 v[172:175], v3, s[32:35], s72 offen offset:3072 sc1
  s_waitcnt vmcnt(0)
  v_max3_u32 v11, v80, v81, v82
  v_max3_u32 v11, v11, v83, v84
  v_max3_u32 v11, v11, v85, v86
  v_max3_u32 v11, v11, v87, v88
  v_max3_u32 v11, v11, v89, v90
  v_max3_u32 v11, v11, v91, v92
  v_max3_u32 v11, v11, v93, v94
  v_max3_u32 v11, v11, v95, v96
  v_max3_u32 v11, v11, v97, v98
  v_max3_u32 v11, v11, v99, v100
  v_max3_u32 v11, v11, v101, v102
  v_max3_u32 v11, v11, v103, v104
  v_max3_u32 v11, v11, v105, v106
  v_max3_u32 v11, v11, v107, v108
  v_max3_u32 v11, v11, v109, v110
  v_max3_u32 v11, v11, v111, v112
  v_max3_u32 v11, v11, v113, v114
  v_max3_u32 v11, v11, v115, v116
  v_max3_u32 v11, v11, v117, v118
  v_max3_u32 v11, v11, v119, v120
  v_max3_u32 v11, v11, v121, v122
  v_max3_u32 v11, v11, v123, v124
  v_max3_u32 v11, v11, v125, v126
  v_max3_u32 v11, v11, v127, v128
  v_max3_u32 v11, v11, v129, v130
  v_max3_u32 v11, v11, v131, v132
  v_max3_u32 v11, v11, v133, v134
  v_max3_u32 v11, v11, v135, v136
  v_max3_u32 v11, v11, v137, v138
  v_max3_u32 v11, v11, v139, v140
  v_max3_u32 v11, v11, v141, v142
  v_max3_u32 v11, v11, v143, v144
  v_max3_u32 v11, v11, v145, v146
  v_max3_u32 v11, v11, v147, v148
  v_max3_u32 v11, v11, v149, v150
  v_max3_u32 v11, v11, v151, v152
  v_max3_u32 v11, v11, v153, v154
  v_max3_u32 v11, v11, v155, v156
  v_max3_u32 v11, v11, v157, v158
  v_max3_u32 v11, v11, v159, v160
  v_max3_u32 v11, v11, v161, v162
  v_max3_u32 v11, v11, v163, v164
  v_max3_u32 v11, v11, v165, v166
  v_max3_u32 v11, v11, v167, v168
  v_max3_u32 v11, v11, v169, v170
  v_max3_u32 v11, v11, v171, v172
  v_max3_u32 v11, v11, v173, v174
  v_max_u32 v11, v11, v175
  v_cmp_eq_u32 vcc, -1, v11
  s_cbranch_vccz pok_268
  s_sleep 2
  s_sub_u32 s52, s52, 1
  s_cbranch_scc0 poll_267
  s_mov_b32 s54, 63
  s_branch k1_fail
pok_268:
  s_branch bk_235
rt_236:
  s_mov_b32 s52, 60000
poll_269:
  buffer_load_dword v11, v213, s[32:35], s66 offen sc1
  s_waitcnt vmcnt(0)
  v_cmp_eq_u32 vcc, -1, v11
  s_cbranch_vccz pok_270
  s_sleep 2
  s_sub_u32 s52, s52, 1
  s_cbranch_scc0 poll_269
  s_mov_b32 s54, 65
  s_branch k1_fail
pok_270:
  s_mov_b32 s52, 60000
poll_271:
  buffer_load_dwordx4 v[88:91], v3, s[32:35], s67 offen offset:2048 sc1
  buffer_load_dwordx4 v[92:95], v3, s[32:35], s67 offen offset:3072 sc1
  buffer_load_dwordx4 v[96:99], v3, s[32:35], s68 offen offset:0 sc1
  buffer_load_dwordx4 v[100:103], v3, s[32:35], s68 offen offset:1024 sc1
  buffer_load_dwordx4 v[104:107], v3, s[32:35], s68 offen offset:2048 sc1
  buffer_load_dwordx4 v[108:111], v3, s[32:35], s68 offen offset:3072 sc1
  buffer_load_dwordx4 v[112:115], v3, s[32:35], s69 offen offset:0 sc1
  buffer_load_dwordx4 v[116:119], v3, s[32:35], s69 offen offset:1024 sc1
  buffer_load_dwordx4 v[120:123], v3, s[32:35], s69 offen offset:2048 sc1
  buffer_load_dwordx4 v[124:127], v3, s[32:35], s69 offen offset:3072 sc1
  buffer_load_dwordx4 v[128:131], v3, s[32:35], s70 offen offset:0 sc1
  buffer_load_dwordx4 v[132:135], v3, s[32:35], s70 offen offset:1024 sc1
  buffer_load_dwordx4 v[136:139], v3, s[32:35], s70 offen offset:2048 sc1
  buffer_load_dwordx4 v[140:143], v3, s[32:35], s70 offen offset:3072 sc1
  buffer_load_dwordx4 v[144:147], v3, s[32:35], s71 offen offset:0 sc1
  buffer_load_dwordx4 v[148:151], v3, s[32:35], s71 offen offset:1024 sc1
  buffer_load_dwordx4 v[152:155], v3, s[32:35], s71 offen offset:2048 sc1
  buffer_load_dwordx4 v[156:159], v3, s[32:35], s71 offen offset:3072 sc1
  buffer_load_dwordx4 v[160:163], v3, s[32:35], s72 offen offset:0 sc1
  buffer_load_dwordx4 v[164:167], v3, s[32:35], s72 offen offset:1024 sc1
  buffer_load_dwordx4 v[168:171], v3, s[32:35], s72 offen offset:2048 sc1
  buffer_load_dwordx4 v[172:175], v3, s[32:35], s72 offen offset:3072 sc1
  s_waitcnt vmcnt(0)
  v_max3_u32 v11, v88, v89, v90
  v_max3_u32 v11, v11, v91, v92
  v_max3_u32 v11, v11, v93, v94
  v_max3_u32 v11, v11, v95, v96
  v_max3_u32 v11, v11, v97, v98
  v_max3_u32 v11, v11, v99, v100
  v_max3_u32 v11, v11, v101, v102
  v_max3_u32 v11, v11, v103, v104
  v_max3_u32 v11, v11, v105, v106
  v_max3_u32 v11, v11, v107, v108
  v_max3_u32 v11, v11, v109, v110
  v_max3_u32 v11, v11, v111, v112
  v_max3_u32 v11, v11, v113, v114
  v_max3_u32 v11, v11, v115, v116
  v_max3_u32 v11, v11, v117, v118
  v_max3_u32 v11, v11, v119, v120
  v_max3_u32 v11, v11, v121, v122
  v_max3_u32 v11, v11, v123, v124
  v_max3_u32 v11, v11, v125, v126
  v_max3_u32 v11, v11, v127, v128
  v_max3_u32 v11, v11, v129, v130
  v_max3_u32 v11, v11, v131, v132
  v_max3_u32 v11, v11, v133, v134
  v_max3_u32 v11, v11, v135, v136
  v_max3_u32 v11, v11, v137, v138
  v_max3_u32 v11, v11, v139, v140
  v_max3_u32 v11, v11, v141, v142
  v_max3_u32 v11, v11, v143, v144
  v_max3_u32 v11, v11, v145, v146
  v_max3_u32 v11, v11, v147, v148
  v_max3_u32 v11, v11, v149, v150
  v_max3_u32 v11, v11, v151, v152
  v_max3_u32 v11, v11, v153, v154
  v_max3_u32 v11, v11, v155, v156
  v_max3_u32 v11, v11, v157, v158
  v_max3_u32 v11, v11, v159, v160
  v_max3_u32 v11, v11, v161, v162
  v_max3_u32 v11, v11, v163, v164
  v_max3_u32 v11, v11, v165, v166
  v_max3_u32 v11, v11, v167, v168
  v_max3_u32 v11, v11, v169, v170
  v_max3_u32 v11, v11, v171, v172
  v_max3_u32 v11, v11, v173, v174
  v_max_u32 v11, v11, v175
  v_cmp_eq_u32 vcc, -1, v11
  s_cbranch_vccz pok_272
  s_sleep 2
  s_sub_u32 s52, s52, 1
  s_cbranch_scc0 poll_271
  s_mov_b32 s54, 63
  s_branch k1_fail
pok_272:
  s_branch bk_237
rt_238:
  s_mov_b32 s52, 60000
poll_273:
  buffer_load_dword v11, v213, s[32:35], s66 offen sc1
  s_waitcnt vmcnt(0)
  v_cmp_eq_u32 vcc, -1, v11
  s_cbranch_vccz pok_274
  s_sleep 2
  s_sub_u32 s52, s52, 1
  s_cbranch_scc0 poll_273
  s_mov_b32 s54, 65
  s_branch k1_fail
pok_274:
  s_mov_b32 s52, 60000
poll_275:
  buffer_load_dwordx4 v[96:99], v3, s[32:35], s68 offen offset:0 sc1
  buffer_load_dwordx4 v[100:103], v3, s[32:35], s68 offen offset:1024 sc1
  buffer_load_dwordx4 v[104:107], v3, s[32:35], s68 offen offset:2048 sc1
  buffer_load_dwordx4 v[108:111], v3, s[32:35], s68 offen offset:3072 sc1
  buffer_load_dwordx4 v[112:115], v3, s[32:35], s69 offen offset:0 sc1
  buffer_load_dwordx4 v[116:119], v3, s[32:35], s69 offen offset:1024 sc1
  buffer_load_dwordx4 v[120:123], v3, s[32:35], s69 offen offset:2048 sc1
  buffer_load_dwordx4 v[124:127], v3, s[32:35], s69 offen offset:3072 sc1
  buffer_load_dwordx4 v[128:131], v3, s[32:35], s70 offen offset:0 sc1
  buffer_load_dwordx4 v[132:135], v3, s[32:35], s70 offen offset:1024 sc1
  buffer_load_dwordx4 v[136:139], v3, s[32:35], s70 offen offset:2048 sc1
  buffer_load_dwordx4 v[140:143], v3, s[32:35], s70 offen offset:3072 sc1
  buffer_load_dwordx4 v[144:147], v3, s[32:35], s71 offen offset:0 sc1
  buffer_load_dwordx4 v[148:151], v3, s[32:35], s71 offen offset:1024 sc1
  buffer_load_dwordx4 v[152:155], v3, s[32:35], s71 offen offset:2048 sc1
  buffer_load_dwordx4 v[156:159], v3, s[32:35], s71 offen offset:3072 sc1
  buffer_load_dwordx4 v[160:163], v3, s[32:35], s72 offen offset:0 sc1
  buffer_load_dwordx4 v[164:167], v3, s[32:35], s72 offen offset:1024 sc1
  buffer_load_dwordx4 v[168:171], v3, s[32:35], s72 offen offset:2048 sc1
  buffer_load_dwordx4 v[172:175], v3, s[32:35], s72 offen offset:3072 sc1
  s_waitcnt vmcnt(0)
  v_max3_u32 v11, v96, v97, v98
  v_max3_u32 v11, v11, v99, v100
  v_max3_u32 v11, v11, v101, v102
  v_max3_u32 v11, v11, v103, v104
  v_max3_u32 v11, v11, v105, v106
  v_max3_u32 v11, v11, v107, v108
  v_max3_u32 v11, v11, v109, v110
  v_max3_u32 v11, v11, v111, v112
  v_max3_u32 v11, v11, v113, v114
  v_max3_u32 v11, v11, v115, v116
  v_max3_u32 v11, v11, v117, v118
  v_max3_u32 v11, v11, v119, v120
  v_max3_u32 v11, v11, v121, v122
  v_max3_u32 v11, v11, v123, v124
  v_max3_u32 v11, v11, v125, v126
  v_max3_u32 v11, v11, v127, v128
  v_max3_u32 v11, v11, v129, v130
  v_max3_u32 v11, v11, v131, v132
  v_max3_u32 v11, v11, v133, v134
  v_max3_u32 v11, v11, v135, v136
  v_max3_u32 v11, v11, v137, v138
  v_max3_u32 v11, v11, v139, v140
  v_max3_u32 v11, v11, v141, v142
  v_max3_u32 v11, v11, v143, v144
  v_max3_u32 v11, v11, v145, v146
  v_max3_u32 v11, v11, v147, v148
  v_max3_u32 v11, v11, v149, v150
  v_max3_u32 v11, v11, v151, v152
  v_max3_u32 v11, v11, v153, v154
  v_max3_u32 v11, v11, v155, v156
  v_max3_u32 v11, v11, v157, v158
  v_max3_u32 v11, v11, v159, v160
  v_max3_u32 v11, v11, v161, v162
  v_max3_u32 v11, v11, v163, v164
  v_max3_u32 v11, v11, v165, v166
  v_max3_u32 v11, v11, v167, v168
  v_max3_u32 v11, v11, v169, v170
  v_max3_u32 v11, v11, v171, v172
  v_max3_u32 v11, v11, v173, v174
  v_max_u32 v11, v11, v175
  v_cmp_eq_u32 vcc, -1, v11
  s_cbranch_vccz pok_276
  s_sleep 2
  s_sub_u32 s52, s52, 1
  s_cbranch_scc0 poll_275
  s_mov_b32 s54, 63
  s_branch k1_fail
pok_276:
  s_branch bk_239
rt_240:
  s_mov_b32 s52, 60000
poll_277:
  buffer_load_dword v11, v213, s[32:35], s66 offen sc1
  s_waitcnt vmcnt(0)
  v_cmp_eq_u32 vcc, -1, v11
  s_cbranch_vccz pok_278
  s_sleep 2
  s_sub_u32 s52, s52, 1
  s_cbranch_scc0 poll_277
  s_mov_b32 s54, 65
  s_branch k1_fail
pok_278:
  s_mov_b32 s52, 60000
poll_279:
  buffer_load_dwordx4 v[104:107], v3, s[32:35], s68 offen offset:2048 sc1
  buffer_load_dwordx4 v[108:111], v3, s[32:35], s68 offen offset:3072 sc1
  buffer_load_dwordx4 v[112:115], v3, s[32:35], s69 offen offset:0 sc1
  buffer_load_dwordx4 v[116:119], v3, s[32:35], s69 offen offset:1024 sc1
  buffer_load_dwordx4 v[120:123], v3, s[32:35], s69 offen offset:2048 sc1
  buffer_load_dwordx4 v[124:127], v3, s[32:35], s69 offen offset:3072 sc1
  buffer_load_dwordx4 v[128:131], v3, s[32:35], s70 offen offset:0 sc1
  buffer_load_dwordx4 v[132:135], v3, s[32:35], s70 offen offset:1024 sc1
  buffer_load_dwordx4 v[136:139], v3, s[32:35], s70 offen offset:2048 sc1
  buffer_load_dwordx4 v[140:143], v3, s[32:35], s70 offen offset:3072 sc1
  buffer_load_dwordx4 v[144:147], v3, s[32:35], s71 offen offset:0 sc1
  buffer_load_dwordx4 v[148:151], v3, s[32:35], s71 offen offset:1024 sc1
  buffer_load_dwordx4 v[152:155], v3, s[32:35], s71 offen offset:2048 sc1
  buffer_load_dwordx4 v[156:159], v3, s[32:35], s71 offen offset:3072 sc1
  buffer_load_dwordx4 v[160:163], v3, s[32:35], s72 offen offset:0 sc1
  buffer_load_dwordx4 v[164:167], v3, s[32:35], s72 offen offset:1024 sc1
  buffer_load_dwordx4 v[168:171], v3, s[32:35], s72 offen offset:2048 sc1
  buffer_load_dwordx4 v[172:175], v3, s[32:35], s72 offen offset:3072 sc1
  s_waitcnt vmcnt(0)
  v_max3_u32 v11, v104, v105, v106
  v_max3_u32 v11, v11, v107, v108
  v_max3_u32 v11, v11, v109, v110
  v_max3_u32 v11, v11, v111, v112
  v_max3_u32 v11, v11, v113, v114
  v_max3_u32 v11, v11, v115, v116
  v_max3_u32 v11, v11, v117, v118
  v_max3_u32 v11, v11, v119, v120
  v_max3_u32 v11, v11, v121, v122
  v_max3_u32 v11, v11, v123, v124
  v_max3_u32 v11, v11, v125, v126
  v_max3_u32 v11, v11, v127, v128
  v_max3_u32 v11, v11, v129, v130
  v_max3_u32 v11, v11, v131, v132
  v_max3_u32 v11, v11, v133, v134
  v_max3_u32 v11, v11, v135, v136
  v_max3_u32 v11, v11, v137, v138
  v_max3_u32 v11, v11, v139, v140
  v_max3_u32 v11, v11, v141, v142
  v_max3_u32 v11, v11, v143, v144
  v_max3_u32 v11, v11, v145, v146
  v_max3_u32 v11, v11, v147, v148
  v_max3_u32 v11, v11, v149, v150
  v_max3_u32 v11, v11, v151, v152
  v_max3_u32 v11, v11, v153, v154
  v_max3_u32 v11, v11, v155, v156
  v_max3_u32 v11, v11, v157, v158
  v_max3_u32 v11, v11, v159, v160
  v_max3_u32 v11, v11, v161, v162
  v_max3_u32 v11, v11, v163, v164
  v_max3_u32 v11, v11, v165, v166
  v_max3_u32 v11, v11, v167, v168
  v_max3_u32 v11, v11, v169, v170
  v_max3_u32 v11, v11, v171, v172
  v_max3_u32 v11, v11, v173, v174
  v_max_u32 v11, v11, v175
  v_cmp_eq_u32 vcc, -1, v11
  s_cbranch_vccz pok_280
  s_sleep 2
  s_sub_u32 s52, s52, 1
  s_cbranch_scc0 poll_279
  s_mov_b32 s54, 63
  s_branch k1_fail
pok_280:
  s_branch bk_241
rt_242:
  s_mov_b32 s52, 60000
poll_281:
  buffer_load_dword v11, v213, s[32:35], s66 offen sc1
  s_waitcnt vmcnt(0)
  v_cmp_eq_u32 vcc, -1, v11
  s_cbranch_vccz pok_282
  s_sleep 2
  s_sub_u32 s52, s52, 1
  s_cbranch_scc0 poll_281
  s_mov_b32 s54, 65
  s_branch k1_fail
pok_282:
  s_mov_b32 s52, 60000
poll_283:
  buffer_load_dwordx4 v[112:115], v3, s[32:35], s69 offen offset:0 sc1
  buffer_load_dwordx4 v[116:119], v3, s[32:35], s69 offen offset:1024 sc1
  buffer_load_dwordx4 v[120:123], v3, s[32:35], s69 offen offset:2048 sc1
  buffer_load_dwordx4 v[124:127], v3, s[32:35], s69 offen offset:3072 sc1
  buffer_load_dwordx4 v[128:131], v3, s[32:35], s70 offen offset:0 sc1
  buffer_load_dwordx4 v[132:135], v3, s[32:35], s70 offen offset:1024 sc1
  buffer_load_dwordx4 v[136:139], v3, s[32:35], s70 offen offset:2048 sc1
  buffer_load_dwordx4 v[140:143], v3, s[32:35], s70 offen offset:3072 sc1
  buffer_load_dwordx4 v[144:147], v3, s[32:35], s71 offen offset:0 sc1
  buffer_load_dwordx4 v[148:151], v3, s[32:35], s71 offen offset:1024 sc1
  buffer_load_dwordx4 v[152:155], v3, s[32:35], s71 offen offset:2048 sc1
  buffer_load_dwordx4 v[156:159], v3, s[32:35], s71 offen offset:3072 sc1
  buffer_load_dwordx4 v[160:163], v3, s[32:35], s72 offen offset:0 sc1
  buffer_load_dwordx4 v[164:167], v3, s[32:35], s72 offen offset:1024 sc1
  buffer_load_dwordx4 v[168:171], v3, s[32:35], s72 offen offset:2048 sc1
  buffer_load_dwordx4 v[172:175], v3, s[32:35], s72 offen offset:3072 sc1
  s_waitcnt vmcnt(0)
  v_max3_u32 v11, v112, v113, v114
  v_max3_u32 v11, v11, v115, v116
  v_max3_u32 v11, v11, v117, v118
  v_max3_u32 v11, v11, v119, v120
  v_max3_u32 v11, v11, v121, v122
  v_max3_u32 v11, v11, v123, v124
  v_max3_u32 v11, v11, v125, v126
  v_max3_u32 v11, v11, v127, v128
  v_max3_u32 v11, v11, v129, v130
  v_max3_u32 v11, v11, v131, v132
  v_max3_u32 v11, v11, v133, v134
  v_max3_u32 v11, v11, v135, v136
  v_max3_u32 v11, v11, v137, v138
  v_max3_u32 v11, v11, v139, v140
  v_max3_u32 v11, v11, v141, v142
  v_max3_u32 v11, v11, v143, v144
  v_max3_u32 v11, v11, v145, v146
  v_max3_u32 v11, v11, v147, v148
  v_max3_u32 v11, v11, v149, v150
  v_max3_u32 v11, v11, v151, v152
  v_max3_u32 v11, v11, v153, v154
  v_max3_u32 v11, v11, v155, v156
  v_max3_u32 v11, v11, v157, v158
  v_max3_u32 v11, v11, v159, v160
  v_max3_u32 v11, v11, v161, v162
  v_max3_u32 v11, v11, v163, v164
  v_max3_u32 v11, v11, v165, v166
  v_max3_u32 v11, v11, v167, v168
  v_max3_u32 v11, v11, v169, v170
  v_max3_u32 v11, v11, v171, v172
  v_max3_u32 v11, v11, v173, v174
  v_max_u32 v11, v11, v175
  v_cmp_eq_u32 vcc, -1, v11
  s_cbranch_vccz pok_284
  s_sleep 2
  s_sub_u32 s52, s52, 1
  s_cbranch_scc0 poll_283
  s_mov_b32 s54, 63
  s_branch k1_fail
pok_284:
  s_branch bk_243
rt_244:
  s_mov_b32 s52, 60000
poll_285:
  buffer_load_dword v11, v213, s[32:35], s66 offen sc1
  s_waitcnt vmcnt(0)
  v_cmp_eq_u32 vcc, -1, v11
  s_cbranch_vccz pok_286
  s_sleep 2
  s_sub_u32 s52, s52, 1
  s_cbranch_scc0 poll_285
  s_mov_b32 s54, 65
  s_branch k1_fail
pok_286:
  s_mov_b32 s52, 60000
poll_287:
  buffer_load_dwordx4 v[120:123], v3, s[32:35], s69 offen offset:2048 sc1
  buffer_load_dwordx4 v[124:127], v3, s[32:35], s69 offen offset:3072 sc1
  buffer_load_dwordx4 v[128:131], v3, s[32:35], s70 offen offset:0 sc1
  buffer_load_dwordx4 v[132:135], v3, s[32:35], s70 offen offset:1024 sc1
  buffer_load_dwordx4 v[136:139], v3, s[32:35], s70 offen offset:2048 sc1
  buffer_load_dwordx4 v[140:143], v3, s[32:35], s70 offen offset:3072 sc1
  buffer_load_dwordx4 v[144:147], v3, s[32:35], s71 offen offset:0 sc1
  buffer_load_dwordx4 v[148:151], v3, s[32:35], s71 offen offset:1024 sc1
  buffer_load_dwordx4 v[152:155], v3, s[32:35], s71 offen offset:2048 sc1
  buffer_load_dwordx4 v[156:159], v3, s[32:35], s71 offen offset:3072 sc1
  buffer_load_dwordx4 v[160:163], v3, s[32:35], s72 offen offset:0 sc1
  buffer_load_dwordx4 v[164:167], v3, s[32:35], s72 offen offset:1024 sc1
  buffer_load_dwordx4 v[168:171], v3, s[32:35], s72 offen offset:2048 sc1
  buffer_load_dwordx4 v[172:175], v3, s[32:35], s72 offen offset:3072 sc1
  s_waitcnt vmcnt(0)
  v_max3_u32 v11, v120, v121, v122
  v_max3_u32 v11, v11, v123, v124
  v_max3_u32 v11, v11, v125, v126
  v_max3_u32 v11, v11, v127, v128
  v_max3_u32 v11, v11, v129, v130
  v_max3_u32 v11, v11, v131, v132
  v_max3_u32 v11, v11, v133, v134
  v_max3_u32 v11, v11, v135, v136
  v_max3_u32 v11, v11, v137, v138
  v_max3_u32 v11, v11, v139, v140
  v_max3_u32 v11, v11, v141, v142
  v_max3_u32 v11, v11, v143, v144
  v_max3_u32 v11, v11, v145, v146
  v_max3_u32 v11, v11, v147, v148
  v_max3_u32 v11, v11, v149, v150
  v_max3_u32 v11, v11, v151, v152
  v_max3_u32 v11, v11, v153, v154
  v_max3_u32 v11, v11, v155, v156
  v_max3_u32 v11, v11, v157, v158
  v_max3_u32 v11, v11, v159, v160
  v_max3_u32 v11, v11, v161, v162
  v_max3_u32 v11, v11, v163, v164
  v_max3_u32 v11, v11, v165, v166
  v_max3_u32 v11, v11, v167, v168
  v_max3_u32 v11, v11, v169, v170
  v_max3_u32 v11, v11, v171, v172
  v_max3_u32 v11, v11, v173, v174
  v_max_u32 v11, v11, v175
  v_cmp_eq_u32 vcc, -1, v11
  s_cbranch_vccz pok_288
  s_sleep 2
  s_sub_u32 s52, s52, 1
  s_cbranch_scc0 poll_287
  s_mov_b32 s54, 63
  s_branch k1_fail
pok_288:
  s_branch bk_245
rt_246:
  s_mov_b32 s52, 60000
poll_289:
  buffer_load_dword v11, v213, s[32:35], s66 offen sc1
  s_waitcnt vmcnt(0)
  v_cmp_eq_u32 vcc, -1, v11
  s_cbranch_vccz pok_290
  s_sleep 2
  s_sub_u32 s52, s52, 1
  s_cbranch_scc0 poll_289
  s_mov_b32 s54, 65
  s_branch k1_fail
pok_290:
  s_mov_b32 s52, 60000
poll_291:
  buffer_load_dwordx4 v[128:131], v3, s[32:35], s70 offen offset:0 sc1
  buffer_load_dwordx4 v[132:135], v3, s[32:35], s70 offen offset:1024 sc1
  buffer_load_dwordx4 v[136:139], v3, s[32:35], s70 offen offset:2048 sc1
  buffer_load_dwordx4 v[140:143], v3, s[32:35], s70 offen offset:3072 sc1
  buffer_load_dwordx4 v[144:147], v3, s[32:35], s71 offen offset:0 sc1
  buffer_load_dwordx4 v[148:151], v3, s[32:35], s71 offen offset:1024 sc1
  buffer_load_dwordx4 v[152:155], v3, s[32:35], s71 offen offset:2048 sc1
  buffer_load_dwordx4 v[156:159], v3, s[32:35], s71 offen offset:3072 sc1
  buffer_load_dwordx4 v[160:163], v3, s[32:35], s72 offen offset:0 sc1
  buffer_load_dwordx4 v[164:167], v3, s[32:35], s72 offen offset:1024 sc1
  buffer_load_dwordx4 v[168:171], v3, s[32:35], s72 offen offset:2048 sc1
  buffer_load_dwordx4 v[172:175], v3, s[32:35], s72 offen offset:3072 sc1
  s_waitcnt vmcnt(0)
  v_max3_u32 v11, v128, v129, v130
  v_max3_u32 v11, v11, v131, v132
  v_max3_u32 v11, v11, v133, v134
  v_max3_u32 v11, v11, v135, v136
  v_max3_u32 v11, v11, v137, v138
  v_max3_u32 v11, v11, v139, v140
  v_max3_u32 v11, v11, v141, v142
  v_max3_u32 v11, v11, v143, v144
  v_max3_u32 v11, v11, v145, v146
  v_max3_u32 v11, v11, v147, v148
  v_max3_u32 v11, v11, v149, v150
  v_max3_u32 v11, v11, v151, v152
  v_max3_u32 v11, v11, v153, v154
  v_max3_u32 v11, v11, v155, v156
  v_max3_u32 v11, v11, v157, v158
  v_max3_u32 v11, v11, v159, v160
  v_max3_u32 v11, v11, v161, v162
  v_max3_u32 v11, v11, v163, v164
  v_max3_u32 v11, v11, v165, v166
  v_max3_u32 v11, v11, v167, v168
  v_max3_u32 v11, v11, v169, v170
  v_max3_u32 v11, v11, v171, v172
  v_max3_u32 v11, v11, v173, v174
  v_max_u32 v11, v11, v175
  v_cmp_eq_u32 vcc, -1, v11
  s_cbranch_vccz pok_292
  s_sleep 2
  s_sub_u32 s52, s52, 1
  s_cbranch_scc0 poll_291
  s_mov_b32 s54, 63
  s_branch k1_fail
pok_292:
  s_branch bk_247
rt_248:
  s_mov_b32 s52, 60000
poll_293:
  buffer_load_dword v11, v213, s[32:35], s66 offen sc1
  s_waitcnt vmcnt(0)
  v_cmp_eq_u32 vcc, -1, v11
  s_cbranch_vccz pok_294
  s_sleep 2
  s_sub_u32 s52, s52, 1
  s_cbranch_scc0 poll_293
  s_mov_b32 s54, 65
  s_branch k1_fail
pok_294:
  s_mov_b32 s52, 60000
poll_295:
  buffer_load_dwordx4 v[136:139], v3, s[32:35], s70 offen offset:2048 sc1
  buffer_load_dwordx4 v[140:143], v3, s[32:35], s70 offen offset:3072 sc1
  buffer_load_dwordx4 v[144:147], v3, s[32:35], s71 offen offset:0 sc1
  buffer_load_dwordx4 v[148:151], v3, s[32:35], s71 offen offset:1024 sc1
  buffer_load_dwordx4 v[152:155], v3, s[32:35], s71 offen offset:2048 sc1
  buffer_load_dwordx4 v[156:159], v3, s[32:35], s71 offen offset:3072 sc1
  buffer_load_dwordx4 v[160:163], v3, s[32:35], s72 offen offset:0 sc1
  buffer_load_dwordx4 v[164:167], v3, s[32:35], s72 offen offset:1024 sc1
  buffer_load_dwordx4 v[168:171], v3, s[32:35], s72 offen offset:2048 sc1
  buffer_load_dwordx4 v[172:175], v3, s[32:35], s72 offen offset:3072 sc1
  s_waitcnt vmcnt(0)
  v_max3_u32 v11, v136, v137, v138
  v_max3_u32 v11, v11, v139, v140
  v_max3_u32 v11, v11, v141, v142
  v_max3_u32 v11, v11, v143, v144
  v_max3_u32 v11, v11, v145, v146
  v_max3_u32 v11, v11, v147, v148
  v_max3_u32 v11, v11, v149, v150
  v_max3_u32 v11, v11, v151, v152
  v_max3_u32 v11, v11, v153, v154
  v_max3_u32 v11, v11, v155, v156
  v_max3_u32 v11, v11, v157, v158
  v_max3_u32 v11, v11, v159, v160
  v_max3_u32 v11, v11, v161, v162
  v_max3_u32 v11, v11, v163, v164
  v_max3_u32 v11, v11, v165, v166
  v_max3_u32 v11, v11, v167, v168
  v_max3_u32 v11, v11, v169, v170
  v_max3_u32 v11, v11, v171, v172
  v_max3_u32 v11, v11, v173, v174
  v_max_u32 v11, v11, v175
  v_cmp_eq_u32 vcc, -1, v11
  s_cbranch_vccz pok_296
  s_sleep 2
  s_sub_u32 s52, s52, 1
  s_cbranch_scc0 poll_295
  s_mov_b32 s54, 63
  s_branch k1_fail
pok_296:
  s_branch bk_249
rt_250:
  s_mov_b32 s52, 60000
poll_297:
  buffer_load_dword v11, v213, s[32:35], s66 offen sc1
  s_waitcnt vmcnt(0)
  v_cmp_eq_u32 vcc, -1, v11
  s_cbranch_vccz pok_298
  s_sleep 2
  s_sub_u32 s52, s52, 1
  s_cbranch_scc0 poll_297
  s_mov_b32 s54, 65
  s_branch k1_fail
pok_298:
  s_mov_b32 s52, 60000
poll_299:
  buffer_load_dwordx4 v[144:147], v3, s[32:35], s71 offen offset:0 sc1
  buffer_load_dwordx4 v[148:151], v3, s[32:35], s71 offen offset:1024 sc1
  buffer_load_dwordx4 v[152:155], v3, s[32:35], s71 offen offset:2048 sc1
  buffer_load_dwordx4 v[156:159], v3, s[32:35], s71 offen offset:3072 sc1
  buffer_load_dwordx4 v[160:163], v3, s[32:35], s72 offen offset:0 sc1
  buffer_load_dwordx4 v[164:167], v3, s[32:35], s72 offen offset:1024 sc1
  buffer_load_dwordx4 v[168:171], v3, s[32:35], s72 offen offset:2048 sc1
  buffer_load_dwordx4 v[172:175], v3, s[32:35], s72 offen offset:3072 sc1
  s_waitcnt vmcnt(0)
  v_max3_u32 v11, v144, v145, v146
  v_max3_u32 v11, v11, v147, v148
  v_max3_u32 v11, v11, v149, v150
  v_max3_u32 v11, v11, v151, v152
  v_max3_u32 v11, v11, v153, v154
  v_max3_u32 v11, v11, v155, v156
  v_max3_u32 v11, v11, v157, v158
  v_max3_u32 v11, v11, v159, v160
  v_max3_u32 v11, v11, v161, v162
  v_max3_u32 v11, v11, v163, v164
  v_max3_u32 v11, v11, v165, v166
  v_max3_u32 v11, v11, v167, v168
  v_max3_u32 v11, v11, v169, v170
  v_max3_u32 v11, v11, v171, v172
  v_max3_u32 v11, v11, v173, v174
  v_max_u32 v11, v11, v175
  v_cmp_eq_u32 vcc, -1, v11
  s_cbranch_vccz pok_300
  s_sleep 2
  s_sub_u32 s52, s52, 1
  s_cbranch_scc0 poll_299
  s_mov_b32 s54, 63
  s_branch k1_fail
pok_300:
  s_branch bk_251
rt_252:
  s_mov_b32 s52, 60000
poll_301:
  buffer_load_dword v11, v213, s[32:35], s66 offen sc1
  s_waitcnt vmcnt(0)
  v_cmp_eq_u32 vcc, -1, v11
  s_cbranch_vccz pok_302
  s_sleep 2
  s_sub_u32 s52, s52, 1
  s_cbranch_scc0 poll_301
  s_mov_b32 s54, 65
  s_branch k1_fail
pok_302:
  s_mov_b32 s52, 60000
poll_303:
  buffer_load_dwordx4 v[152:155], v3, s[32:35], s71 offen offset:2048 sc1
  buffer_load_dwordx4 v[156:159], v3, s[32:35], s71 offen offset:3072 sc1
  buffer_load_dwordx4 v[160:163], v3, s[32:35], s72 offen offset:0 sc1
  buffer_load_dwordx4 v[164:167], v3, s[32:35], s72 offen offset:1024 sc1
  buffer_load_dwordx4 v[168:171], v3, s[32:35], s72 offen offset:2048 sc1
  buffer_load_dwordx4 v[172:175], v3, s[32:35], s72 offen offset:3072 sc1
  s_waitcnt vmcnt(0)
  v_max3_u32 v11, v152, v153, v154
  v_max3_u32 v11, v11, v155, v156
  v_max3_u32 v11, v11, v157, v158
  v_max3_u32 v11, v11, v159, v160
  v_max3_u32 v11, v11, v161, v162
  v_max3_u32 v11, v11, v163, v164
  v_max3_u32 v11, v11, v165, v166
  v_max3_u32 v11, v11, v167, v168
  v_max3_u32 v11, v11, v169, v170
  v_max3_u32 v11, v11, v171, v172
  v_max3_u32 v11, v11, v173, v174
  v_max_u32 v11, v11, v175
  v_cmp_eq_u32 vcc, -1, v11
  s_cbranch_vccz pok_304
  s_sleep 2
  s_sub_u32 s52, s52, 1
  s_cbranch_scc0 poll_303
  s_mov_b32 s54, 63
  s_branch k1_fail
pok_304:
  s_branch bk_253
rt_254:
  s_mov_b32 s52, 60000
poll_305:
  buffer_load_dword v11, v213, s[32:35], s66 offen sc1
  s_waitcnt vmcnt(0)
  v_cmp_eq_u32 vcc, -1, v11
  s_cbranch_vccz pok_306
  s_sleep 2
  s_sub_u32 s52, s52, 1
  s_cbranch_scc0 poll_305
  s_mov_b32 s54, 65
  s_branch k1_fail
pok_306:
  s_mov_b32 s52, 60000
poll_307:
  buffer_load_dwordx4 v[160:163], v3, s[32:35], s72 offen offset:0 sc1
  buffer_load_dwordx4 v[164:167], v3, s[32:35], s72 offen offset:1024 sc1
  buffer_load_dwordx4 v[168:171], v3, s[32:35], s72 offen offset:2048 sc1
  buffer_load_dwordx4 v[172:175], v3, s[32:35], s72 offen offset:3072 sc1
  s_waitcnt vmcnt(0)
  v_max3_u32 v11, v160, v161, v162
  v_max3_u32 v11, v11, v163, v164
  v_max3_u32 v11, v11, v165, v166
  v_max3_u32 v11, v11, v167, v168
  v_max3_u32 v11, v11, v169, v170
  v_max3_u32 v11, v11, v171, v172
  v_max3_u32 v11, v11, v173, v174
  v_max_u32 v11, v11, v175
  v_cmp_eq_u32 vcc, -1, v11
  s_cbranch_vccz pok_308
  s_sleep 2
  s_sub_u32 s52, s52, 1
  s_cbranch_scc0 poll_307
  s_mov_b32 s54, 63
  s_branch k1_fail
pok_308:
  s_branch bk_255
rt_256:
  s_mov_b32 s52, 60000
poll_309:
  buffer_load_dword v11, v213, s[32:35], s66 offen sc1
  s_waitcnt vmcnt(0)
  v_cmp_eq_u32 vcc, -1, v11
  s_cbranch_vccz pok_310
  s_sleep 2
  s_sub_u32 s52, s52, 1
  s_cbranch_scc0 poll_309
  s_mov_b32 s54, 65
  s_branch k1_fail
pok_310:
  s_mov_b32 s52, 60000
poll_311:
  buffer_load_dwordx4 v[168:171], v3, s[32:35], s72 offen offset:2048 sc1
  buffer_load_dwordx4 v[172:175], v3, s[32:35], s72 offen offset:3072 sc1
  s_waitcnt vmcnt(0)
  v_max3_u32 v11, v168, v169, v170
  v_max3_u32 v11, v11, v171, v172
  v_max3_u32 v11, v11, v173, v174
  v_max_u32 v11, v11, v175
  v_cmp_eq_u32 vcc, -1, v11
  s_cbranch_vccz pok_312
  s_sleep 2
  s_sub_u32 s52, s52, 1
  s_cbranch_scc0 poll_311
  s_mov_b32 s54, 63
  s_branch k1_fail
pok_312:
  s_branch bk_257
.section .rodata,"a"
.p2align 6
.amdhsa_kernel prep_kernel
  .amdhsa_next_free_vgpr 400
  .amdhsa_next_free_sgpr 102
  .amdhsa_accum_offset 256
  .amdhsa_group_segment_fixed_size 0
  .amdhsa_kernarg_size 112
  .amdhsa_user_sgpr_count 2
  .amdhsa_user_sgpr_kernarg_segment_ptr 1
  .amdhsa_system_sgpr_workgroup_id_x 1
.end_amdhsa_kernel
.section .rodata,"a"
.p2align 6
.amdhsa_kernel interleave_layers__memory_aug_recurrent_mem_tr__glu_gated_glu__prompt_kernel
  .amdhsa_next_free_vgpr 512
  .amdhsa_next_free_sgpr 102
  .amdhsa_accum_offset 256
  .amdhsa_group_segment_fixed_size 0
  .amdhsa_kernarg_size 112
  .amdhsa_user_sgpr_count 2
  .amdhsa_user_sgpr_kernarg_segment_ptr 1
  .amdhsa_system_sgpr_workgroup_id_x 1
.end_amdhsa_kernel
```
